```python
import torch

def _softmax(x, axis=-1):
    return torch.softmax(x, dim=axis)
def _gelu(x):
    return torch.nn.functional.gelu(x, approximate="tanh")
def _silu(x):
    return torch.nn.functional.silu(x)
def _sigmoid(x):
    return torch.sigmoid(x)
def _layernorm(x, axis=-1, eps=1e-5):
    m = x.mean(dim=axis, keepdim=True)
    v = x.var(dim=axis, keepdim=True, unbiased=False)
    return (x - m) / torch.sqrt(v + eps)
def _scatter_add(tgt, idx, src, axis=0):
    return tgt.clone().index_add_(axis, idx, src)
def _segment_sum(src, seg, n):
    out = torch.zeros((n,) + src.shape[1:], dtype=src.dtype)
    return out.index_add_(0, seg, src)
def _pad(x, pw):
    flat = tuple(v for pair in reversed(pw) for v in pair)
    return torch.nn.functional.pad(x, flat)

kernel_name = 'sequential_preLN__compressed_kv_cla__dense_activation_squared_relu__prompt'

def setup_inputs():

    _w = (lambda a: (lambda t: t.to(torch.bfloat16) if t.is_floating_point() else t)(torch.as_tensor(a)))
    def _A_setup():
        B, H, Sq, Sk, D, M = 1, 32, 2048, 2048, 128, 576
        Dc = 4 * D
        return {
            "x": _w((lambda *s: torch.randn(*s, dtype=torch.bfloat16) * 0.05)(B, Sq, M)),
            "c_kv": _w((lambda *s: torch.randn(*s, dtype=torch.bfloat16) * 0.4)(B, Sk, Dc)),
            "w_q": _w((lambda *s: torch.randn(*s, dtype=torch.bfloat16) * 3.2)(M, H, D) * (M ** -0.5)),
            "w_uk": _w((lambda *s: torch.randn(*s, dtype=torch.bfloat16) * 3.2)(Dc, H, D) * (Dc ** -0.5)),
            "w_uv": _w((lambda *s: torch.randn(*s, dtype=torch.bfloat16) * 0.4)(Dc, H, D) * (Dc ** -0.5)),
            "w_o": _w((lambda *s: torch.randn(*s, dtype=torch.bfloat16) * 0.4)(H, D, M) * ((H * D) ** -0.5)),
        }
    _A_in = _A_setup()

    def _B_setup():
        B, S, D, F = 1, 2048, 576, 4608
        return {
            "x": _w((lambda *s: torch.randn(*s, dtype=torch.bfloat16) * 0.05)(B, S, D)),
            "w1": _w((lambda *s: torch.randn(*s, dtype=torch.bfloat16) * 0.05)(D, F)),
            "b1": _w((lambda *s: torch.randn(*s, dtype=torch.bfloat16) * 0.4)(F)),
            "w2": _w((lambda *s: torch.randn(*s, dtype=torch.bfloat16) * 0.05)(F, D)),
            "b2": _w((lambda *s: torch.randn(*s, dtype=torch.bfloat16) * 3.2)(D)),
        }
    _B_in = _B_setup()

    return {
        "A_x": _A_in["x"],
        "A_c_kv": _A_in["c_kv"],
        "A_w_q": _A_in["w_q"],
        "A_w_uk": _A_in["w_uk"],
        "A_w_uv": _A_in["w_uv"],
        "A_w_o": _A_in["w_o"],
        "B_x": _B_in["x"],
        "B_w1": _B_in["w1"],
        "B_b1": _B_in["b1"],
        "B_w2": _B_in["w2"],
        "B_b2": _B_in["b2"],
    }

def reference(A_x, A_c_kv, A_w_q, A_w_uk, A_w_uv, A_w_o, B_x, B_w1, B_b1, B_w2, B_b2):
    def _A_ref(x, c_kv, w_q, w_uk, w_uv, w_o):
        B, Sq, M = x.shape[0], x.shape[1], x.shape[2]
        Sk = c_kv.shape[1]
        H, D = w_q.shape[1], w_q.shape[2]
        q = torch.einsum("bqm,mhd->bhqd", x, w_q)
        k = torch.einsum("bkc,chd->bhkd", c_kv, w_uk)
        v = torch.einsum("bkc,chd->bhkd", c_kv, w_uv)
        scores = torch.einsum("bhqd,bhkd->bhqk", q, k) * (D ** -0.5)
        off = Sk - Sq
        qi = torch.arange(Sq)[:, None]
        kj = torch.arange(Sk)[None, :]
        cmask = kj <= (qi + off)
        scores = torch.where(cmask[None, None], scores, -1e9)
        p = _softmax(scores, axis=-1)
        ctx = torch.einsum("bhqk,bhkd->bhqd", p, v)
        return torch.einsum("bhqd,hdm->bqm", ctx, w_o)

    def _B_ref(x, w1, b1, w2, b2):
        h = torch.einsum("bsd,df->bsf", x, w1) + b1
        zero = torch.zeros_like(h)
        r = torch.where(h > zero, h, zero)
        h = r * r
        out = torch.einsum("bsf,fd->bsd", h, w2) + b2
        return out

    x = A_x
    h = x + _A_ref(_layernorm(x, axis=-1), A_c_kv, A_w_q, A_w_uk, A_w_uv, A_w_o)
    h2 = h + _B_ref(_layernorm(h, axis=-1), B_w1, B_b1, B_w2, B_b2)
    return h2
```

```asm
; @launch kernel=kv_proj_kernel grid=(256,1,1) block=(512,1,1) lds=133120
; @launch kernel=attn_kernel grid=(256,1,1) block=(512,1,1) lds=159232
; @launch kernel=oproj_kernel grid=(256,1,1) block=(512,1,1) lds=151552
; @launch kernel=red1_kernel grid=(512,1,1) block=(256,1,1) lds=0
; @launch kernel=mlp_up_kernel grid=(256,1,1) block=(512,1,1) lds=77824
; @launch kernel=down_kernel grid=(256,1,1) block=(512,1,1) lds=151552
; @launch kernel=red2_kernel grid=(512,1,1) block=(256,1,1) lds=0
.amdgcn_target "amdgcn-amd-amdhsa--gfx950"
.text
.globl kv_proj_kernel
.p2align 8
.type kv_proj_kernel,@function
kv_proj_kernel:
    s_cmp_ge_u32 s2, 256
    s_cbranch_scc1 L_kv_end
    s_load_dwordx2 s[44:45], s[0:1], 8
    s_load_dwordx4 s[48:51], s[0:1], 24
    s_load_dwordx2 s[46:47], s[0:1], 104
    s_load_dwordx2 s[52:53], s[0:1], 0
    v_lshrrev_b32 v2, 6, v0
    v_and_b32 v1, 63, v0
    s_nop 0
    v_readfirstlane_b32 s20, v2
    s_nop 3
    s_and_b32 s21, s20, 3
    s_lshr_b32 s32, s20, 2
    s_and_b32 s22, s32, 1
    s_lshr_b32 s23, s32, 1
    s_and_b32 s32, s2, 7
    s_lshr_b32 s33, s2, 3
    s_and_b32 s34, s33, 3
    s_lshl_b32 s32, s32, 2
    s_add_u32 s32, s32, s34
    s_lshr_b32 s33, s33, 2
    s_lshl_b32 s24, s33, 8
    s_and_b32 s34, s32, 15
    s_lshl_b32 s25, s34, 8
    s_lshr_b32 s26, s32, 4
    s_waitcnt lgkmcnt(0)
    s_mov_b32 s4, s44
    s_mov_b32 s5, s45
    s_mov_b32 s6, 0x200000
    s_mov_b32 s7, 0x00020000
    s_cmp_eq_u32 s26, 0
    s_cselect_b32 s8, s48, s50
    s_cselect_b32 s9, s49, s51
    s_mov_b32 s10, 0x400000
    s_mov_b32 s11, 0x00020000
    s_mov_b32 s33, 0x2000000
    s_cselect_b32 s32, 0x1000000, s33
    s_add_u32 s12, s46, s32
    s_addc_u32 s13, s47, 0
    s_mov_b32 s14, 0x1000000
    s_mov_b32 s15, 0x00020000
    s_mov_b32 s16, s52
    s_mov_b32 s17, s53
    s_mov_b32 s18, 0x240000
    s_mov_b32 s19, 0x00020000
    s_mov_b32 s40, s46
    s_mov_b32 s41, s47
    s_mov_b32 s42, 0x240000
    s_mov_b32 s43, 0x00020000
    s_mov_b32 s27, 0
    s_mov_b32 s28, 0
    s_lshr_b32 s32, s2, 3
    s_and_b32 s33, s32, 3
    s_lshr_b32 s32, s32, 2
    s_mul_i32 s32, s32, 0
    s_mul_i32 s33, s33, 0
    s_add_u32 s54, s32, s33
    s_cmp_ge_u32 s54, 16
    s_cselect_b32 s32, 16, 0
    s_sub_u32 s54, s54, s32
    s_mul_i32 s32, s54, 64
    s_add_u32 s27, s27, s32
    s_mul_i32 s32, s54, 0x40000
    s_add_u32 s28, s28, s32
    s_lshl_b32 s32, s2, 3
    s_add_u32 s32, s32, s20
    s_mul_i32 s35, s32, 1152
    v_lshlrev_b32 v50, 5, v1
    s_mov_b32 exec_lo, 0xffffffff
    s_mov_b32 exec_hi, 0xf
    buffer_load_dwordx4 v[20:23], v50, s[16:19], s35 offen
    buffer_load_dwordx4 v[24:27], v50, s[16:19], s35 offen offset:16
    s_mov_b64 exec, -1
    s_lshr_b32 s38, s32, 5
    s_mul_i32 s38, s38, 36864
    s_and_b32 s39, s32, 31
    s_lshl_b32 s39, s39, 4
    s_add_u32 s38, s38, s39
    s_mov_b32 s55, s20
    s_mul_i32 s32, s55, 32
    s_add_u32 s32, s32, 0
    v_lshrrev_b32 v2, 2, v1
    v_add_u32 v2, s32, v2
    v_bfe_u32 v3, v2, 3, 1
    v_mul_u32_u24 v3, 3, v3
    v_and_b32 v4, 3, v1
    v_xor_b32 v4, v4, v3
    v_lshlrev_b32 v4, 4, v4
    v_add_u32 v2, s24, v2
    s_mov_b32 s33, 1024
    v_mul_lo_u32 v2, v2, s33
    v_add_u32 v10, v2, v4
    s_mul_i32 s32, s55, 32
    s_add_u32 s32, s32, 16
    v_lshrrev_b32 v2, 2, v1
    v_add_u32 v2, s32, v2
    v_bfe_u32 v3, v2, 3, 1
    v_mul_u32_u24 v3, 3, v3
    v_and_b32 v4, 3, v1
    v_xor_b32 v4, v4, v3
    v_lshlrev_b32 v4, 4, v4
    v_add_u32 v2, s24, v2
    s_mov_b32 s33, 1024
    v_mul_lo_u32 v2, v2, s33
    v_add_u32 v11, v2, v4
    s_mul_i32 s29, s55, 2048
    s_lshl_b32 s34, s25, 1
    s_mov_b32 s33, 8192
    s_mul_i32 s32, s55, 2
    s_add_u32 s32, s32, 0
    s_and_b32 s35, s32, 3
    s_lshr_b32 s32, s32, 2
    s_lshl_b32 s32, s32, 3
    s_add_u32 s32, s32, s35
    v_lshrrev_b32 v2, 5, v1
    v_lshlrev_b32 v2, 2, v2
    v_add_u32 v2, s32, v2
    v_mul_lo_u32 v2, v2, s33
    v_and_b32 v3, 31, v1
    v_lshl_add_u32 v2, v3, 4, v2
    v_add_u32 v12, s34, v2
    s_mul_i32 s32, s55, 2
    s_add_u32 s32, s32, 1
    s_and_b32 s35, s32, 3
    s_lshr_b32 s32, s32, 2
    s_lshl_b32 s32, s32, 3
    s_add_u32 s32, s32, s35
    v_lshrrev_b32 v2, 5, v1
    v_lshlrev_b32 v2, 2, v2
    v_add_u32 v2, s32, v2
    v_mul_lo_u32 v2, v2, s33
    v_and_b32 v3, 31, v1
    v_lshl_add_u32 v2, v3, 4, v2
    v_add_u32 v13, s34, v2
    s_mul_i32 s30, s55, 2112
    s_mul_i32 s32, s21, 64
    v_and_b32 v2, 15, v1
    v_add_u32 v2, s32, v2
    v_lshrrev_b32 v3, 4, v1
    v_bfe_u32 v4, v2, 3, 1
    v_mul_u32_u24 v4, 3, v4
    v_xor_b32 v3, v3, v4
    v_lshlrev_b32 v3, 4, v3
    v_lshl_add_u32 v14, v2, 6, v3
    v_add_u32 v15, 0x10000, v14
    v_add_u32 v16, 0x20000, v14
    v_lshrrev_b32 v2, 4, v1
    v_bfe_u32 v3, v1, 2, 2
    v_and_b32 v4, 3, v1
    v_lshl_add_u32 v3, v2, 2, v3
    v_mul_u32_u24 v3, 1056, v3
    v_lshl_add_u32 v17, v4, 3, v3
    s_mul_i32 s33, s22, 256
    v_add_u32 v17, s33, v17
    v_add_u32 v18, 0x10000, v17
    v_add_u32 v19, 0x20000, v17
    s_add_u32 m0, s29, 0x0
    s_nop 0
    buffer_load_dwordx4 v10, s[4:7], s27 offen lds
    s_add_u32 m0, s29, 0x400
    s_nop 0
    buffer_load_dwordx4 v11, s[4:7], s27 offen lds
    s_add_u32 m0, s30, 0x4000
    s_nop 0
    buffer_load_dwordx4 v12, s[8:11], s28 offen lds
    s_add_u32 m0, s30, 0x4420
    s_nop 0
    buffer_load_dwordx4 v13, s[8:11], s28 offen lds
    s_add_u32 s27, s27, 64
    s_add_u32 s28, s28, 0x40000
    s_add_u32 s54, s54, 1
    s_cmp_eq_u32 s54, 16
    s_cselect_b32 s34, 0x400, 0
    s_cselect_b32 s35, 0x400000, 0
    s_cselect_b32 s54, 0, s54
    s_sub_u32 s27, s27, s34
    s_sub_u32 s28, s28, s35
    s_add_u32 m0, s29, 0x8200
    s_nop 0
    buffer_load_dwordx4 v10, s[4:7], s27 offen lds
    s_add_u32 m0, s29, 0x8600
    s_nop 0
    buffer_load_dwordx4 v11, s[4:7], s27 offen lds
    s_add_u32 m0, s30, 0xc200
    s_nop 0
    buffer_load_dwordx4 v12, s[8:11], s28 offen lds
    s_add_u32 m0, s30, 0xc620
    s_nop 0
    buffer_load_dwordx4 v13, s[8:11], s28 offen lds
    s_add_u32 s27, s27, 64
    s_add_u32 s28, s28, 0x40000
    s_add_u32 s54, s54, 1
    s_cmp_eq_u32 s54, 16
    s_cselect_b32 s34, 0x400, 0
    s_cselect_b32 s35, 0x400000, 0
    s_cselect_b32 s54, 0, s54
    s_sub_u32 s27, s27, s34
    s_sub_u32 s28, s28, s35
    s_add_u32 m0, s29, 0x10400
    s_nop 0
    buffer_load_dwordx4 v10, s[4:7], s27 offen lds
    s_add_u32 m0, s29, 0x10800
    s_nop 0
    buffer_load_dwordx4 v11, s[4:7], s27 offen lds
    s_add_u32 m0, s30, 0x14400
    s_nop 0
    buffer_load_dwordx4 v12, s[8:11], s28 offen lds
    s_add_u32 m0, s30, 0x14820
    s_nop 0
    buffer_load_dwordx4 v13, s[8:11], s28 offen lds
    s_add_u32 s27, s27, 64
    s_add_u32 s28, s28, 0x40000
    s_add_u32 s54, s54, 1
    s_cmp_eq_u32 s54, 16
    s_cselect_b32 s34, 0x400, 0
    s_cselect_b32 s35, 0x400000, 0
    s_cselect_b32 s54, 0, s54
    s_sub_u32 s27, s27, s34
    s_sub_u32 s28, s28, s35
    s_add_u32 m0, s29, 0x18600
    s_nop 0
    buffer_load_dwordx4 v10, s[4:7], s27 offen lds
    s_add_u32 m0, s29, 0x18a00
    s_nop 0
    buffer_load_dwordx4 v11, s[4:7], s27 offen lds
    s_add_u32 m0, s30, 0x1c600
    s_nop 0
    buffer_load_dwordx4 v12, s[8:11], s28 offen lds
    s_add_u32 m0, s30, 0x1ca20
    s_nop 0
    buffer_load_dwordx4 v13, s[8:11], s28 offen lds
    s_add_u32 s27, s27, 64
    s_add_u32 s28, s28, 0x40000
    s_add_u32 s54, s54, 1
    s_cmp_eq_u32 s54, 16
    s_cselect_b32 s34, 0x400, 0
    s_cselect_b32 s35, 0x400000, 0
    s_cselect_b32 s54, 0, s54
    s_sub_u32 s27, s27, s34
    s_sub_u32 s28, s28, s35
    s_load_dwordx2 s[56:57], s[0:1], 16
    s_lshl_b32 s32, s2, 3
    s_add_u32 s32, s32, s20
    s_lshl_b32 s32, s32, 13
    v_lshlrev_b32 v2, 7, v1
    s_waitcnt lgkmcnt(0)
    s_mov_b32 s16, s56
    s_mov_b32 s17, s57
    s_mov_b32 s18, 0x480000
    s_mov_b32 s19, 0x00020000
    buffer_load_dword v244, v2, s[16:19], s32 offen
    s_waitcnt vmcnt(17)
    v_lshlrev_b32 v28, 16, v20
    v_and_b32 v29, 0xffff0000, v20
    v_lshlrev_b32 v30, 16, v21
    v_and_b32 v31, 0xffff0000, v21
    v_lshlrev_b32 v32, 16, v22
    v_and_b32 v33, 0xffff0000, v22
    v_lshlrev_b32 v34, 16, v23
    v_and_b32 v35, 0xffff0000, v23
    v_lshlrev_b32 v36, 16, v24
    v_and_b32 v37, 0xffff0000, v24
    v_lshlrev_b32 v38, 16, v25
    v_and_b32 v39, 0xffff0000, v25
    v_lshlrev_b32 v40, 16, v26
    v_and_b32 v41, 0xffff0000, v26
    v_lshlrev_b32 v42, 16, v27
    v_and_b32 v43, 0xffff0000, v27
    v_mov_b32 v44, 0
    s_mov_b32 exec_lo, 0xffffffff
    s_mov_b32 exec_hi, 0xf
    v_add_f32 v44, v44, v28
    v_add_f32 v44, v44, v29
    v_add_f32 v44, v44, v30
    v_add_f32 v44, v44, v31
    v_add_f32 v44, v44, v32
    v_add_f32 v44, v44, v33
    v_add_f32 v44, v44, v34
    v_add_f32 v44, v44, v35
    v_add_f32 v44, v44, v36
    v_add_f32 v44, v44, v37
    v_add_f32 v44, v44, v38
    v_add_f32 v44, v44, v39
    v_add_f32 v44, v44, v40
    v_add_f32 v44, v44, v41
    v_add_f32 v44, v44, v42
    v_add_f32 v44, v44, v43
    s_mov_b64 exec, -1
    s_nop 1
    v_add_f32_dpp v44, v44, v44 row_shr:1 row_mask:0xf bank_mask:0xf
    s_nop 1
    v_add_f32_dpp v44, v44, v44 row_shr:2 row_mask:0xf bank_mask:0xf
    s_nop 1
    v_add_f32_dpp v44, v44, v44 row_shr:4 row_mask:0xf bank_mask:0xf
    s_nop 1
    v_add_f32_dpp v44, v44, v44 row_shr:8 row_mask:0xf bank_mask:0xf
    s_nop 1
    v_add_f32_dpp v44, v44, v44 row_bcast:15 row_mask:0xa bank_mask:0xf
    s_nop 1
    v_add_f32_dpp v44, v44, v44 row_bcast:31 row_mask:0xc bank_mask:0xf
    s_nop 1
    v_readlane_b32 s36, v44, 63
    s_nop 3
    s_mov_b32 s37, 0x3ae38e39
    v_mov_b32 v45, s36
    v_mul_f32 v45, s37, v45
    v_mov_b32 v44, 0
    s_mov_b32 exec_lo, 0xffffffff
    s_mov_b32 exec_hi, 0xf
    v_sub_f32 v49, v28, v45
    v_fmac_f32 v44, v49, v49
    v_sub_f32 v49, v29, v45
    v_fmac_f32 v44, v49, v49
    v_sub_f32 v49, v30, v45
    v_fmac_f32 v44, v49, v49
    v_sub_f32 v49, v31, v45
    v_fmac_f32 v44, v49, v49
    v_sub_f32 v49, v32, v45
    v_fmac_f32 v44, v49, v49
    v_sub_f32 v49, v33, v45
    v_fmac_f32 v44, v49, v49
    v_sub_f32 v49, v34, v45
    v_fmac_f32 v44, v49, v49
    v_sub_f32 v49, v35, v45
    v_fmac_f32 v44, v49, v49
    v_sub_f32 v49, v36, v45
    v_fmac_f32 v44, v49, v49
    v_sub_f32 v49, v37, v45
    v_fmac_f32 v44, v49, v49
    v_sub_f32 v49, v38, v45
    v_fmac_f32 v44, v49, v49
    v_sub_f32 v49, v39, v45
    v_fmac_f32 v44, v49, v49
    v_sub_f32 v49, v40, v45
    v_fmac_f32 v44, v49, v49
    v_sub_f32 v49, v41, v45
    v_fmac_f32 v44, v49, v49
    v_sub_f32 v49, v42, v45
    v_fmac_f32 v44, v49, v49
    v_sub_f32 v49, v43, v45
    v_fmac_f32 v44, v49, v49
    s_mov_b64 exec, -1
    s_nop 1
    v_add_f32_dpp v44, v44, v44 row_shr:1 row_mask:0xf bank_mask:0xf
    s_nop 1
    v_add_f32_dpp v44, v44, v44 row_shr:2 row_mask:0xf bank_mask:0xf
    s_nop 1
    v_add_f32_dpp v44, v44, v44 row_shr:4 row_mask:0xf bank_mask:0xf
    s_nop 1
    v_add_f32_dpp v44, v44, v44 row_shr:8 row_mask:0xf bank_mask:0xf
    s_nop 1
    v_add_f32_dpp v44, v44, v44 row_bcast:15 row_mask:0xa bank_mask:0xf
    s_nop 1
    v_add_f32_dpp v44, v44, v44 row_bcast:31 row_mask:0xc bank_mask:0xf
    s_nop 1
    v_readlane_b32 s36, v44, 63
    s_nop 3
    v_mov_b32 v46, s36
    v_mul_f32 v46, s37, v46
    v_cvt_pk_bf16_f32 v46, v46, v45
    v_and_b32 v45, 0xffff0000, v46
    v_lshlrev_b32 v46, 16, v46
    v_add_f32 v46, 0x3727c5ac, v46
    v_cvt_pk_bf16_f32 v46, v46, v46
    v_lshlrev_b32 v46, 16, v46
    v_sqrt_f32 v46, v46
    s_nop 0
    v_cvt_pk_bf16_f32 v46, v46, v46
    v_lshlrev_b32 v46, 16, v46
    v_rcp_f32 v48, v46
    v_sub_f32 v49, v28, v45
    v_sub_f32 v47, v29, v45
    v_cvt_pk_bf16_f32 v49, v49, v47
    v_and_b32 v47, 0xffff0000, v49
    v_lshlrev_b32 v49, 16, v49
    v_mul_f32 v49, v49, v48
    v_mul_f32 v47, v47, v48
    v_cvt_pk_bf16_f32 v20, v49, v47
    v_sub_f32 v49, v30, v45
    v_sub_f32 v47, v31, v45
    v_cvt_pk_bf16_f32 v49, v49, v47
    v_and_b32 v47, 0xffff0000, v49
    v_lshlrev_b32 v49, 16, v49
    v_mul_f32 v49, v49, v48
    v_mul_f32 v47, v47, v48
    v_cvt_pk_bf16_f32 v21, v49, v47
    v_sub_f32 v49, v32, v45
    v_sub_f32 v47, v33, v45
    v_cvt_pk_bf16_f32 v49, v49, v47
    v_and_b32 v47, 0xffff0000, v49
    v_lshlrev_b32 v49, 16, v49
    v_mul_f32 v49, v49, v48
    v_mul_f32 v47, v47, v48
    v_cvt_pk_bf16_f32 v22, v49, v47
    v_sub_f32 v49, v34, v45
    v_sub_f32 v47, v35, v45
    v_cvt_pk_bf16_f32 v49, v49, v47
    v_and_b32 v47, 0xffff0000, v49
    v_lshlrev_b32 v49, 16, v49
    v_mul_f32 v49, v49, v48
    v_mul_f32 v47, v47, v48
    v_cvt_pk_bf16_f32 v23, v49, v47
    v_sub_f32 v49, v36, v45
    v_sub_f32 v47, v37, v45
    v_cvt_pk_bf16_f32 v49, v49, v47
    v_and_b32 v47, 0xffff0000, v49
    v_lshlrev_b32 v49, 16, v49
    v_mul_f32 v49, v49, v48
    v_mul_f32 v47, v47, v48
    v_cvt_pk_bf16_f32 v24, v49, v47
    v_sub_f32 v49, v38, v45
    v_sub_f32 v47, v39, v45
    v_cvt_pk_bf16_f32 v49, v49, v47
    v_and_b32 v47, 0xffff0000, v49
    v_lshlrev_b32 v49, 16, v49
    v_mul_f32 v49, v49, v48
    v_mul_f32 v47, v47, v48
    v_cvt_pk_bf16_f32 v25, v49, v47
    v_sub_f32 v49, v40, v45
    v_sub_f32 v47, v41, v45
    v_cvt_pk_bf16_f32 v49, v49, v47
    v_and_b32 v47, 0xffff0000, v49
    v_lshlrev_b32 v49, 16, v49
    v_mul_f32 v49, v49, v48
    v_mul_f32 v47, v47, v48
    v_cvt_pk_bf16_f32 v26, v49, v47
    v_sub_f32 v49, v42, v45
    v_sub_f32 v47, v43, v45
    v_cvt_pk_bf16_f32 v49, v49, v47
    v_and_b32 v47, 0xffff0000, v49
    v_lshlrev_b32 v49, 16, v49
    v_mul_f32 v49, v49, v48
    v_mul_f32 v47, v47, v48
    v_cvt_pk_bf16_f32 v27, v49, v47
    s_mov_b32 exec_lo, 0xffffffff
    s_mov_b32 exec_hi, 0xf
    v_lshlrev_b32 v50, 10, v1
    buffer_store_dwordx4 v[20:23], v50, s[40:43], s38 offen sc0 sc1
    buffer_store_dwordx4 v[24:27], v50, s[40:43], s38 offen offset:512 sc0 sc1
    s_mov_b64 exec, -1
    s_nop 1
    v_mov_b32 v116, 0
    v_mov_b32 v117, 0
    v_mov_b32 v118, 0
    v_mov_b32 v119, 0
    v_mov_b32 v120, 0
    v_mov_b32 v121, 0
    v_mov_b32 v122, 0
    v_mov_b32 v123, 0
    v_mov_b32 v124, 0
    v_mov_b32 v125, 0
    v_mov_b32 v126, 0
    v_mov_b32 v127, 0
    v_mov_b32 v128, 0
    v_mov_b32 v129, 0
    v_mov_b32 v130, 0
    v_mov_b32 v131, 0
    v_mov_b32 v132, 0
    v_mov_b32 v133, 0
    v_mov_b32 v134, 0
    v_mov_b32 v135, 0
    v_mov_b32 v136, 0
    v_mov_b32 v137, 0
    v_mov_b32 v138, 0
    v_mov_b32 v139, 0
    v_mov_b32 v140, 0
    v_mov_b32 v141, 0
    v_mov_b32 v142, 0
    v_mov_b32 v143, 0
    v_mov_b32 v144, 0
    v_mov_b32 v145, 0
    v_mov_b32 v146, 0
    v_mov_b32 v147, 0
    v_mov_b32 v148, 0
    v_mov_b32 v149, 0
    v_mov_b32 v150, 0
    v_mov_b32 v151, 0
    v_mov_b32 v152, 0
    v_mov_b32 v153, 0
    v_mov_b32 v154, 0
    v_mov_b32 v155, 0
    v_mov_b32 v156, 0
    v_mov_b32 v157, 0
    v_mov_b32 v158, 0
    v_mov_b32 v159, 0
    v_mov_b32 v160, 0
    v_mov_b32 v161, 0
    v_mov_b32 v162, 0
    v_mov_b32 v163, 0
    v_mov_b32 v164, 0
    v_mov_b32 v165, 0
    v_mov_b32 v166, 0
    v_mov_b32 v167, 0
    v_mov_b32 v168, 0
    v_mov_b32 v169, 0
    v_mov_b32 v170, 0
    v_mov_b32 v171, 0
    v_mov_b32 v172, 0
    v_mov_b32 v173, 0
    v_mov_b32 v174, 0
    v_mov_b32 v175, 0
    v_mov_b32 v176, 0
    v_mov_b32 v177, 0
    v_mov_b32 v178, 0
    v_mov_b32 v179, 0
    v_mov_b32 v180, 0
    v_mov_b32 v181, 0
    v_mov_b32 v182, 0
    v_mov_b32 v183, 0
    v_mov_b32 v184, 0
    v_mov_b32 v185, 0
    v_mov_b32 v186, 0
    v_mov_b32 v187, 0
    v_mov_b32 v188, 0
    v_mov_b32 v189, 0
    v_mov_b32 v190, 0
    v_mov_b32 v191, 0
    v_mov_b32 v192, 0
    v_mov_b32 v193, 0
    v_mov_b32 v194, 0
    v_mov_b32 v195, 0
    v_mov_b32 v196, 0
    v_mov_b32 v197, 0
    v_mov_b32 v198, 0
    v_mov_b32 v199, 0
    v_mov_b32 v200, 0
    v_mov_b32 v201, 0
    v_mov_b32 v202, 0
    v_mov_b32 v203, 0
    v_mov_b32 v204, 0
    v_mov_b32 v205, 0
    v_mov_b32 v206, 0
    v_mov_b32 v207, 0
    v_mov_b32 v208, 0
    v_mov_b32 v209, 0
    v_mov_b32 v210, 0
    v_mov_b32 v211, 0
    v_mov_b32 v212, 0
    v_mov_b32 v213, 0
    v_mov_b32 v214, 0
    v_mov_b32 v215, 0
    v_mov_b32 v216, 0
    v_mov_b32 v217, 0
    v_mov_b32 v218, 0
    v_mov_b32 v219, 0
    v_mov_b32 v220, 0
    v_mov_b32 v221, 0
    v_mov_b32 v222, 0
    v_mov_b32 v223, 0
    v_mov_b32 v224, 0
    v_mov_b32 v225, 0
    v_mov_b32 v226, 0
    v_mov_b32 v227, 0
    v_mov_b32 v228, 0
    v_mov_b32 v229, 0
    v_mov_b32 v230, 0
    v_mov_b32 v231, 0
    v_mov_b32 v232, 0
    v_mov_b32 v233, 0
    v_mov_b32 v234, 0
    v_mov_b32 v235, 0
    v_mov_b32 v236, 0
    v_mov_b32 v237, 0
    v_mov_b32 v238, 0
    v_mov_b32 v239, 0
    v_mov_b32 v240, 0
    v_mov_b32 v241, 0
    v_mov_b32 v242, 0
    v_mov_b32 v243, 0
    s_cmp_eq_u32 s26, 0
    s_cbranch_scc0 L_kv_v
    s_waitcnt vmcnt(12)
    s_barrier
    ds_read_b64_tr_b16 v[52:53], v17 offset:16384
    ds_read_b64_tr_b16 v[54:55], v17 offset:16896
    ds_read_b128 v[20:23], v14 offset:0
    ds_read_b128 v[24:27], v14 offset:1024
    ds_read_b128 v[28:31], v14 offset:2048
    ds_read_b128 v[32:35], v14 offset:3072
    ds_read_b64_tr_b16 v[56:57], v17 offset:16416
    ds_read_b64_tr_b16 v[58:59], v17 offset:16928
    ds_read_b64_tr_b16 v[60:61], v17 offset:16448
    ds_read_b64_tr_b16 v[62:63], v17 offset:16960
    ds_read_b64_tr_b16 v[64:65], v17 offset:16480
    ds_read_b64_tr_b16 v[66:67], v17 offset:16992
    ds_read_b64_tr_b16 v[68:69], v17 offset:16512
    ds_read_b64_tr_b16 v[70:71], v17 offset:17024
    ds_read_b64_tr_b16 v[72:73], v17 offset:16544
    ds_read_b64_tr_b16 v[74:75], v17 offset:17056
    ds_read_b64_tr_b16 v[76:77], v17 offset:16576
    ds_read_b64_tr_b16 v[78:79], v17 offset:17088
    ds_read_b64_tr_b16 v[80:81], v17 offset:16608
    ds_read_b64_tr_b16 v[82:83], v17 offset:17120
    s_mov_b32 s31, 3
L_kvk_loop_1:
    s_waitcnt lgkmcnt(0)
    s_waitcnt vmcnt(8)
    s_barrier
    v_mfma_f32_16x16x32_bf16 v[116:119], v[52:55], v[20:23], v[116:119]
    ds_read_b64_tr_b16 v[84:85], v17 offset:49664
    v_mfma_f32_16x16x32_bf16 v[120:123], v[52:55], v[24:27], v[120:123]
    ds_read_b64_tr_b16 v[86:87], v17 offset:50176
    v_mfma_f32_16x16x32_bf16 v[124:127], v[52:55], v[28:31], v[124:127]
    ds_read_b128 v[36:39], v14 offset:33280
    v_mfma_f32_16x16x32_bf16 v[128:131], v[52:55], v[32:35], v[128:131]
    ds_read_b128 v[40:43], v14 offset:34304
    v_mfma_f32_16x16x32_bf16 v[132:135], v[56:59], v[20:23], v[132:135]
    v_mfma_f32_16x16x32_bf16 v[136:139], v[56:59], v[24:27], v[136:139]
    s_add_u32 m0, s29, 0x0
    s_nop 0
    buffer_load_dwordx4 v10, s[4:7], s27 offen lds
    v_mfma_f32_16x16x32_bf16 v[140:143], v[56:59], v[28:31], v[140:143]
    ds_read_b128 v[44:47], v14 offset:35328
    v_mfma_f32_16x16x32_bf16 v[144:147], v[56:59], v[32:35], v[144:147]
    ds_read_b128 v[48:51], v14 offset:36352
    v_mfma_f32_16x16x32_bf16 v[148:151], v[60:63], v[20:23], v[148:151]
    ds_read_b64_tr_b16 v[88:89], v17 offset:49696
    v_mfma_f32_16x16x32_bf16 v[152:155], v[60:63], v[24:27], v[152:155]
    v_mfma_f32_16x16x32_bf16 v[156:159], v[60:63], v[28:31], v[156:159]
    ds_read_b64_tr_b16 v[90:91], v17 offset:50208
    v_mfma_f32_16x16x32_bf16 v[160:163], v[60:63], v[32:35], v[160:163]
    s_add_u32 m0, s29, 0x400
    s_nop 0
    buffer_load_dwordx4 v11, s[4:7], s27 offen lds
    v_mfma_f32_16x16x32_bf16 v[164:167], v[64:67], v[20:23], v[164:167]
    ds_read_b64_tr_b16 v[92:93], v17 offset:49728
    v_mfma_f32_16x16x32_bf16 v[168:171], v[64:67], v[24:27], v[168:171]
    v_mfma_f32_16x16x32_bf16 v[172:175], v[64:67], v[28:31], v[172:175]
    ds_read_b64_tr_b16 v[94:95], v17 offset:50240
    v_mfma_f32_16x16x32_bf16 v[176:179], v[64:67], v[32:35], v[176:179]
    ds_read_b64_tr_b16 v[96:97], v17 offset:49760
    v_mfma_f32_16x16x32_bf16 v[180:183], v[68:71], v[20:23], v[180:183]
    ds_read_b64_tr_b16 v[98:99], v17 offset:50272
    v_mfma_f32_16x16x32_bf16 v[184:187], v[68:71], v[24:27], v[184:187]
    s_add_u32 m0, s30, 0x4000
    s_nop 0
    buffer_load_dwordx4 v12, s[8:11], s28 offen lds
    v_mfma_f32_16x16x32_bf16 v[188:191], v[68:71], v[28:31], v[188:191]
    v_mfma_f32_16x16x32_bf16 v[192:195], v[68:71], v[32:35], v[192:195]
    ds_read_b64_tr_b16 v[100:101], v17 offset:49792
    v_mfma_f32_16x16x32_bf16 v[196:199], v[72:75], v[20:23], v[196:199]
    ds_read_b64_tr_b16 v[102:103], v17 offset:50304
    v_mfma_f32_16x16x32_bf16 v[200:203], v[72:75], v[24:27], v[200:203]
    ds_read_b64_tr_b16 v[104:105], v17 offset:49824
    v_mfma_f32_16x16x32_bf16 v[204:207], v[72:75], v[28:31], v[204:207]
    v_mfma_f32_16x16x32_bf16 v[208:211], v[72:75], v[32:35], v[208:211]
    ds_read_b64_tr_b16 v[106:107], v17 offset:50336
    v_mfma_f32_16x16x32_bf16 v[212:215], v[76:79], v[20:23], v[212:215]
    s_add_u32 m0, s30, 0x4420
    s_nop 0
    buffer_load_dwordx4 v13, s[8:11], s28 offen lds
    v_mfma_f32_16x16x32_bf16 v[216:219], v[76:79], v[24:27], v[216:219]
    ds_read_b64_tr_b16 v[108:109], v17 offset:49856
    v_mfma_f32_16x16x32_bf16 v[220:223], v[76:79], v[28:31], v[220:223]
    ds_read_b64_tr_b16 v[110:111], v17 offset:50368
    v_mfma_f32_16x16x32_bf16 v[224:227], v[76:79], v[32:35], v[224:227]
    v_mfma_f32_16x16x32_bf16 v[228:231], v[80:83], v[20:23], v[228:231]
    ds_read_b64_tr_b16 v[112:113], v17 offset:49888
    v_mfma_f32_16x16x32_bf16 v[232:235], v[80:83], v[24:27], v[232:235]
    ds_read_b64_tr_b16 v[114:115], v17 offset:50400
    v_mfma_f32_16x16x32_bf16 v[236:239], v[80:83], v[28:31], v[236:239]
    s_add_u32 s27, s27, 64
    s_add_u32 s28, s28, 0x40000
    s_add_u32 s54, s54, 1
    s_cmp_eq_u32 s54, 16
    s_cselect_b32 s34, 0x400, 0
    s_cselect_b32 s35, 0x400000, 0
    s_cselect_b32 s54, 0, s54
    s_sub_u32 s27, s27, s34
    s_sub_u32 s28, s28, s35
    v_mfma_f32_16x16x32_bf16 v[240:243], v[80:83], v[32:35], v[240:243]
    s_waitcnt lgkmcnt(0)
    s_waitcnt vmcnt(8)
    s_barrier
    v_mfma_f32_16x16x32_bf16 v[116:119], v[84:87], v[36:39], v[116:119]
    ds_read_b64_tr_b16 v[52:53], v18 offset:17408
    v_mfma_f32_16x16x32_bf16 v[120:123], v[84:87], v[40:43], v[120:123]
    ds_read_b64_tr_b16 v[54:55], v18 offset:17920
    v_mfma_f32_16x16x32_bf16 v[124:127], v[84:87], v[44:47], v[124:127]
    ds_read_b128 v[20:23], v15 offset:1024
    v_mfma_f32_16x16x32_bf16 v[128:131], v[84:87], v[48:51], v[128:131]
    ds_read_b128 v[24:27], v15 offset:2048
    v_mfma_f32_16x16x32_bf16 v[132:135], v[88:91], v[36:39], v[132:135]
    v_mfma_f32_16x16x32_bf16 v[136:139], v[88:91], v[40:43], v[136:139]
    s_add_u32 m0, s29, 0x8200
    s_nop 0
    buffer_load_dwordx4 v10, s[4:7], s27 offen lds
    v_mfma_f32_16x16x32_bf16 v[140:143], v[88:91], v[44:47], v[140:143]
    ds_read_b128 v[28:31], v15 offset:3072
    v_mfma_f32_16x16x32_bf16 v[144:147], v[88:91], v[48:51], v[144:147]
    ds_read_b128 v[32:35], v15 offset:4096
    v_mfma_f32_16x16x32_bf16 v[148:151], v[92:95], v[36:39], v[148:151]
    ds_read_b64_tr_b16 v[56:57], v18 offset:17440
    v_mfma_f32_16x16x32_bf16 v[152:155], v[92:95], v[40:43], v[152:155]
    v_mfma_f32_16x16x32_bf16 v[156:159], v[92:95], v[44:47], v[156:159]
    ds_read_b64_tr_b16 v[58:59], v18 offset:17952
    v_mfma_f32_16x16x32_bf16 v[160:163], v[92:95], v[48:51], v[160:163]
    s_add_u32 m0, s29, 0x8600
    s_nop 0
    buffer_load_dwordx4 v11, s[4:7], s27 offen lds
    v_mfma_f32_16x16x32_bf16 v[164:167], v[96:99], v[36:39], v[164:167]
    ds_read_b64_tr_b16 v[60:61], v18 offset:17472
    v_mfma_f32_16x16x32_bf16 v[168:171], v[96:99], v[40:43], v[168:171]
    v_mfma_f32_16x16x32_bf16 v[172:175], v[96:99], v[44:47], v[172:175]
    ds_read_b64_tr_b16 v[62:63], v18 offset:17984
    v_mfma_f32_16x16x32_bf16 v[176:179], v[96:99], v[48:51], v[176:179]
    ds_read_b64_tr_b16 v[64:65], v18 offset:17504
    v_mfma_f32_16x16x32_bf16 v[180:183], v[100:103], v[36:39], v[180:183]
    ds_read_b64_tr_b16 v[66:67], v18 offset:18016
    v_mfma_f32_16x16x32_bf16 v[184:187], v[100:103], v[40:43], v[184:187]
    s_add_u32 m0, s30, 0xc200
    s_nop 0
    buffer_load_dwordx4 v12, s[8:11], s28 offen lds
    v_mfma_f32_16x16x32_bf16 v[188:191], v[100:103], v[44:47], v[188:191]
    v_mfma_f32_16x16x32_bf16 v[192:195], v[100:103], v[48:51], v[192:195]
    ds_read_b64_tr_b16 v[68:69], v18 offset:17536
    v_mfma_f32_16x16x32_bf16 v[196:199], v[104:107], v[36:39], v[196:199]
    ds_read_b64_tr_b16 v[70:71], v18 offset:18048
    v_mfma_f32_16x16x32_bf16 v[200:203], v[104:107], v[40:43], v[200:203]
    ds_read_b64_tr_b16 v[72:73], v18 offset:17568
    v_mfma_f32_16x16x32_bf16 v[204:207], v[104:107], v[44:47], v[204:207]
    v_mfma_f32_16x16x32_bf16 v[208:211], v[104:107], v[48:51], v[208:211]
    ds_read_b64_tr_b16 v[74:75], v18 offset:18080
    v_mfma_f32_16x16x32_bf16 v[212:215], v[108:111], v[36:39], v[212:215]
    s_add_u32 m0, s30, 0xc620
    s_nop 0
    buffer_load_dwordx4 v13, s[8:11], s28 offen lds
    v_mfma_f32_16x16x32_bf16 v[216:219], v[108:111], v[40:43], v[216:219]
    ds_read_b64_tr_b16 v[76:77], v18 offset:17600
    v_mfma_f32_16x16x32_bf16 v[220:223], v[108:111], v[44:47], v[220:223]
    ds_read_b64_tr_b16 v[78:79], v18 offset:18112
    v_mfma_f32_16x16x32_bf16 v[224:227], v[108:111], v[48:51], v[224:227]
    v_mfma_f32_16x16x32_bf16 v[228:231], v[112:115], v[36:39], v[228:231]
    ds_read_b64_tr_b16 v[80:81], v18 offset:17632
    v_mfma_f32_16x16x32_bf16 v[232:235], v[112:115], v[40:43], v[232:235]
    ds_read_b64_tr_b16 v[82:83], v18 offset:18144
    v_mfma_f32_16x16x32_bf16 v[236:239], v[112:115], v[44:47], v[236:239]
    s_add_u32 s27, s27, 64
    s_add_u32 s28, s28, 0x40000
    s_add_u32 s54, s54, 1
    s_cmp_eq_u32 s54, 16
    s_cselect_b32 s34, 0x400, 0
    s_cselect_b32 s35, 0x400000, 0
    s_cselect_b32 s54, 0, s54
    s_sub_u32 s27, s27, s34
    s_sub_u32 s28, s28, s35
    v_mfma_f32_16x16x32_bf16 v[240:243], v[112:115], v[48:51], v[240:243]
    s_waitcnt lgkmcnt(0)
    s_waitcnt vmcnt(8)
    s_barrier
    v_mfma_f32_16x16x32_bf16 v[116:119], v[52:55], v[20:23], v[116:119]
    ds_read_b64_tr_b16 v[84:85], v18 offset:50688
    v_mfma_f32_16x16x32_bf16 v[120:123], v[52:55], v[24:27], v[120:123]
    ds_read_b64_tr_b16 v[86:87], v18 offset:51200
    v_mfma_f32_16x16x32_bf16 v[124:127], v[52:55], v[28:31], v[124:127]
    ds_read_b128 v[36:39], v15 offset:34304
    v_mfma_f32_16x16x32_bf16 v[128:131], v[52:55], v[32:35], v[128:131]
    ds_read_b128 v[40:43], v15 offset:35328
    v_mfma_f32_16x16x32_bf16 v[132:135], v[56:59], v[20:23], v[132:135]
    v_mfma_f32_16x16x32_bf16 v[136:139], v[56:59], v[24:27], v[136:139]
    s_add_u32 m0, s29, 0x10400
    s_nop 0
    buffer_load_dwordx4 v10, s[4:7], s27 offen lds
    v_mfma_f32_16x16x32_bf16 v[140:143], v[56:59], v[28:31], v[140:143]
    ds_read_b128 v[44:47], v15 offset:36352
    v_mfma_f32_16x16x32_bf16 v[144:147], v[56:59], v[32:35], v[144:147]
    ds_read_b128 v[48:51], v15 offset:37376
    v_mfma_f32_16x16x32_bf16 v[148:151], v[60:63], v[20:23], v[148:151]
    ds_read_b64_tr_b16 v[88:89], v18 offset:50720
    v_mfma_f32_16x16x32_bf16 v[152:155], v[60:63], v[24:27], v[152:155]
    v_mfma_f32_16x16x32_bf16 v[156:159], v[60:63], v[28:31], v[156:159]
    ds_read_b64_tr_b16 v[90:91], v18 offset:51232
    v_mfma_f32_16x16x32_bf16 v[160:163], v[60:63], v[32:35], v[160:163]
    s_add_u32 m0, s29, 0x10800
    s_nop 0
    buffer_load_dwordx4 v11, s[4:7], s27 offen lds
    v_mfma_f32_16x16x32_bf16 v[164:167], v[64:67], v[20:23], v[164:167]
    ds_read_b64_tr_b16 v[92:93], v18 offset:50752
    v_mfma_f32_16x16x32_bf16 v[168:171], v[64:67], v[24:27], v[168:171]
    v_mfma_f32_16x16x32_bf16 v[172:175], v[64:67], v[28:31], v[172:175]
    ds_read_b64_tr_b16 v[94:95], v18 offset:51264
    v_mfma_f32_16x16x32_bf16 v[176:179], v[64:67], v[32:35], v[176:179]
    ds_read_b64_tr_b16 v[96:97], v18 offset:50784
    v_mfma_f32_16x16x32_bf16 v[180:183], v[68:71], v[20:23], v[180:183]
    ds_read_b64_tr_b16 v[98:99], v18 offset:51296
    v_mfma_f32_16x16x32_bf16 v[184:187], v[68:71], v[24:27], v[184:187]
    s_add_u32 m0, s30, 0x14400
    s_nop 0
    buffer_load_dwordx4 v12, s[8:11], s28 offen lds
    v_mfma_f32_16x16x32_bf16 v[188:191], v[68:71], v[28:31], v[188:191]
    v_mfma_f32_16x16x32_bf16 v[192:195], v[68:71], v[32:35], v[192:195]
    ds_read_b64_tr_b16 v[100:101], v18 offset:50816
    v_mfma_f32_16x16x32_bf16 v[196:199], v[72:75], v[20:23], v[196:199]
    ds_read_b64_tr_b16 v[102:103], v18 offset:51328
    v_mfma_f32_16x16x32_bf16 v[200:203], v[72:75], v[24:27], v[200:203]
    ds_read_b64_tr_b16 v[104:105], v18 offset:50848
    v_mfma_f32_16x16x32_bf16 v[204:207], v[72:75], v[28:31], v[204:207]
    v_mfma_f32_16x16x32_bf16 v[208:211], v[72:75], v[32:35], v[208:211]
    ds_read_b64_tr_b16 v[106:107], v18 offset:51360
    v_mfma_f32_16x16x32_bf16 v[212:215], v[76:79], v[20:23], v[212:215]
    s_add_u32 m0, s30, 0x14820
    s_nop 0
    buffer_load_dwordx4 v13, s[8:11], s28 offen lds
    v_mfma_f32_16x16x32_bf16 v[216:219], v[76:79], v[24:27], v[216:219]
    ds_read_b64_tr_b16 v[108:109], v18 offset:50880
    v_mfma_f32_16x16x32_bf16 v[220:223], v[76:79], v[28:31], v[220:223]
    ds_read_b64_tr_b16 v[110:111], v18 offset:51392
    v_mfma_f32_16x16x32_bf16 v[224:227], v[76:79], v[32:35], v[224:227]
    v_mfma_f32_16x16x32_bf16 v[228:231], v[80:83], v[20:23], v[228:231]
    ds_read_b64_tr_b16 v[112:113], v18 offset:50912
    v_mfma_f32_16x16x32_bf16 v[232:235], v[80:83], v[24:27], v[232:235]
    ds_read_b64_tr_b16 v[114:115], v18 offset:51424
    v_mfma_f32_16x16x32_bf16 v[236:239], v[80:83], v[28:31], v[236:239]
    s_add_u32 s27, s27, 64
    s_add_u32 s28, s28, 0x40000
    s_add_u32 s54, s54, 1
    s_cmp_eq_u32 s54, 16
    s_cselect_b32 s34, 0x400, 0
    s_cselect_b32 s35, 0x400000, 0
    s_cselect_b32 s54, 0, s54
    s_sub_u32 s27, s27, s34
    s_sub_u32 s28, s28, s35
    v_mfma_f32_16x16x32_bf16 v[240:243], v[80:83], v[32:35], v[240:243]
    s_waitcnt lgkmcnt(0)
    s_waitcnt vmcnt(8)
    s_barrier
    v_mfma_f32_16x16x32_bf16 v[116:119], v[84:87], v[36:39], v[116:119]
    ds_read_b64_tr_b16 v[52:53], v17 offset:16384
    v_mfma_f32_16x16x32_bf16 v[120:123], v[84:87], v[40:43], v[120:123]
    ds_read_b64_tr_b16 v[54:55], v17 offset:16896
    v_mfma_f32_16x16x32_bf16 v[124:127], v[84:87], v[44:47], v[124:127]
    ds_read_b128 v[20:23], v14 offset:0
    v_mfma_f32_16x16x32_bf16 v[128:131], v[84:87], v[48:51], v[128:131]
    ds_read_b128 v[24:27], v14 offset:1024
    v_mfma_f32_16x16x32_bf16 v[132:135], v[88:91], v[36:39], v[132:135]
    v_mfma_f32_16x16x32_bf16 v[136:139], v[88:91], v[40:43], v[136:139]
    s_add_u32 m0, s29, 0x18600
    s_nop 0
    buffer_load_dwordx4 v10, s[4:7], s27 offen lds
    v_mfma_f32_16x16x32_bf16 v[140:143], v[88:91], v[44:47], v[140:143]
    ds_read_b128 v[28:31], v14 offset:2048
    v_mfma_f32_16x16x32_bf16 v[144:147], v[88:91], v[48:51], v[144:147]
    ds_read_b128 v[32:35], v14 offset:3072
    v_mfma_f32_16x16x32_bf16 v[148:151], v[92:95], v[36:39], v[148:151]
    ds_read_b64_tr_b16 v[56:57], v17 offset:16416
    v_mfma_f32_16x16x32_bf16 v[152:155], v[92:95], v[40:43], v[152:155]
    v_mfma_f32_16x16x32_bf16 v[156:159], v[92:95], v[44:47], v[156:159]
    ds_read_b64_tr_b16 v[58:59], v17 offset:16928
    v_mfma_f32_16x16x32_bf16 v[160:163], v[92:95], v[48:51], v[160:163]
    s_add_u32 m0, s29, 0x18a00
    s_nop 0
    buffer_load_dwordx4 v11, s[4:7], s27 offen lds
    v_mfma_f32_16x16x32_bf16 v[164:167], v[96:99], v[36:39], v[164:167]
    ds_read_b64_tr_b16 v[60:61], v17 offset:16448
    v_mfma_f32_16x16x32_bf16 v[168:171], v[96:99], v[40:43], v[168:171]
    v_mfma_f32_16x16x32_bf16 v[172:175], v[96:99], v[44:47], v[172:175]
    ds_read_b64_tr_b16 v[62:63], v17 offset:16960
    v_mfma_f32_16x16x32_bf16 v[176:179], v[96:99], v[48:51], v[176:179]
    ds_read_b64_tr_b16 v[64:65], v17 offset:16480
    v_mfma_f32_16x16x32_bf16 v[180:183], v[100:103], v[36:39], v[180:183]
    ds_read_b64_tr_b16 v[66:67], v17 offset:16992
    v_mfma_f32_16x16x32_bf16 v[184:187], v[100:103], v[40:43], v[184:187]
    s_add_u32 m0, s30, 0x1c600
    s_nop 0
    buffer_load_dwordx4 v12, s[8:11], s28 offen lds
    v_mfma_f32_16x16x32_bf16 v[188:191], v[100:103], v[44:47], v[188:191]
    v_mfma_f32_16x16x32_bf16 v[192:195], v[100:103], v[48:51], v[192:195]
    ds_read_b64_tr_b16 v[68:69], v17 offset:16512
    v_mfma_f32_16x16x32_bf16 v[196:199], v[104:107], v[36:39], v[196:199]
    ds_read_b64_tr_b16 v[70:71], v17 offset:17024
    v_mfma_f32_16x16x32_bf16 v[200:203], v[104:107], v[40:43], v[200:203]
    ds_read_b64_tr_b16 v[72:73], v17 offset:16544
    v_mfma_f32_16x16x32_bf16 v[204:207], v[104:107], v[44:47], v[204:207]
    v_mfma_f32_16x16x32_bf16 v[208:211], v[104:107], v[48:51], v[208:211]
    ds_read_b64_tr_b16 v[74:75], v17 offset:17056
    v_mfma_f32_16x16x32_bf16 v[212:215], v[108:111], v[36:39], v[212:215]
    s_add_u32 m0, s30, 0x1ca20
    s_nop 0
    buffer_load_dwordx4 v13, s[8:11], s28 offen lds
    v_mfma_f32_16x16x32_bf16 v[216:219], v[108:111], v[40:43], v[216:219]
    ds_read_b64_tr_b16 v[76:77], v17 offset:16576
    v_mfma_f32_16x16x32_bf16 v[220:223], v[108:111], v[44:47], v[220:223]
    ds_read_b64_tr_b16 v[78:79], v17 offset:17088
    v_mfma_f32_16x16x32_bf16 v[224:227], v[108:111], v[48:51], v[224:227]
    v_mfma_f32_16x16x32_bf16 v[228:231], v[112:115], v[36:39], v[228:231]
    ds_read_b64_tr_b16 v[80:81], v17 offset:16608
    v_mfma_f32_16x16x32_bf16 v[232:235], v[112:115], v[40:43], v[232:235]
    ds_read_b64_tr_b16 v[82:83], v17 offset:17120
    v_mfma_f32_16x16x32_bf16 v[236:239], v[112:115], v[44:47], v[236:239]
    s_add_u32 s27, s27, 64
    s_add_u32 s28, s28, 0x40000
    s_add_u32 s54, s54, 1
    s_cmp_eq_u32 s54, 16
    s_cselect_b32 s34, 0x400, 0
    s_cselect_b32 s35, 0x400000, 0
    s_cselect_b32 s54, 0, s54
    s_sub_u32 s27, s27, s34
    s_sub_u32 s28, s28, s35
    v_mfma_f32_16x16x32_bf16 v[240:243], v[112:115], v[48:51], v[240:243]
    s_sub_u32 s31, s31, 1
    s_cmp_lg_u32 s31, 0
    s_cbranch_scc1 L_kvk_loop_1
    s_waitcnt lgkmcnt(0)
    s_waitcnt vmcnt(8)
    s_barrier
    v_mfma_f32_16x16x32_bf16 v[116:119], v[52:55], v[20:23], v[116:119]
    ds_read_b64_tr_b16 v[84:85], v17 offset:49664
    v_mfma_f32_16x16x32_bf16 v[120:123], v[52:55], v[24:27], v[120:123]
    ds_read_b64_tr_b16 v[86:87], v17 offset:50176
    v_mfma_f32_16x16x32_bf16 v[124:127], v[52:55], v[28:31], v[124:127]
    v_mfma_f32_16x16x32_bf16 v[128:131], v[52:55], v[32:35], v[128:131]
    ds_read_b128 v[36:39], v14 offset:33280
    v_mfma_f32_16x16x32_bf16 v[132:135], v[56:59], v[20:23], v[132:135]
    ds_read_b128 v[40:43], v14 offset:34304
    v_mfma_f32_16x16x32_bf16 v[136:139], v[56:59], v[24:27], v[136:139]
    v_mfma_f32_16x16x32_bf16 v[140:143], v[56:59], v[28:31], v[140:143]
    ds_read_b128 v[44:47], v14 offset:35328
    v_mfma_f32_16x16x32_bf16 v[144:147], v[56:59], v[32:35], v[144:147]
    v_mfma_f32_16x16x32_bf16 v[148:151], v[60:63], v[20:23], v[148:151]
    ds_read_b128 v[48:51], v14 offset:36352
    v_mfma_f32_16x16x32_bf16 v[152:155], v[60:63], v[24:27], v[152:155]
    ds_read_b64_tr_b16 v[88:89], v17 offset:49696
    v_mfma_f32_16x16x32_bf16 v[156:159], v[60:63], v[28:31], v[156:159]
    v_mfma_f32_16x16x32_bf16 v[160:163], v[60:63], v[32:35], v[160:163]
    ds_read_b64_tr_b16 v[90:91], v17 offset:50208
    v_mfma_f32_16x16x32_bf16 v[164:167], v[64:67], v[20:23], v[164:167]
    ds_read_b64_tr_b16 v[92:93], v17 offset:49728
    v_mfma_f32_16x16x32_bf16 v[168:171], v[64:67], v[24:27], v[168:171]
    v_mfma_f32_16x16x32_bf16 v[172:175], v[64:67], v[28:31], v[172:175]
    ds_read_b64_tr_b16 v[94:95], v17 offset:50240
    v_mfma_f32_16x16x32_bf16 v[176:179], v[64:67], v[32:35], v[176:179]
    v_mfma_f32_16x16x32_bf16 v[180:183], v[68:71], v[20:23], v[180:183]
    ds_read_b64_tr_b16 v[96:97], v17 offset:49760
    v_mfma_f32_16x16x32_bf16 v[184:187], v[68:71], v[24:27], v[184:187]
    ds_read_b64_tr_b16 v[98:99], v17 offset:50272
    v_mfma_f32_16x16x32_bf16 v[188:191], v[68:71], v[28:31], v[188:191]
    v_mfma_f32_16x16x32_bf16 v[192:195], v[68:71], v[32:35], v[192:195]
    ds_read_b64_tr_b16 v[100:101], v17 offset:49792
    v_mfma_f32_16x16x32_bf16 v[196:199], v[72:75], v[20:23], v[196:199]
    ds_read_b64_tr_b16 v[102:103], v17 offset:50304
    v_mfma_f32_16x16x32_bf16 v[200:203], v[72:75], v[24:27], v[200:203]
    v_mfma_f32_16x16x32_bf16 v[204:207], v[72:75], v[28:31], v[204:207]
    ds_read_b64_tr_b16 v[104:105], v17 offset:49824
    v_mfma_f32_16x16x32_bf16 v[208:211], v[72:75], v[32:35], v[208:211]
    v_mfma_f32_16x16x32_bf16 v[212:215], v[76:79], v[20:23], v[212:215]
    ds_read_b64_tr_b16 v[106:107], v17 offset:50336
    v_mfma_f32_16x16x32_bf16 v[216:219], v[76:79], v[24:27], v[216:219]
    ds_read_b64_tr_b16 v[108:109], v17 offset:49856
    v_mfma_f32_16x16x32_bf16 v[220:223], v[76:79], v[28:31], v[220:223]
    v_mfma_f32_16x16x32_bf16 v[224:227], v[76:79], v[32:35], v[224:227]
    ds_read_b64_tr_b16 v[110:111], v17 offset:50368
    v_mfma_f32_16x16x32_bf16 v[228:231], v[80:83], v[20:23], v[228:231]
    ds_read_b64_tr_b16 v[112:113], v17 offset:49888
    v_mfma_f32_16x16x32_bf16 v[232:235], v[80:83], v[24:27], v[232:235]
    v_mfma_f32_16x16x32_bf16 v[236:239], v[80:83], v[28:31], v[236:239]
    ds_read_b64_tr_b16 v[114:115], v17 offset:50400
    v_mfma_f32_16x16x32_bf16 v[240:243], v[80:83], v[32:35], v[240:243]
    s_waitcnt lgkmcnt(0)
    s_waitcnt vmcnt(4)
    s_barrier
    v_mfma_f32_16x16x32_bf16 v[116:119], v[84:87], v[36:39], v[116:119]
    ds_read_b64_tr_b16 v[52:53], v18 offset:17408
    v_mfma_f32_16x16x32_bf16 v[120:123], v[84:87], v[40:43], v[120:123]
    ds_read_b64_tr_b16 v[54:55], v18 offset:17920
    v_mfma_f32_16x16x32_bf16 v[124:127], v[84:87], v[44:47], v[124:127]
    v_mfma_f32_16x16x32_bf16 v[128:131], v[84:87], v[48:51], v[128:131]
    ds_read_b128 v[20:23], v15 offset:1024
    v_mfma_f32_16x16x32_bf16 v[132:135], v[88:91], v[36:39], v[132:135]
    ds_read_b128 v[24:27], v15 offset:2048
    v_mfma_f32_16x16x32_bf16 v[136:139], v[88:91], v[40:43], v[136:139]
    v_mfma_f32_16x16x32_bf16 v[140:143], v[88:91], v[44:47], v[140:143]
    ds_read_b128 v[28:31], v15 offset:3072
    v_mfma_f32_16x16x32_bf16 v[144:147], v[88:91], v[48:51], v[144:147]
    v_mfma_f32_16x16x32_bf16 v[148:151], v[92:95], v[36:39], v[148:151]
    ds_read_b128 v[32:35], v15 offset:4096
    v_mfma_f32_16x16x32_bf16 v[152:155], v[92:95], v[40:43], v[152:155]
    ds_read_b64_tr_b16 v[56:57], v18 offset:17440
    v_mfma_f32_16x16x32_bf16 v[156:159], v[92:95], v[44:47], v[156:159]
    v_mfma_f32_16x16x32_bf16 v[160:163], v[92:95], v[48:51], v[160:163]
    ds_read_b64_tr_b16 v[58:59], v18 offset:17952
    v_mfma_f32_16x16x32_bf16 v[164:167], v[96:99], v[36:39], v[164:167]
    ds_read_b64_tr_b16 v[60:61], v18 offset:17472
    v_mfma_f32_16x16x32_bf16 v[168:171], v[96:99], v[40:43], v[168:171]
    v_mfma_f32_16x16x32_bf16 v[172:175], v[96:99], v[44:47], v[172:175]
    ds_read_b64_tr_b16 v[62:63], v18 offset:17984
    v_mfma_f32_16x16x32_bf16 v[176:179], v[96:99], v[48:51], v[176:179]
    v_mfma_f32_16x16x32_bf16 v[180:183], v[100:103], v[36:39], v[180:183]
    ds_read_b64_tr_b16 v[64:65], v18 offset:17504
    v_mfma_f32_16x16x32_bf16 v[184:187], v[100:103], v[40:43], v[184:187]
    ds_read_b64_tr_b16 v[66:67], v18 offset:18016
    v_mfma_f32_16x16x32_bf16 v[188:191], v[100:103], v[44:47], v[188:191]
    v_mfma_f32_16x16x32_bf16 v[192:195], v[100:103], v[48:51], v[192:195]
    ds_read_b64_tr_b16 v[68:69], v18 offset:17536
    v_mfma_f32_16x16x32_bf16 v[196:199], v[104:107], v[36:39], v[196:199]
    ds_read_b64_tr_b16 v[70:71], v18 offset:18048
    v_mfma_f32_16x16x32_bf16 v[200:203], v[104:107], v[40:43], v[200:203]
    v_mfma_f32_16x16x32_bf16 v[204:207], v[104:107], v[44:47], v[204:207]
    ds_read_b64_tr_b16 v[72:73], v18 offset:17568
    v_mfma_f32_16x16x32_bf16 v[208:211], v[104:107], v[48:51], v[208:211]
    v_mfma_f32_16x16x32_bf16 v[212:215], v[108:111], v[36:39], v[212:215]
    ds_read_b64_tr_b16 v[74:75], v18 offset:18080
    v_mfma_f32_16x16x32_bf16 v[216:219], v[108:111], v[40:43], v[216:219]
    ds_read_b64_tr_b16 v[76:77], v18 offset:17600
    v_mfma_f32_16x16x32_bf16 v[220:223], v[108:111], v[44:47], v[220:223]
    v_mfma_f32_16x16x32_bf16 v[224:227], v[108:111], v[48:51], v[224:227]
    ds_read_b64_tr_b16 v[78:79], v18 offset:18112
    v_mfma_f32_16x16x32_bf16 v[228:231], v[112:115], v[36:39], v[228:231]
    ds_read_b64_tr_b16 v[80:81], v18 offset:17632
    v_mfma_f32_16x16x32_bf16 v[232:235], v[112:115], v[40:43], v[232:235]
    v_mfma_f32_16x16x32_bf16 v[236:239], v[112:115], v[44:47], v[236:239]
    ds_read_b64_tr_b16 v[82:83], v18 offset:18144
    v_mfma_f32_16x16x32_bf16 v[240:243], v[112:115], v[48:51], v[240:243]
    s_waitcnt lgkmcnt(0)
    s_waitcnt vmcnt(0)
    s_barrier
    v_mfma_f32_16x16x32_bf16 v[116:119], v[52:55], v[20:23], v[116:119]
    ds_read_b64_tr_b16 v[84:85], v18 offset:50688
    v_mfma_f32_16x16x32_bf16 v[120:123], v[52:55], v[24:27], v[120:123]
    ds_read_b64_tr_b16 v[86:87], v18 offset:51200
    v_mfma_f32_16x16x32_bf16 v[124:127], v[52:55], v[28:31], v[124:127]
    v_mfma_f32_16x16x32_bf16 v[128:131], v[52:55], v[32:35], v[128:131]
    ds_read_b128 v[36:39], v15 offset:34304
    v_mfma_f32_16x16x32_bf16 v[132:135], v[56:59], v[20:23], v[132:135]
    ds_read_b128 v[40:43], v15 offset:35328
    v_mfma_f32_16x16x32_bf16 v[136:139], v[56:59], v[24:27], v[136:139]
    v_mfma_f32_16x16x32_bf16 v[140:143], v[56:59], v[28:31], v[140:143]
    ds_read_b128 v[44:47], v15 offset:36352
    v_mfma_f32_16x16x32_bf16 v[144:147], v[56:59], v[32:35], v[144:147]
    v_mfma_f32_16x16x32_bf16 v[148:151], v[60:63], v[20:23], v[148:151]
    ds_read_b128 v[48:51], v15 offset:37376
    v_mfma_f32_16x16x32_bf16 v[152:155], v[60:63], v[24:27], v[152:155]
    ds_read_b64_tr_b16 v[88:89], v18 offset:50720
    v_mfma_f32_16x16x32_bf16 v[156:159], v[60:63], v[28:31], v[156:159]
    v_mfma_f32_16x16x32_bf16 v[160:163], v[60:63], v[32:35], v[160:163]
    ds_read_b64_tr_b16 v[90:91], v18 offset:51232
    v_mfma_f32_16x16x32_bf16 v[164:167], v[64:67], v[20:23], v[164:167]
    ds_read_b64_tr_b16 v[92:93], v18 offset:50752
    v_mfma_f32_16x16x32_bf16 v[168:171], v[64:67], v[24:27], v[168:171]
    v_mfma_f32_16x16x32_bf16 v[172:175], v[64:67], v[28:31], v[172:175]
    ds_read_b64_tr_b16 v[94:95], v18 offset:51264
    v_mfma_f32_16x16x32_bf16 v[176:179], v[64:67], v[32:35], v[176:179]
    v_mfma_f32_16x16x32_bf16 v[180:183], v[68:71], v[20:23], v[180:183]
    ds_read_b64_tr_b16 v[96:97], v18 offset:50784
    v_mfma_f32_16x16x32_bf16 v[184:187], v[68:71], v[24:27], v[184:187]
    ds_read_b64_tr_b16 v[98:99], v18 offset:51296
    v_mfma_f32_16x16x32_bf16 v[188:191], v[68:71], v[28:31], v[188:191]
    v_mfma_f32_16x16x32_bf16 v[192:195], v[68:71], v[32:35], v[192:195]
    ds_read_b64_tr_b16 v[100:101], v18 offset:50816
    v_mfma_f32_16x16x32_bf16 v[196:199], v[72:75], v[20:23], v[196:199]
    ds_read_b64_tr_b16 v[102:103], v18 offset:51328
    v_mfma_f32_16x16x32_bf16 v[200:203], v[72:75], v[24:27], v[200:203]
    v_mfma_f32_16x16x32_bf16 v[204:207], v[72:75], v[28:31], v[204:207]
    ds_read_b64_tr_b16 v[104:105], v18 offset:50848
    v_mfma_f32_16x16x32_bf16 v[208:211], v[72:75], v[32:35], v[208:211]
    v_mfma_f32_16x16x32_bf16 v[212:215], v[76:79], v[20:23], v[212:215]
    ds_read_b64_tr_b16 v[106:107], v18 offset:51360
    v_mfma_f32_16x16x32_bf16 v[216:219], v[76:79], v[24:27], v[216:219]
    ds_read_b64_tr_b16 v[108:109], v18 offset:50880
    v_mfma_f32_16x16x32_bf16 v[220:223], v[76:79], v[28:31], v[220:223]
    v_mfma_f32_16x16x32_bf16 v[224:227], v[76:79], v[32:35], v[224:227]
    ds_read_b64_tr_b16 v[110:111], v18 offset:51392
    v_mfma_f32_16x16x32_bf16 v[228:231], v[80:83], v[20:23], v[228:231]
    ds_read_b64_tr_b16 v[112:113], v18 offset:50912
    v_mfma_f32_16x16x32_bf16 v[232:235], v[80:83], v[24:27], v[232:235]
    v_mfma_f32_16x16x32_bf16 v[236:239], v[80:83], v[28:31], v[236:239]
    ds_read_b64_tr_b16 v[114:115], v18 offset:51424
    v_mfma_f32_16x16x32_bf16 v[240:243], v[80:83], v[32:35], v[240:243]
    s_waitcnt lgkmcnt(0)
    v_mfma_f32_16x16x32_bf16 v[116:119], v[84:87], v[36:39], v[116:119]
    v_mfma_f32_16x16x32_bf16 v[120:123], v[84:87], v[40:43], v[120:123]
    v_mfma_f32_16x16x32_bf16 v[124:127], v[84:87], v[44:47], v[124:127]
    v_mfma_f32_16x16x32_bf16 v[128:131], v[84:87], v[48:51], v[128:131]
    v_mfma_f32_16x16x32_bf16 v[132:135], v[88:91], v[36:39], v[132:135]
    v_mfma_f32_16x16x32_bf16 v[136:139], v[88:91], v[40:43], v[136:139]
    v_mfma_f32_16x16x32_bf16 v[140:143], v[88:91], v[44:47], v[140:143]
    v_mfma_f32_16x16x32_bf16 v[144:147], v[88:91], v[48:51], v[144:147]
    v_mfma_f32_16x16x32_bf16 v[148:151], v[92:95], v[36:39], v[148:151]
    v_mfma_f32_16x16x32_bf16 v[152:155], v[92:95], v[40:43], v[152:155]
    v_mfma_f32_16x16x32_bf16 v[156:159], v[92:95], v[44:47], v[156:159]
    v_mfma_f32_16x16x32_bf16 v[160:163], v[92:95], v[48:51], v[160:163]
    v_mfma_f32_16x16x32_bf16 v[164:167], v[96:99], v[36:39], v[164:167]
    v_mfma_f32_16x16x32_bf16 v[168:171], v[96:99], v[40:43], v[168:171]
    v_mfma_f32_16x16x32_bf16 v[172:175], v[96:99], v[44:47], v[172:175]
    v_mfma_f32_16x16x32_bf16 v[176:179], v[96:99], v[48:51], v[176:179]
    v_mfma_f32_16x16x32_bf16 v[180:183], v[100:103], v[36:39], v[180:183]
    v_mfma_f32_16x16x32_bf16 v[184:187], v[100:103], v[40:43], v[184:187]
    v_mfma_f32_16x16x32_bf16 v[188:191], v[100:103], v[44:47], v[188:191]
    v_mfma_f32_16x16x32_bf16 v[192:195], v[100:103], v[48:51], v[192:195]
    v_mfma_f32_16x16x32_bf16 v[196:199], v[104:107], v[36:39], v[196:199]
    v_mfma_f32_16x16x32_bf16 v[200:203], v[104:107], v[40:43], v[200:203]
    v_mfma_f32_16x16x32_bf16 v[204:207], v[104:107], v[44:47], v[204:207]
    v_mfma_f32_16x16x32_bf16 v[208:211], v[104:107], v[48:51], v[208:211]
    v_mfma_f32_16x16x32_bf16 v[212:215], v[108:111], v[36:39], v[212:215]
    v_mfma_f32_16x16x32_bf16 v[216:219], v[108:111], v[40:43], v[216:219]
    v_mfma_f32_16x16x32_bf16 v[220:223], v[108:111], v[44:47], v[220:223]
    v_mfma_f32_16x16x32_bf16 v[224:227], v[108:111], v[48:51], v[224:227]
    v_mfma_f32_16x16x32_bf16 v[228:231], v[112:115], v[36:39], v[228:231]
    v_mfma_f32_16x16x32_bf16 v[232:235], v[112:115], v[40:43], v[232:235]
    v_mfma_f32_16x16x32_bf16 v[236:239], v[112:115], v[44:47], v[236:239]
    v_mfma_f32_16x16x32_bf16 v[240:243], v[112:115], v[48:51], v[240:243]
    s_nop 15
    s_lshr_b32 s32, s25, 7
    s_add_u32 s32, s32, s22
    s_lshl_b32 s32, s32, 19
    s_lshr_b32 s33, s24, 6
    s_add_u32 s33, s33, s21
    s_lshl_b32 s33, s33, 14
    s_add_u32 s32, s32, s33
    v_bfe_u32 v2, v1, 4, 1
    v_mul_u32_u24 v2, 1024, v2
    v_and_b32 v3, 15, v1
    v_lshl_add_u32 v2, v3, 4, v2
    v_lshrrev_b32 v3, 5, v1
    v_lshl_add_u32 v2, v3, 8, v2
    v_cvt_pk_bf16_f32 v20, v116, v117
    v_cvt_pk_bf16_f32 v21, v118, v119
    v_cvt_pk_bf16_f32 v22, v120, v121
    v_cvt_pk_bf16_f32 v23, v122, v123
    s_add_u32 s33, s32, 0
    s_nop 0
    v_permlane32_swap_b32 v20, v22
    v_permlane32_swap_b32 v21, v23
    buffer_store_dwordx4 v[20:23], v2, s[12:15], s33 offen offset:0 sc0 sc1
    v_cvt_pk_bf16_f32 v24, v124, v125
    v_cvt_pk_bf16_f32 v25, v126, v127
    v_cvt_pk_bf16_f32 v26, v128, v129
    v_cvt_pk_bf16_f32 v27, v130, v131
    s_add_u32 s33, s32, 0
    s_nop 0
    v_permlane32_swap_b32 v24, v26
    v_permlane32_swap_b32 v25, v27
    buffer_store_dwordx4 v[24:27], v2, s[12:15], s33 offen offset:512 sc0 sc1
    v_cvt_pk_bf16_f32 v28, v132, v133
    v_cvt_pk_bf16_f32 v29, v134, v135
    v_cvt_pk_bf16_f32 v30, v136, v137
    v_cvt_pk_bf16_f32 v31, v138, v139
    s_add_u32 s33, s32, 2048
    s_nop 0
    v_permlane32_swap_b32 v28, v30
    v_permlane32_swap_b32 v29, v31
    buffer_store_dwordx4 v[28:31], v2, s[12:15], s33 offen offset:0 sc0 sc1
    v_cvt_pk_bf16_f32 v32, v140, v141
    v_cvt_pk_bf16_f32 v33, v142, v143
    v_cvt_pk_bf16_f32 v34, v144, v145
    v_cvt_pk_bf16_f32 v35, v146, v147
    s_add_u32 s33, s32, 2048
    s_nop 0
    v_permlane32_swap_b32 v32, v34
    v_permlane32_swap_b32 v33, v35
    buffer_store_dwordx4 v[32:35], v2, s[12:15], s33 offen offset:512 sc0 sc1
    v_cvt_pk_bf16_f32 v20, v148, v149
    v_cvt_pk_bf16_f32 v21, v150, v151
    v_cvt_pk_bf16_f32 v22, v152, v153
    v_cvt_pk_bf16_f32 v23, v154, v155
    s_add_u32 s33, s32, 4096
    s_nop 0
    v_permlane32_swap_b32 v20, v22
    v_permlane32_swap_b32 v21, v23
    buffer_store_dwordx4 v[20:23], v2, s[12:15], s33 offen offset:0 sc0 sc1
    v_cvt_pk_bf16_f32 v24, v156, v157
    v_cvt_pk_bf16_f32 v25, v158, v159
    v_cvt_pk_bf16_f32 v26, v160, v161
    v_cvt_pk_bf16_f32 v27, v162, v163
    s_add_u32 s33, s32, 4096
    s_nop 0
    v_permlane32_swap_b32 v24, v26
    v_permlane32_swap_b32 v25, v27
    buffer_store_dwordx4 v[24:27], v2, s[12:15], s33 offen offset:512 sc0 sc1
    v_cvt_pk_bf16_f32 v28, v164, v165
    v_cvt_pk_bf16_f32 v29, v166, v167
    v_cvt_pk_bf16_f32 v30, v168, v169
    v_cvt_pk_bf16_f32 v31, v170, v171
    s_add_u32 s33, s32, 6144
    s_nop 0
    v_permlane32_swap_b32 v28, v30
    v_permlane32_swap_b32 v29, v31
    buffer_store_dwordx4 v[28:31], v2, s[12:15], s33 offen offset:0 sc0 sc1
    v_cvt_pk_bf16_f32 v32, v172, v173
    v_cvt_pk_bf16_f32 v33, v174, v175
    v_cvt_pk_bf16_f32 v34, v176, v177
    v_cvt_pk_bf16_f32 v35, v178, v179
    s_add_u32 s33, s32, 6144
    s_nop 0
    v_permlane32_swap_b32 v32, v34
    v_permlane32_swap_b32 v33, v35
    buffer_store_dwordx4 v[32:35], v2, s[12:15], s33 offen offset:512 sc0 sc1
    v_cvt_pk_bf16_f32 v20, v180, v181
    v_cvt_pk_bf16_f32 v21, v182, v183
    v_cvt_pk_bf16_f32 v22, v184, v185
    v_cvt_pk_bf16_f32 v23, v186, v187
    s_add_u32 s33, s32, 8192
    s_nop 0
    v_permlane32_swap_b32 v20, v22
    v_permlane32_swap_b32 v21, v23
    buffer_store_dwordx4 v[20:23], v2, s[12:15], s33 offen offset:0 sc0 sc1
    v_cvt_pk_bf16_f32 v24, v188, v189
    v_cvt_pk_bf16_f32 v25, v190, v191
    v_cvt_pk_bf16_f32 v26, v192, v193
    v_cvt_pk_bf16_f32 v27, v194, v195
    s_add_u32 s33, s32, 8192
    s_nop 0
    v_permlane32_swap_b32 v24, v26
    v_permlane32_swap_b32 v25, v27
    buffer_store_dwordx4 v[24:27], v2, s[12:15], s33 offen offset:512 sc0 sc1
    v_cvt_pk_bf16_f32 v28, v196, v197
    v_cvt_pk_bf16_f32 v29, v198, v199
    v_cvt_pk_bf16_f32 v30, v200, v201
    v_cvt_pk_bf16_f32 v31, v202, v203
    s_add_u32 s33, s32, 10240
    s_nop 0
    v_permlane32_swap_b32 v28, v30
    v_permlane32_swap_b32 v29, v31
    buffer_store_dwordx4 v[28:31], v2, s[12:15], s33 offen offset:0 sc0 sc1
    v_cvt_pk_bf16_f32 v32, v204, v205
    v_cvt_pk_bf16_f32 v33, v206, v207
    v_cvt_pk_bf16_f32 v34, v208, v209
    v_cvt_pk_bf16_f32 v35, v210, v211
    s_add_u32 s33, s32, 10240
    s_nop 0
    v_permlane32_swap_b32 v32, v34
    v_permlane32_swap_b32 v33, v35
    buffer_store_dwordx4 v[32:35], v2, s[12:15], s33 offen offset:512 sc0 sc1
    v_cvt_pk_bf16_f32 v20, v212, v213
    v_cvt_pk_bf16_f32 v21, v214, v215
    v_cvt_pk_bf16_f32 v22, v216, v217
    v_cvt_pk_bf16_f32 v23, v218, v219
    s_add_u32 s33, s32, 12288
    s_nop 0
    v_permlane32_swap_b32 v20, v22
    v_permlane32_swap_b32 v21, v23
    buffer_store_dwordx4 v[20:23], v2, s[12:15], s33 offen offset:0 sc0 sc1
    v_cvt_pk_bf16_f32 v24, v220, v221
    v_cvt_pk_bf16_f32 v25, v222, v223
    v_cvt_pk_bf16_f32 v26, v224, v225
    v_cvt_pk_bf16_f32 v27, v226, v227
    s_add_u32 s33, s32, 12288
    s_nop 0
    v_permlane32_swap_b32 v24, v26
    v_permlane32_swap_b32 v25, v27
    buffer_store_dwordx4 v[24:27], v2, s[12:15], s33 offen offset:512 sc0 sc1
    v_cvt_pk_bf16_f32 v28, v228, v229
    v_cvt_pk_bf16_f32 v29, v230, v231
    v_cvt_pk_bf16_f32 v30, v232, v233
    v_cvt_pk_bf16_f32 v31, v234, v235
    s_add_u32 s33, s32, 14336
    s_nop 0
    v_permlane32_swap_b32 v28, v30
    v_permlane32_swap_b32 v29, v31
    buffer_store_dwordx4 v[28:31], v2, s[12:15], s33 offen offset:0 sc0 sc1
    v_cvt_pk_bf16_f32 v32, v236, v237
    v_cvt_pk_bf16_f32 v33, v238, v239
    v_cvt_pk_bf16_f32 v34, v240, v241
    v_cvt_pk_bf16_f32 v35, v242, v243
    s_add_u32 s33, s32, 14336
    s_nop 0
    v_permlane32_swap_b32 v32, v34
    v_permlane32_swap_b32 v33, v35
    buffer_store_dwordx4 v[32:35], v2, s[12:15], s33 offen offset:512 sc0 sc1
    s_endpgm
L_kv_v:
    s_waitcnt vmcnt(12)
    s_barrier
    ds_read_b64_tr_b16 v[52:53], v17 offset:16384
    ds_read_b64_tr_b16 v[54:55], v17 offset:16896
    ds_read_b128 v[20:23], v14 offset:0
    ds_read_b128 v[24:27], v14 offset:1024
    ds_read_b128 v[28:31], v14 offset:2048
    ds_read_b128 v[32:35], v14 offset:3072
    ds_read_b64_tr_b16 v[56:57], v17 offset:16416
    ds_read_b64_tr_b16 v[58:59], v17 offset:16928
    ds_read_b64_tr_b16 v[60:61], v17 offset:16448
    ds_read_b64_tr_b16 v[62:63], v17 offset:16960
    ds_read_b64_tr_b16 v[64:65], v17 offset:16480
    ds_read_b64_tr_b16 v[66:67], v17 offset:16992
    ds_read_b64_tr_b16 v[68:69], v17 offset:16512
    ds_read_b64_tr_b16 v[70:71], v17 offset:17024
    ds_read_b64_tr_b16 v[72:73], v17 offset:16544
    ds_read_b64_tr_b16 v[74:75], v17 offset:17056
    ds_read_b64_tr_b16 v[76:77], v17 offset:16576
    ds_read_b64_tr_b16 v[78:79], v17 offset:17088
    ds_read_b64_tr_b16 v[80:81], v17 offset:16608
    ds_read_b64_tr_b16 v[82:83], v17 offset:17120
    s_mov_b32 s31, 3
L_kvv_loop_2:
    s_waitcnt lgkmcnt(0)
    s_waitcnt vmcnt(8)
    s_barrier
    v_mfma_f32_16x16x32_bf16 v[116:119], v[20:23], v[52:55], v[116:119]
    ds_read_b64_tr_b16 v[84:85], v17 offset:49664
    v_mfma_f32_16x16x32_bf16 v[120:123], v[24:27], v[52:55], v[120:123]
    ds_read_b64_tr_b16 v[86:87], v17 offset:50176
    v_mfma_f32_16x16x32_bf16 v[124:127], v[28:31], v[52:55], v[124:127]
    ds_read_b128 v[36:39], v14 offset:33280
    v_mfma_f32_16x16x32_bf16 v[128:131], v[32:35], v[52:55], v[128:131]
    ds_read_b128 v[40:43], v14 offset:34304
    v_mfma_f32_16x16x32_bf16 v[132:135], v[20:23], v[56:59], v[132:135]
    v_mfma_f32_16x16x32_bf16 v[136:139], v[24:27], v[56:59], v[136:139]
    s_add_u32 m0, s29, 0x0
    s_nop 0
    buffer_load_dwordx4 v10, s[4:7], s27 offen lds
    v_mfma_f32_16x16x32_bf16 v[140:143], v[28:31], v[56:59], v[140:143]
    ds_read_b128 v[44:47], v14 offset:35328
    v_mfma_f32_16x16x32_bf16 v[144:147], v[32:35], v[56:59], v[144:147]
    ds_read_b128 v[48:51], v14 offset:36352
    v_mfma_f32_16x16x32_bf16 v[148:151], v[20:23], v[60:63], v[148:151]
    ds_read_b64_tr_b16 v[88:89], v17 offset:49696
    v_mfma_f32_16x16x32_bf16 v[152:155], v[24:27], v[60:63], v[152:155]
    v_mfma_f32_16x16x32_bf16 v[156:159], v[28:31], v[60:63], v[156:159]
    ds_read_b64_tr_b16 v[90:91], v17 offset:50208
    v_mfma_f32_16x16x32_bf16 v[160:163], v[32:35], v[60:63], v[160:163]
    s_add_u32 m0, s29, 0x400
    s_nop 0
    buffer_load_dwordx4 v11, s[4:7], s27 offen lds
    v_mfma_f32_16x16x32_bf16 v[164:167], v[20:23], v[64:67], v[164:167]
    ds_read_b64_tr_b16 v[92:93], v17 offset:49728
    v_mfma_f32_16x16x32_bf16 v[168:171], v[24:27], v[64:67], v[168:171]
    v_mfma_f32_16x16x32_bf16 v[172:175], v[28:31], v[64:67], v[172:175]
    ds_read_b64_tr_b16 v[94:95], v17 offset:50240
    v_mfma_f32_16x16x32_bf16 v[176:179], v[32:35], v[64:67], v[176:179]
    ds_read_b64_tr_b16 v[96:97], v17 offset:49760
    v_mfma_f32_16x16x32_bf16 v[180:183], v[20:23], v[68:71], v[180:183]
    ds_read_b64_tr_b16 v[98:99], v17 offset:50272
    v_mfma_f32_16x16x32_bf16 v[184:187], v[24:27], v[68:71], v[184:187]
    s_add_u32 m0, s30, 0x4000
    s_nop 0
    buffer_load_dwordx4 v12, s[8:11], s28 offen lds
    v_mfma_f32_16x16x32_bf16 v[188:191], v[28:31], v[68:71], v[188:191]
    v_mfma_f32_16x16x32_bf16 v[192:195], v[32:35], v[68:71], v[192:195]
    ds_read_b64_tr_b16 v[100:101], v17 offset:49792
    v_mfma_f32_16x16x32_bf16 v[196:199], v[20:23], v[72:75], v[196:199]
    ds_read_b64_tr_b16 v[102:103], v17 offset:50304
    v_mfma_f32_16x16x32_bf16 v[200:203], v[24:27], v[72:75], v[200:203]
    ds_read_b64_tr_b16 v[104:105], v17 offset:49824
    v_mfma_f32_16x16x32_bf16 v[204:207], v[28:31], v[72:75], v[204:207]
    v_mfma_f32_16x16x32_bf16 v[208:211], v[32:35], v[72:75], v[208:211]
    ds_read_b64_tr_b16 v[106:107], v17 offset:50336
    v_mfma_f32_16x16x32_bf16 v[212:215], v[20:23], v[76:79], v[212:215]
    s_add_u32 m0, s30, 0x4420
    s_nop 0
    buffer_load_dwordx4 v13, s[8:11], s28 offen lds
    v_mfma_f32_16x16x32_bf16 v[216:219], v[24:27], v[76:79], v[216:219]
    ds_read_b64_tr_b16 v[108:109], v17 offset:49856
    v_mfma_f32_16x16x32_bf16 v[220:223], v[28:31], v[76:79], v[220:223]
    ds_read_b64_tr_b16 v[110:111], v17 offset:50368
    v_mfma_f32_16x16x32_bf16 v[224:227], v[32:35], v[76:79], v[224:227]
    v_mfma_f32_16x16x32_bf16 v[228:231], v[20:23], v[80:83], v[228:231]
    ds_read_b64_tr_b16 v[112:113], v17 offset:49888
    v_mfma_f32_16x16x32_bf16 v[232:235], v[24:27], v[80:83], v[232:235]
    ds_read_b64_tr_b16 v[114:115], v17 offset:50400
    v_mfma_f32_16x16x32_bf16 v[236:239], v[28:31], v[80:83], v[236:239]
    s_add_u32 s27, s27, 64
    s_add_u32 s28, s28, 0x40000
    s_add_u32 s54, s54, 1
    s_cmp_eq_u32 s54, 16
    s_cselect_b32 s34, 0x400, 0
    s_cselect_b32 s35, 0x400000, 0
    s_cselect_b32 s54, 0, s54
    s_sub_u32 s27, s27, s34
    s_sub_u32 s28, s28, s35
    v_mfma_f32_16x16x32_bf16 v[240:243], v[32:35], v[80:83], v[240:243]
    s_waitcnt lgkmcnt(0)
    s_waitcnt vmcnt(8)
    s_barrier
    v_mfma_f32_16x16x32_bf16 v[116:119], v[36:39], v[84:87], v[116:119]
    ds_read_b64_tr_b16 v[52:53], v18 offset:17408
    v_mfma_f32_16x16x32_bf16 v[120:123], v[40:43], v[84:87], v[120:123]
    ds_read_b64_tr_b16 v[54:55], v18 offset:17920
    v_mfma_f32_16x16x32_bf16 v[124:127], v[44:47], v[84:87], v[124:127]
    ds_read_b128 v[20:23], v15 offset:1024
    v_mfma_f32_16x16x32_bf16 v[128:131], v[48:51], v[84:87], v[128:131]
    ds_read_b128 v[24:27], v15 offset:2048
    v_mfma_f32_16x16x32_bf16 v[132:135], v[36:39], v[88:91], v[132:135]
    v_mfma_f32_16x16x32_bf16 v[136:139], v[40:43], v[88:91], v[136:139]
    s_add_u32 m0, s29, 0x8200
    s_nop 0
    buffer_load_dwordx4 v10, s[4:7], s27 offen lds
    v_mfma_f32_16x16x32_bf16 v[140:143], v[44:47], v[88:91], v[140:143]
    ds_read_b128 v[28:31], v15 offset:3072
    v_mfma_f32_16x16x32_bf16 v[144:147], v[48:51], v[88:91], v[144:147]
    ds_read_b128 v[32:35], v15 offset:4096
    v_mfma_f32_16x16x32_bf16 v[148:151], v[36:39], v[92:95], v[148:151]
    ds_read_b64_tr_b16 v[56:57], v18 offset:17440
    v_mfma_f32_16x16x32_bf16 v[152:155], v[40:43], v[92:95], v[152:155]
    v_mfma_f32_16x16x32_bf16 v[156:159], v[44:47], v[92:95], v[156:159]
    ds_read_b64_tr_b16 v[58:59], v18 offset:17952
    v_mfma_f32_16x16x32_bf16 v[160:163], v[48:51], v[92:95], v[160:163]
    s_add_u32 m0, s29, 0x8600
    s_nop 0
    buffer_load_dwordx4 v11, s[4:7], s27 offen lds
    v_mfma_f32_16x16x32_bf16 v[164:167], v[36:39], v[96:99], v[164:167]
    ds_read_b64_tr_b16 v[60:61], v18 offset:17472
    v_mfma_f32_16x16x32_bf16 v[168:171], v[40:43], v[96:99], v[168:171]
    v_mfma_f32_16x16x32_bf16 v[172:175], v[44:47], v[96:99], v[172:175]
    ds_read_b64_tr_b16 v[62:63], v18 offset:17984
    v_mfma_f32_16x16x32_bf16 v[176:179], v[48:51], v[96:99], v[176:179]
    ds_read_b64_tr_b16 v[64:65], v18 offset:17504
    v_mfma_f32_16x16x32_bf16 v[180:183], v[36:39], v[100:103], v[180:183]
    ds_read_b64_tr_b16 v[66:67], v18 offset:18016
    v_mfma_f32_16x16x32_bf16 v[184:187], v[40:43], v[100:103], v[184:187]
    s_add_u32 m0, s30, 0xc200
    s_nop 0
    buffer_load_dwordx4 v12, s[8:11], s28 offen lds
    v_mfma_f32_16x16x32_bf16 v[188:191], v[44:47], v[100:103], v[188:191]
    v_mfma_f32_16x16x32_bf16 v[192:195], v[48:51], v[100:103], v[192:195]
    ds_read_b64_tr_b16 v[68:69], v18 offset:17536
    v_mfma_f32_16x16x32_bf16 v[196:199], v[36:39], v[104:107], v[196:199]
    ds_read_b64_tr_b16 v[70:71], v18 offset:18048
    v_mfma_f32_16x16x32_bf16 v[200:203], v[40:43], v[104:107], v[200:203]
    ds_read_b64_tr_b16 v[72:73], v18 offset:17568
    v_mfma_f32_16x16x32_bf16 v[204:207], v[44:47], v[104:107], v[204:207]
    v_mfma_f32_16x16x32_bf16 v[208:211], v[48:51], v[104:107], v[208:211]
    ds_read_b64_tr_b16 v[74:75], v18 offset:18080
    v_mfma_f32_16x16x32_bf16 v[212:215], v[36:39], v[108:111], v[212:215]
    s_add_u32 m0, s30, 0xc620
    s_nop 0
    buffer_load_dwordx4 v13, s[8:11], s28 offen lds
    v_mfma_f32_16x16x32_bf16 v[216:219], v[40:43], v[108:111], v[216:219]
    ds_read_b64_tr_b16 v[76:77], v18 offset:17600
    v_mfma_f32_16x16x32_bf16 v[220:223], v[44:47], v[108:111], v[220:223]
    ds_read_b64_tr_b16 v[78:79], v18 offset:18112
    v_mfma_f32_16x16x32_bf16 v[224:227], v[48:51], v[108:111], v[224:227]
    v_mfma_f32_16x16x32_bf16 v[228:231], v[36:39], v[112:115], v[228:231]
    ds_read_b64_tr_b16 v[80:81], v18 offset:17632
    v_mfma_f32_16x16x32_bf16 v[232:235], v[40:43], v[112:115], v[232:235]
    ds_read_b64_tr_b16 v[82:83], v18 offset:18144
    v_mfma_f32_16x16x32_bf16 v[236:239], v[44:47], v[112:115], v[236:239]
    s_add_u32 s27, s27, 64
    s_add_u32 s28, s28, 0x40000
    s_add_u32 s54, s54, 1
    s_cmp_eq_u32 s54, 16
    s_cselect_b32 s34, 0x400, 0
    s_cselect_b32 s35, 0x400000, 0
    s_cselect_b32 s54, 0, s54
    s_sub_u32 s27, s27, s34
    s_sub_u32 s28, s28, s35
    v_mfma_f32_16x16x32_bf16 v[240:243], v[48:51], v[112:115], v[240:243]
    s_waitcnt lgkmcnt(0)
    s_waitcnt vmcnt(8)
    s_barrier
    v_mfma_f32_16x16x32_bf16 v[116:119], v[20:23], v[52:55], v[116:119]
    ds_read_b64_tr_b16 v[84:85], v18 offset:50688
    v_mfma_f32_16x16x32_bf16 v[120:123], v[24:27], v[52:55], v[120:123]
    ds_read_b64_tr_b16 v[86:87], v18 offset:51200
    v_mfma_f32_16x16x32_bf16 v[124:127], v[28:31], v[52:55], v[124:127]
    ds_read_b128 v[36:39], v15 offset:34304
    v_mfma_f32_16x16x32_bf16 v[128:131], v[32:35], v[52:55], v[128:131]
    ds_read_b128 v[40:43], v15 offset:35328
    v_mfma_f32_16x16x32_bf16 v[132:135], v[20:23], v[56:59], v[132:135]
    v_mfma_f32_16x16x32_bf16 v[136:139], v[24:27], v[56:59], v[136:139]
    s_add_u32 m0, s29, 0x10400
    s_nop 0
    buffer_load_dwordx4 v10, s[4:7], s27 offen lds
    v_mfma_f32_16x16x32_bf16 v[140:143], v[28:31], v[56:59], v[140:143]
    ds_read_b128 v[44:47], v15 offset:36352
    v_mfma_f32_16x16x32_bf16 v[144:147], v[32:35], v[56:59], v[144:147]
    ds_read_b128 v[48:51], v15 offset:37376
    v_mfma_f32_16x16x32_bf16 v[148:151], v[20:23], v[60:63], v[148:151]
    ds_read_b64_tr_b16 v[88:89], v18 offset:50720
    v_mfma_f32_16x16x32_bf16 v[152:155], v[24:27], v[60:63], v[152:155]
    v_mfma_f32_16x16x32_bf16 v[156:159], v[28:31], v[60:63], v[156:159]
    ds_read_b64_tr_b16 v[90:91], v18 offset:51232
    v_mfma_f32_16x16x32_bf16 v[160:163], v[32:35], v[60:63], v[160:163]
    s_add_u32 m0, s29, 0x10800
    s_nop 0
    buffer_load_dwordx4 v11, s[4:7], s27 offen lds
    v_mfma_f32_16x16x32_bf16 v[164:167], v[20:23], v[64:67], v[164:167]
    ds_read_b64_tr_b16 v[92:93], v18 offset:50752
    v_mfma_f32_16x16x32_bf16 v[168:171], v[24:27], v[64:67], v[168:171]
    v_mfma_f32_16x16x32_bf16 v[172:175], v[28:31], v[64:67], v[172:175]
    ds_read_b64_tr_b16 v[94:95], v18 offset:51264
    v_mfma_f32_16x16x32_bf16 v[176:179], v[32:35], v[64:67], v[176:179]
    ds_read_b64_tr_b16 v[96:97], v18 offset:50784
    v_mfma_f32_16x16x32_bf16 v[180:183], v[20:23], v[68:71], v[180:183]
    ds_read_b64_tr_b16 v[98:99], v18 offset:51296
    v_mfma_f32_16x16x32_bf16 v[184:187], v[24:27], v[68:71], v[184:187]
    s_add_u32 m0, s30, 0x14400
    s_nop 0
    buffer_load_dwordx4 v12, s[8:11], s28 offen lds
    v_mfma_f32_16x16x32_bf16 v[188:191], v[28:31], v[68:71], v[188:191]
    v_mfma_f32_16x16x32_bf16 v[192:195], v[32:35], v[68:71], v[192:195]
    ds_read_b64_tr_b16 v[100:101], v18 offset:50816
    v_mfma_f32_16x16x32_bf16 v[196:199], v[20:23], v[72:75], v[196:199]
    ds_read_b64_tr_b16 v[102:103], v18 offset:51328
    v_mfma_f32_16x16x32_bf16 v[200:203], v[24:27], v[72:75], v[200:203]
    ds_read_b64_tr_b16 v[104:105], v18 offset:50848
    v_mfma_f32_16x16x32_bf16 v[204:207], v[28:31], v[72:75], v[204:207]
    v_mfma_f32_16x16x32_bf16 v[208:211], v[32:35], v[72:75], v[208:211]
    ds_read_b64_tr_b16 v[106:107], v18 offset:51360
    v_mfma_f32_16x16x32_bf16 v[212:215], v[20:23], v[76:79], v[212:215]
    s_add_u32 m0, s30, 0x14820
    s_nop 0
    buffer_load_dwordx4 v13, s[8:11], s28 offen lds
    v_mfma_f32_16x16x32_bf16 v[216:219], v[24:27], v[76:79], v[216:219]
    ds_read_b64_tr_b16 v[108:109], v18 offset:50880
    v_mfma_f32_16x16x32_bf16 v[220:223], v[28:31], v[76:79], v[220:223]
    ds_read_b64_tr_b16 v[110:111], v18 offset:51392
    v_mfma_f32_16x16x32_bf16 v[224:227], v[32:35], v[76:79], v[224:227]
    v_mfma_f32_16x16x32_bf16 v[228:231], v[20:23], v[80:83], v[228:231]
    ds_read_b64_tr_b16 v[112:113], v18 offset:50912
    v_mfma_f32_16x16x32_bf16 v[232:235], v[24:27], v[80:83], v[232:235]
    ds_read_b64_tr_b16 v[114:115], v18 offset:51424
    v_mfma_f32_16x16x32_bf16 v[236:239], v[28:31], v[80:83], v[236:239]
    s_add_u32 s27, s27, 64
    s_add_u32 s28, s28, 0x40000
    s_add_u32 s54, s54, 1
    s_cmp_eq_u32 s54, 16
    s_cselect_b32 s34, 0x400, 0
    s_cselect_b32 s35, 0x400000, 0
    s_cselect_b32 s54, 0, s54
    s_sub_u32 s27, s27, s34
    s_sub_u32 s28, s28, s35
    v_mfma_f32_16x16x32_bf16 v[240:243], v[32:35], v[80:83], v[240:243]
    s_waitcnt lgkmcnt(0)
    s_waitcnt vmcnt(8)
    s_barrier
    v_mfma_f32_16x16x32_bf16 v[116:119], v[36:39], v[84:87], v[116:119]
    ds_read_b64_tr_b16 v[52:53], v17 offset:16384
    v_mfma_f32_16x16x32_bf16 v[120:123], v[40:43], v[84:87], v[120:123]
    ds_read_b64_tr_b16 v[54:55], v17 offset:16896
    v_mfma_f32_16x16x32_bf16 v[124:127], v[44:47], v[84:87], v[124:127]
    ds_read_b128 v[20:23], v14 offset:0
    v_mfma_f32_16x16x32_bf16 v[128:131], v[48:51], v[84:87], v[128:131]
    ds_read_b128 v[24:27], v14 offset:1024
    v_mfma_f32_16x16x32_bf16 v[132:135], v[36:39], v[88:91], v[132:135]
    v_mfma_f32_16x16x32_bf16 v[136:139], v[40:43], v[88:91], v[136:139]
    s_add_u32 m0, s29, 0x18600
    s_nop 0
    buffer_load_dwordx4 v10, s[4:7], s27 offen lds
    v_mfma_f32_16x16x32_bf16 v[140:143], v[44:47], v[88:91], v[140:143]
    ds_read_b128 v[28:31], v14 offset:2048
    v_mfma_f32_16x16x32_bf16 v[144:147], v[48:51], v[88:91], v[144:147]
    ds_read_b128 v[32:35], v14 offset:3072
    v_mfma_f32_16x16x32_bf16 v[148:151], v[36:39], v[92:95], v[148:151]
    ds_read_b64_tr_b16 v[56:57], v17 offset:16416
    v_mfma_f32_16x16x32_bf16 v[152:155], v[40:43], v[92:95], v[152:155]
    v_mfma_f32_16x16x32_bf16 v[156:159], v[44:47], v[92:95], v[156:159]
    ds_read_b64_tr_b16 v[58:59], v17 offset:16928
    v_mfma_f32_16x16x32_bf16 v[160:163], v[48:51], v[92:95], v[160:163]
    s_add_u32 m0, s29, 0x18a00
    s_nop 0
    buffer_load_dwordx4 v11, s[4:7], s27 offen lds
    v_mfma_f32_16x16x32_bf16 v[164:167], v[36:39], v[96:99], v[164:167]
    ds_read_b64_tr_b16 v[60:61], v17 offset:16448
    v_mfma_f32_16x16x32_bf16 v[168:171], v[40:43], v[96:99], v[168:171]
    v_mfma_f32_16x16x32_bf16 v[172:175], v[44:47], v[96:99], v[172:175]
    ds_read_b64_tr_b16 v[62:63], v17 offset:16960
    v_mfma_f32_16x16x32_bf16 v[176:179], v[48:51], v[96:99], v[176:179]
    ds_read_b64_tr_b16 v[64:65], v17 offset:16480
    v_mfma_f32_16x16x32_bf16 v[180:183], v[36:39], v[100:103], v[180:183]
    ds_read_b64_tr_b16 v[66:67], v17 offset:16992
    v_mfma_f32_16x16x32_bf16 v[184:187], v[40:43], v[100:103], v[184:187]
    s_add_u32 m0, s30, 0x1c600
    s_nop 0
    buffer_load_dwordx4 v12, s[8:11], s28 offen lds
    v_mfma_f32_16x16x32_bf16 v[188:191], v[44:47], v[100:103], v[188:191]
    v_mfma_f32_16x16x32_bf16 v[192:195], v[48:51], v[100:103], v[192:195]
    ds_read_b64_tr_b16 v[68:69], v17 offset:16512
    v_mfma_f32_16x16x32_bf16 v[196:199], v[36:39], v[104:107], v[196:199]
    ds_read_b64_tr_b16 v[70:71], v17 offset:17024
    v_mfma_f32_16x16x32_bf16 v[200:203], v[40:43], v[104:107], v[200:203]
    ds_read_b64_tr_b16 v[72:73], v17 offset:16544
    v_mfma_f32_16x16x32_bf16 v[204:207], v[44:47], v[104:107], v[204:207]
    v_mfma_f32_16x16x32_bf16 v[208:211], v[48:51], v[104:107], v[208:211]
    ds_read_b64_tr_b16 v[74:75], v17 offset:17056
    v_mfma_f32_16x16x32_bf16 v[212:215], v[36:39], v[108:111], v[212:215]
    s_add_u32 m0, s30, 0x1ca20
    s_nop 0
    buffer_load_dwordx4 v13, s[8:11], s28 offen lds
    v_mfma_f32_16x16x32_bf16 v[216:219], v[40:43], v[108:111], v[216:219]
    ds_read_b64_tr_b16 v[76:77], v17 offset:16576
    v_mfma_f32_16x16x32_bf16 v[220:223], v[44:47], v[108:111], v[220:223]
    ds_read_b64_tr_b16 v[78:79], v17 offset:17088
    v_mfma_f32_16x16x32_bf16 v[224:227], v[48:51], v[108:111], v[224:227]
    v_mfma_f32_16x16x32_bf16 v[228:231], v[36:39], v[112:115], v[228:231]
    ds_read_b64_tr_b16 v[80:81], v17 offset:16608
    v_mfma_f32_16x16x32_bf16 v[232:235], v[40:43], v[112:115], v[232:235]
    ds_read_b64_tr_b16 v[82:83], v17 offset:17120
    v_mfma_f32_16x16x32_bf16 v[236:239], v[44:47], v[112:115], v[236:239]
    s_add_u32 s27, s27, 64
    s_add_u32 s28, s28, 0x40000
    s_add_u32 s54, s54, 1
    s_cmp_eq_u32 s54, 16
    s_cselect_b32 s34, 0x400, 0
    s_cselect_b32 s35, 0x400000, 0
    s_cselect_b32 s54, 0, s54
    s_sub_u32 s27, s27, s34
    s_sub_u32 s28, s28, s35
    v_mfma_f32_16x16x32_bf16 v[240:243], v[48:51], v[112:115], v[240:243]
    s_sub_u32 s31, s31, 1
    s_cmp_lg_u32 s31, 0
    s_cbranch_scc1 L_kvv_loop_2
    s_waitcnt lgkmcnt(0)
    s_waitcnt vmcnt(8)
    s_barrier
    v_mfma_f32_16x16x32_bf16 v[116:119], v[20:23], v[52:55], v[116:119]
    ds_read_b64_tr_b16 v[84:85], v17 offset:49664
    v_mfma_f32_16x16x32_bf16 v[120:123], v[24:27], v[52:55], v[120:123]
    ds_read_b64_tr_b16 v[86:87], v17 offset:50176
    v_mfma_f32_16x16x32_bf16 v[124:127], v[28:31], v[52:55], v[124:127]
    v_mfma_f32_16x16x32_bf16 v[128:131], v[32:35], v[52:55], v[128:131]
    ds_read_b128 v[36:39], v14 offset:33280
    v_mfma_f32_16x16x32_bf16 v[132:135], v[20:23], v[56:59], v[132:135]
    ds_read_b128 v[40:43], v14 offset:34304
    v_mfma_f32_16x16x32_bf16 v[136:139], v[24:27], v[56:59], v[136:139]
    v_mfma_f32_16x16x32_bf16 v[140:143], v[28:31], v[56:59], v[140:143]
    ds_read_b128 v[44:47], v14 offset:35328
    v_mfma_f32_16x16x32_bf16 v[144:147], v[32:35], v[56:59], v[144:147]
    v_mfma_f32_16x16x32_bf16 v[148:151], v[20:23], v[60:63], v[148:151]
    ds_read_b128 v[48:51], v14 offset:36352
    v_mfma_f32_16x16x32_bf16 v[152:155], v[24:27], v[60:63], v[152:155]
    ds_read_b64_tr_b16 v[88:89], v17 offset:49696
    v_mfma_f32_16x16x32_bf16 v[156:159], v[28:31], v[60:63], v[156:159]
    v_mfma_f32_16x16x32_bf16 v[160:163], v[32:35], v[60:63], v[160:163]
    ds_read_b64_tr_b16 v[90:91], v17 offset:50208
    v_mfma_f32_16x16x32_bf16 v[164:167], v[20:23], v[64:67], v[164:167]
    ds_read_b64_tr_b16 v[92:93], v17 offset:49728
    v_mfma_f32_16x16x32_bf16 v[168:171], v[24:27], v[64:67], v[168:171]
    v_mfma_f32_16x16x32_bf16 v[172:175], v[28:31], v[64:67], v[172:175]
    ds_read_b64_tr_b16 v[94:95], v17 offset:50240
    v_mfma_f32_16x16x32_bf16 v[176:179], v[32:35], v[64:67], v[176:179]
    v_mfma_f32_16x16x32_bf16 v[180:183], v[20:23], v[68:71], v[180:183]
    ds_read_b64_tr_b16 v[96:97], v17 offset:49760
    v_mfma_f32_16x16x32_bf16 v[184:187], v[24:27], v[68:71], v[184:187]
    ds_read_b64_tr_b16 v[98:99], v17 offset:50272
    v_mfma_f32_16x16x32_bf16 v[188:191], v[28:31], v[68:71], v[188:191]
    v_mfma_f32_16x16x32_bf16 v[192:195], v[32:35], v[68:71], v[192:195]
    ds_read_b64_tr_b16 v[100:101], v17 offset:49792
    v_mfma_f32_16x16x32_bf16 v[196:199], v[20:23], v[72:75], v[196:199]
    ds_read_b64_tr_b16 v[102:103], v17 offset:50304
    v_mfma_f32_16x16x32_bf16 v[200:203], v[24:27], v[72:75], v[200:203]
    v_mfma_f32_16x16x32_bf16 v[204:207], v[28:31], v[72:75], v[204:207]
    ds_read_b64_tr_b16 v[104:105], v17 offset:49824
    v_mfma_f32_16x16x32_bf16 v[208:211], v[32:35], v[72:75], v[208:211]
    v_mfma_f32_16x16x32_bf16 v[212:215], v[20:23], v[76:79], v[212:215]
    ds_read_b64_tr_b16 v[106:107], v17 offset:50336
    v_mfma_f32_16x16x32_bf16 v[216:219], v[24:27], v[76:79], v[216:219]
    ds_read_b64_tr_b16 v[108:109], v17 offset:49856
    v_mfma_f32_16x16x32_bf16 v[220:223], v[28:31], v[76:79], v[220:223]
    v_mfma_f32_16x16x32_bf16 v[224:227], v[32:35], v[76:79], v[224:227]
    ds_read_b64_tr_b16 v[110:111], v17 offset:50368
    v_mfma_f32_16x16x32_bf16 v[228:231], v[20:23], v[80:83], v[228:231]
    ds_read_b64_tr_b16 v[112:113], v17 offset:49888
    v_mfma_f32_16x16x32_bf16 v[232:235], v[24:27], v[80:83], v[232:235]
    v_mfma_f32_16x16x32_bf16 v[236:239], v[28:31], v[80:83], v[236:239]
    ds_read_b64_tr_b16 v[114:115], v17 offset:50400
    v_mfma_f32_16x16x32_bf16 v[240:243], v[32:35], v[80:83], v[240:243]
    s_waitcnt lgkmcnt(0)
    s_waitcnt vmcnt(4)
    s_barrier
    v_mfma_f32_16x16x32_bf16 v[116:119], v[36:39], v[84:87], v[116:119]
    ds_read_b64_tr_b16 v[52:53], v18 offset:17408
    v_mfma_f32_16x16x32_bf16 v[120:123], v[40:43], v[84:87], v[120:123]
    ds_read_b64_tr_b16 v[54:55], v18 offset:17920
    v_mfma_f32_16x16x32_bf16 v[124:127], v[44:47], v[84:87], v[124:127]
    v_mfma_f32_16x16x32_bf16 v[128:131], v[48:51], v[84:87], v[128:131]
    ds_read_b128 v[20:23], v15 offset:1024
    v_mfma_f32_16x16x32_bf16 v[132:135], v[36:39], v[88:91], v[132:135]
    ds_read_b128 v[24:27], v15 offset:2048
    v_mfma_f32_16x16x32_bf16 v[136:139], v[40:43], v[88:91], v[136:139]
    v_mfma_f32_16x16x32_bf16 v[140:143], v[44:47], v[88:91], v[140:143]
    ds_read_b128 v[28:31], v15 offset:3072
    v_mfma_f32_16x16x32_bf16 v[144:147], v[48:51], v[88:91], v[144:147]
    v_mfma_f32_16x16x32_bf16 v[148:151], v[36:39], v[92:95], v[148:151]
    ds_read_b128 v[32:35], v15 offset:4096
    v_mfma_f32_16x16x32_bf16 v[152:155], v[40:43], v[92:95], v[152:155]
    ds_read_b64_tr_b16 v[56:57], v18 offset:17440
    v_mfma_f32_16x16x32_bf16 v[156:159], v[44:47], v[92:95], v[156:159]
    v_mfma_f32_16x16x32_bf16 v[160:163], v[48:51], v[92:95], v[160:163]
    ds_read_b64_tr_b16 v[58:59], v18 offset:17952
    v_mfma_f32_16x16x32_bf16 v[164:167], v[36:39], v[96:99], v[164:167]
    ds_read_b64_tr_b16 v[60:61], v18 offset:17472
    v_mfma_f32_16x16x32_bf16 v[168:171], v[40:43], v[96:99], v[168:171]
    v_mfma_f32_16x16x32_bf16 v[172:175], v[44:47], v[96:99], v[172:175]
    ds_read_b64_tr_b16 v[62:63], v18 offset:17984
    v_mfma_f32_16x16x32_bf16 v[176:179], v[48:51], v[96:99], v[176:179]
    v_mfma_f32_16x16x32_bf16 v[180:183], v[36:39], v[100:103], v[180:183]
    ds_read_b64_tr_b16 v[64:65], v18 offset:17504
    v_mfma_f32_16x16x32_bf16 v[184:187], v[40:43], v[100:103], v[184:187]
    ds_read_b64_tr_b16 v[66:67], v18 offset:18016
    v_mfma_f32_16x16x32_bf16 v[188:191], v[44:47], v[100:103], v[188:191]
    v_mfma_f32_16x16x32_bf16 v[192:195], v[48:51], v[100:103], v[192:195]
    ds_read_b64_tr_b16 v[68:69], v18 offset:17536
    v_mfma_f32_16x16x32_bf16 v[196:199], v[36:39], v[104:107], v[196:199]
    ds_read_b64_tr_b16 v[70:71], v18 offset:18048
    v_mfma_f32_16x16x32_bf16 v[200:203], v[40:43], v[104:107], v[200:203]
    v_mfma_f32_16x16x32_bf16 v[204:207], v[44:47], v[104:107], v[204:207]
    ds_read_b64_tr_b16 v[72:73], v18 offset:17568
    v_mfma_f32_16x16x32_bf16 v[208:211], v[48:51], v[104:107], v[208:211]
    v_mfma_f32_16x16x32_bf16 v[212:215], v[36:39], v[108:111], v[212:215]
    ds_read_b64_tr_b16 v[74:75], v18 offset:18080
    v_mfma_f32_16x16x32_bf16 v[216:219], v[40:43], v[108:111], v[216:219]
    ds_read_b64_tr_b16 v[76:77], v18 offset:17600
    v_mfma_f32_16x16x32_bf16 v[220:223], v[44:47], v[108:111], v[220:223]
    v_mfma_f32_16x16x32_bf16 v[224:227], v[48:51], v[108:111], v[224:227]
    ds_read_b64_tr_b16 v[78:79], v18 offset:18112
    v_mfma_f32_16x16x32_bf16 v[228:231], v[36:39], v[112:115], v[228:231]
    ds_read_b64_tr_b16 v[80:81], v18 offset:17632
    v_mfma_f32_16x16x32_bf16 v[232:235], v[40:43], v[112:115], v[232:235]
    v_mfma_f32_16x16x32_bf16 v[236:239], v[44:47], v[112:115], v[236:239]
    ds_read_b64_tr_b16 v[82:83], v18 offset:18144
    v_mfma_f32_16x16x32_bf16 v[240:243], v[48:51], v[112:115], v[240:243]
    s_waitcnt lgkmcnt(0)
    s_waitcnt vmcnt(0)
    s_barrier
    v_mfma_f32_16x16x32_bf16 v[116:119], v[20:23], v[52:55], v[116:119]
    ds_read_b64_tr_b16 v[84:85], v18 offset:50688
    v_mfma_f32_16x16x32_bf16 v[120:123], v[24:27], v[52:55], v[120:123]
    ds_read_b64_tr_b16 v[86:87], v18 offset:51200
    v_mfma_f32_16x16x32_bf16 v[124:127], v[28:31], v[52:55], v[124:127]
    v_mfma_f32_16x16x32_bf16 v[128:131], v[32:35], v[52:55], v[128:131]
    ds_read_b128 v[36:39], v15 offset:34304
    v_mfma_f32_16x16x32_bf16 v[132:135], v[20:23], v[56:59], v[132:135]
    ds_read_b128 v[40:43], v15 offset:35328
    v_mfma_f32_16x16x32_bf16 v[136:139], v[24:27], v[56:59], v[136:139]
    v_mfma_f32_16x16x32_bf16 v[140:143], v[28:31], v[56:59], v[140:143]
    ds_read_b128 v[44:47], v15 offset:36352
    v_mfma_f32_16x16x32_bf16 v[144:147], v[32:35], v[56:59], v[144:147]
    v_mfma_f32_16x16x32_bf16 v[148:151], v[20:23], v[60:63], v[148:151]
    ds_read_b128 v[48:51], v15 offset:37376
    v_mfma_f32_16x16x32_bf16 v[152:155], v[24:27], v[60:63], v[152:155]
    ds_read_b64_tr_b16 v[88:89], v18 offset:50720
    v_mfma_f32_16x16x32_bf16 v[156:159], v[28:31], v[60:63], v[156:159]
    v_mfma_f32_16x16x32_bf16 v[160:163], v[32:35], v[60:63], v[160:163]
    ds_read_b64_tr_b16 v[90:91], v18 offset:51232
    v_mfma_f32_16x16x32_bf16 v[164:167], v[20:23], v[64:67], v[164:167]
    ds_read_b64_tr_b16 v[92:93], v18 offset:50752
    v_mfma_f32_16x16x32_bf16 v[168:171], v[24:27], v[64:67], v[168:171]
    v_mfma_f32_16x16x32_bf16 v[172:175], v[28:31], v[64:67], v[172:175]
    ds_read_b64_tr_b16 v[94:95], v18 offset:51264
    v_mfma_f32_16x16x32_bf16 v[176:179], v[32:35], v[64:67], v[176:179]
    v_mfma_f32_16x16x32_bf16 v[180:183], v[20:23], v[68:71], v[180:183]
    ds_read_b64_tr_b16 v[96:97], v18 offset:50784
    v_mfma_f32_16x16x32_bf16 v[184:187], v[24:27], v[68:71], v[184:187]
    ds_read_b64_tr_b16 v[98:99], v18 offset:51296
    v_mfma_f32_16x16x32_bf16 v[188:191], v[28:31], v[68:71], v[188:191]
    v_mfma_f32_16x16x32_bf16 v[192:195], v[32:35], v[68:71], v[192:195]
    ds_read_b64_tr_b16 v[100:101], v18 offset:50816
    v_mfma_f32_16x16x32_bf16 v[196:199], v[20:23], v[72:75], v[196:199]
    ds_read_b64_tr_b16 v[102:103], v18 offset:51328
    v_mfma_f32_16x16x32_bf16 v[200:203], v[24:27], v[72:75], v[200:203]
    v_mfma_f32_16x16x32_bf16 v[204:207], v[28:31], v[72:75], v[204:207]
    ds_read_b64_tr_b16 v[104:105], v18 offset:50848
    v_mfma_f32_16x16x32_bf16 v[208:211], v[32:35], v[72:75], v[208:211]
    v_mfma_f32_16x16x32_bf16 v[212:215], v[20:23], v[76:79], v[212:215]
    ds_read_b64_tr_b16 v[106:107], v18 offset:51360
    v_mfma_f32_16x16x32_bf16 v[216:219], v[24:27], v[76:79], v[216:219]
    ds_read_b64_tr_b16 v[108:109], v18 offset:50880
    v_mfma_f32_16x16x32_bf16 v[220:223], v[28:31], v[76:79], v[220:223]
    v_mfma_f32_16x16x32_bf16 v[224:227], v[32:35], v[76:79], v[224:227]
    ds_read_b64_tr_b16 v[110:111], v18 offset:51392
    v_mfma_f32_16x16x32_bf16 v[228:231], v[20:23], v[80:83], v[228:231]
    ds_read_b64_tr_b16 v[112:113], v18 offset:50912
    v_mfma_f32_16x16x32_bf16 v[232:235], v[24:27], v[80:83], v[232:235]
    v_mfma_f32_16x16x32_bf16 v[236:239], v[28:31], v[80:83], v[236:239]
    ds_read_b64_tr_b16 v[114:115], v18 offset:51424
    v_mfma_f32_16x16x32_bf16 v[240:243], v[32:35], v[80:83], v[240:243]
    s_waitcnt lgkmcnt(0)
    v_mfma_f32_16x16x32_bf16 v[116:119], v[36:39], v[84:87], v[116:119]
    v_mfma_f32_16x16x32_bf16 v[120:123], v[40:43], v[84:87], v[120:123]
    v_mfma_f32_16x16x32_bf16 v[124:127], v[44:47], v[84:87], v[124:127]
    v_mfma_f32_16x16x32_bf16 v[128:131], v[48:51], v[84:87], v[128:131]
    v_mfma_f32_16x16x32_bf16 v[132:135], v[36:39], v[88:91], v[132:135]
    v_mfma_f32_16x16x32_bf16 v[136:139], v[40:43], v[88:91], v[136:139]
    v_mfma_f32_16x16x32_bf16 v[140:143], v[44:47], v[88:91], v[140:143]
    v_mfma_f32_16x16x32_bf16 v[144:147], v[48:51], v[88:91], v[144:147]
    v_mfma_f32_16x16x32_bf16 v[148:151], v[36:39], v[92:95], v[148:151]
    v_mfma_f32_16x16x32_bf16 v[152:155], v[40:43], v[92:95], v[152:155]
    v_mfma_f32_16x16x32_bf16 v[156:159], v[44:47], v[92:95], v[156:159]
    v_mfma_f32_16x16x32_bf16 v[160:163], v[48:51], v[92:95], v[160:163]
    v_mfma_f32_16x16x32_bf16 v[164:167], v[36:39], v[96:99], v[164:167]
    v_mfma_f32_16x16x32_bf16 v[168:171], v[40:43], v[96:99], v[168:171]
    v_mfma_f32_16x16x32_bf16 v[172:175], v[44:47], v[96:99], v[172:175]
    v_mfma_f32_16x16x32_bf16 v[176:179], v[48:51], v[96:99], v[176:179]
    v_mfma_f32_16x16x32_bf16 v[180:183], v[36:39], v[100:103], v[180:183]
    v_mfma_f32_16x16x32_bf16 v[184:187], v[40:43], v[100:103], v[184:187]
    v_mfma_f32_16x16x32_bf16 v[188:191], v[44:47], v[100:103], v[188:191]
    v_mfma_f32_16x16x32_bf16 v[192:195], v[48:51], v[100:103], v[192:195]
    v_mfma_f32_16x16x32_bf16 v[196:199], v[36:39], v[104:107], v[196:199]
    v_mfma_f32_16x16x32_bf16 v[200:203], v[40:43], v[104:107], v[200:203]
    v_mfma_f32_16x16x32_bf16 v[204:207], v[44:47], v[104:107], v[204:207]
    v_mfma_f32_16x16x32_bf16 v[208:211], v[48:51], v[104:107], v[208:211]
    v_mfma_f32_16x16x32_bf16 v[212:215], v[36:39], v[108:111], v[212:215]
    v_mfma_f32_16x16x32_bf16 v[216:219], v[40:43], v[108:111], v[216:219]
    v_mfma_f32_16x16x32_bf16 v[220:223], v[44:47], v[108:111], v[220:223]
    v_mfma_f32_16x16x32_bf16 v[224:227], v[48:51], v[108:111], v[224:227]
    v_mfma_f32_16x16x32_bf16 v[228:231], v[36:39], v[112:115], v[228:231]
    v_mfma_f32_16x16x32_bf16 v[232:235], v[40:43], v[112:115], v[232:235]
    v_mfma_f32_16x16x32_bf16 v[236:239], v[44:47], v[112:115], v[236:239]
    v_mfma_f32_16x16x32_bf16 v[240:243], v[48:51], v[112:115], v[240:243]
    s_nop 15
    s_lshr_b32 s32, s25, 7
    s_add_u32 s32, s32, s22
    s_lshl_b32 s32, s32, 19
    s_lshr_b32 s33, s24, 6
    s_add_u32 s33, s33, s21
    s_lshl_b32 s33, s33, 14
    s_add_u32 s32, s32, s33
    v_bfe_u32 v2, v1, 4, 1
    v_mul_u32_u24 v2, 2048, v2
    v_and_b32 v3, 15, v1
    v_lshl_add_u32 v2, v3, 4, v2
    v_lshrrev_b32 v3, 5, v1
    v_lshl_add_u32 v2, v3, 8, v2
    v_cvt_pk_bf16_f32 v20, v116, v117
    v_cvt_pk_bf16_f32 v21, v118, v119
    v_cvt_pk_bf16_f32 v22, v132, v133
    v_cvt_pk_bf16_f32 v23, v134, v135
    s_add_u32 s33, s32, 0
    s_nop 0
    v_permlane32_swap_b32 v20, v22
    v_permlane32_swap_b32 v21, v23
    buffer_store_dwordx4 v[20:23], v2, s[12:15], s33 offen offset:0 sc0 sc1
    v_cvt_pk_bf16_f32 v24, v148, v149
    v_cvt_pk_bf16_f32 v25, v150, v151
    v_cvt_pk_bf16_f32 v26, v164, v165
    v_cvt_pk_bf16_f32 v27, v166, v167
    s_add_u32 s33, s32, 0
    s_nop 0
    v_permlane32_swap_b32 v24, v26
    v_permlane32_swap_b32 v25, v27
    buffer_store_dwordx4 v[24:27], v2, s[12:15], s33 offen offset:512 sc0 sc1
    v_cvt_pk_bf16_f32 v28, v180, v181
    v_cvt_pk_bf16_f32 v29, v182, v183
    v_cvt_pk_bf16_f32 v30, v196, v197
    v_cvt_pk_bf16_f32 v31, v198, v199
    s_add_u32 s33, s32, 0
    s_nop 0
    v_permlane32_swap_b32 v28, v30
    v_permlane32_swap_b32 v29, v31
    buffer_store_dwordx4 v[28:31], v2, s[12:15], s33 offen offset:1024 sc0 sc1
    v_cvt_pk_bf16_f32 v32, v212, v213
    v_cvt_pk_bf16_f32 v33, v214, v215
    v_cvt_pk_bf16_f32 v34, v228, v229
    v_cvt_pk_bf16_f32 v35, v230, v231
    s_add_u32 s33, s32, 0
    s_nop 0
    v_permlane32_swap_b32 v32, v34
    v_permlane32_swap_b32 v33, v35
    buffer_store_dwordx4 v[32:35], v2, s[12:15], s33 offen offset:1536 sc0 sc1
    v_cvt_pk_bf16_f32 v20, v120, v121
    v_cvt_pk_bf16_f32 v21, v122, v123
    v_cvt_pk_bf16_f32 v22, v136, v137
    v_cvt_pk_bf16_f32 v23, v138, v139
    s_add_u32 s33, s32, 4096
    s_nop 0
    v_permlane32_swap_b32 v20, v22
    v_permlane32_swap_b32 v21, v23
    buffer_store_dwordx4 v[20:23], v2, s[12:15], s33 offen offset:0 sc0 sc1
    v_cvt_pk_bf16_f32 v24, v152, v153
    v_cvt_pk_bf16_f32 v25, v154, v155
    v_cvt_pk_bf16_f32 v26, v168, v169
    v_cvt_pk_bf16_f32 v27, v170, v171
    s_add_u32 s33, s32, 4096
    s_nop 0
    v_permlane32_swap_b32 v24, v26
    v_permlane32_swap_b32 v25, v27
    buffer_store_dwordx4 v[24:27], v2, s[12:15], s33 offen offset:512 sc0 sc1
    v_cvt_pk_bf16_f32 v28, v184, v185
    v_cvt_pk_bf16_f32 v29, v186, v187
    v_cvt_pk_bf16_f32 v30, v200, v201
    v_cvt_pk_bf16_f32 v31, v202, v203
    s_add_u32 s33, s32, 4096
    s_nop 0
    v_permlane32_swap_b32 v28, v30
    v_permlane32_swap_b32 v29, v31
    buffer_store_dwordx4 v[28:31], v2, s[12:15], s33 offen offset:1024 sc0 sc1
    v_cvt_pk_bf16_f32 v32, v216, v217
    v_cvt_pk_bf16_f32 v33, v218, v219
    v_cvt_pk_bf16_f32 v34, v232, v233
    v_cvt_pk_bf16_f32 v35, v234, v235
    s_add_u32 s33, s32, 4096
    s_nop 0
    v_permlane32_swap_b32 v32, v34
    v_permlane32_swap_b32 v33, v35
    buffer_store_dwordx4 v[32:35], v2, s[12:15], s33 offen offset:1536 sc0 sc1
    v_cvt_pk_bf16_f32 v20, v124, v125
    v_cvt_pk_bf16_f32 v21, v126, v127
    v_cvt_pk_bf16_f32 v22, v140, v141
    v_cvt_pk_bf16_f32 v23, v142, v143
    s_add_u32 s33, s32, 8192
    s_nop 0
    v_permlane32_swap_b32 v20, v22
    v_permlane32_swap_b32 v21, v23
    buffer_store_dwordx4 v[20:23], v2, s[12:15], s33 offen offset:0 sc0 sc1
    v_cvt_pk_bf16_f32 v24, v156, v157
    v_cvt_pk_bf16_f32 v25, v158, v159
    v_cvt_pk_bf16_f32 v26, v172, v173
    v_cvt_pk_bf16_f32 v27, v174, v175
    s_add_u32 s33, s32, 8192
    s_nop 0
    v_permlane32_swap_b32 v24, v26
    v_permlane32_swap_b32 v25, v27
    buffer_store_dwordx4 v[24:27], v2, s[12:15], s33 offen offset:512 sc0 sc1
    v_cvt_pk_bf16_f32 v28, v188, v189
    v_cvt_pk_bf16_f32 v29, v190, v191
    v_cvt_pk_bf16_f32 v30, v204, v205
    v_cvt_pk_bf16_f32 v31, v206, v207
    s_add_u32 s33, s32, 8192
    s_nop 0
    v_permlane32_swap_b32 v28, v30
    v_permlane32_swap_b32 v29, v31
    buffer_store_dwordx4 v[28:31], v2, s[12:15], s33 offen offset:1024 sc0 sc1
    v_cvt_pk_bf16_f32 v32, v220, v221
    v_cvt_pk_bf16_f32 v33, v222, v223
    v_cvt_pk_bf16_f32 v34, v236, v237
    v_cvt_pk_bf16_f32 v35, v238, v239
    s_add_u32 s33, s32, 8192
    s_nop 0
    v_permlane32_swap_b32 v32, v34
    v_permlane32_swap_b32 v33, v35
    buffer_store_dwordx4 v[32:35], v2, s[12:15], s33 offen offset:1536 sc0 sc1
    v_cvt_pk_bf16_f32 v20, v128, v129
    v_cvt_pk_bf16_f32 v21, v130, v131
    v_cvt_pk_bf16_f32 v22, v144, v145
    v_cvt_pk_bf16_f32 v23, v146, v147
    s_add_u32 s33, s32, 12288
    s_nop 0
    v_permlane32_swap_b32 v20, v22
    v_permlane32_swap_b32 v21, v23
    buffer_store_dwordx4 v[20:23], v2, s[12:15], s33 offen offset:0 sc0 sc1
    v_cvt_pk_bf16_f32 v24, v160, v161
    v_cvt_pk_bf16_f32 v25, v162, v163
    v_cvt_pk_bf16_f32 v26, v176, v177
    v_cvt_pk_bf16_f32 v27, v178, v179
    s_add_u32 s33, s32, 12288
    s_nop 0
    v_permlane32_swap_b32 v24, v26
    v_permlane32_swap_b32 v25, v27
    buffer_store_dwordx4 v[24:27], v2, s[12:15], s33 offen offset:512 sc0 sc1
    v_cvt_pk_bf16_f32 v28, v192, v193
    v_cvt_pk_bf16_f32 v29, v194, v195
    v_cvt_pk_bf16_f32 v30, v208, v209
    v_cvt_pk_bf16_f32 v31, v210, v211
    s_add_u32 s33, s32, 12288
    s_nop 0
    v_permlane32_swap_b32 v28, v30
    v_permlane32_swap_b32 v29, v31
    buffer_store_dwordx4 v[28:31], v2, s[12:15], s33 offen offset:1024 sc0 sc1
    v_cvt_pk_bf16_f32 v32, v224, v225
    v_cvt_pk_bf16_f32 v33, v226, v227
    v_cvt_pk_bf16_f32 v34, v240, v241
    v_cvt_pk_bf16_f32 v35, v242, v243
    s_add_u32 s33, s32, 12288
    s_nop 0
    v_permlane32_swap_b32 v32, v34
    v_permlane32_swap_b32 v33, v35
    buffer_store_dwordx4 v[32:35], v2, s[12:15], s33 offen offset:1536 sc0 sc1
    s_endpgm
L_kv_end:
    s_endpgm
.globl attn_kernel
.p2align 8
.type attn_kernel,@function
attn_kernel:
    s_cmp_ge_u32 s2, 256
    s_cbranch_scc1 L_attn_end
    s_load_dwordx2 s[44:45], s[0:1], 16
    s_load_dwordx2 s[46:47], s[0:1], 104
    v_lshrrev_b32 v8, 6, v0
    v_and_b32 v1, 63, v0
    s_nop 0
    v_readfirstlane_b32 s24, v8
    s_nop 3
    s_and_b32 s25, s24, 3
    s_lshl_b32 s37, s25, 12
    s_and_b32 s27, s2, 31
    s_lshr_b32 s38, s2, 5
    s_sub_u32 s39, 15, s38
    s_lshl_b32 s30, s39, 1
    s_add_u32 s30, s30, 2
    s_cmp_lt_u32 s24, 4
    s_cselect_b32 s26, 1, 0
    s_cselect_b32 s38, s38, s39
    s_lshl_b32 s28, s38, 7
    s_lshl_b32 s39, s25, 5
    s_add_u32 s28, s28, s39
    s_lshl_b32 s29, s38, 1
    s_lshr_b32 s39, s25, 1
    s_add_u32 s29, s29, s39
    s_add_u32 s29, s29, 1
    s_lshl_b32 s36, s27, 19
    s_add_u32 s36, s36, s37
    s_mov_b32 s52, 0x41a00000
    s_mov_b32 s53, 0x3e0293ee
    s_waitcnt lgkmcnt(0)
    s_mov_b32 s4, s46
    s_mov_b32 s5, s47
    s_mov_b32 s6, 0x240000
    s_mov_b32 s7, 0x00020000
    s_mov_b32 s8, s44
    s_mov_b32 s9, s45
    s_mov_b32 s10, 0x480000
    s_mov_b32 s11, 0x00020000
    s_add_u32 s12, s46, 0x1000000
    s_addc_u32 s13, s47, 0
    s_mov_b32 s14, 0x1000000
    s_mov_b32 s15, 0x00020000
    s_add_u32 s16, s46, 0x2000000
    s_addc_u32 s17, s47, 0
    s_mov_b32 s18, 0x1000000
    s_mov_b32 s19, 0x00020000
    s_add_u32 s20, s46, 0x3000000
    s_addc_u32 s21, s47, 0
    s_mov_b32 s22, 0x1000000
    s_mov_b32 s23, 0x00020000
    v_lshrrev_b32 v6, 4, v1
    v_lshlrev_b32 v6, 15, v6
    v_and_b32 v9, 15, v1
    v_lshl_add_u32 v6, v9, 4, v6
    v_lshlrev_b32 v12, 4, v1
    s_lshr_b32 s38, s24, 2
    s_lshl_b32 s38, s38, 4
    s_add_u32 s38, s38, s25
    s_lshl_b32 s38, s38, 13
    s_lshl_b32 s39, s27, 8
    s_add_u32 s38, s38, s39
    s_mul_i32 s39, s24, 1088
    s_lshr_b32 s54, s28, 5
    s_mul_i32 s54, s54, 36864
    s_add_u32 m0, s39, 0x0
    s_nop 0
    buffer_load_dwordx4 v6, s[8:11], s38 offen lds
    s_add_u32 s38, s38, 0x40000
    buffer_load_dwordx4 v[48:51], v12, s[4:7], s54 offen offset:0
    buffer_load_dwordx4 v[52:55], v12, s[4:7], s54 offen offset:1024
    s_add_u32 m0, s39, 0x2200
    s_nop 0
    buffer_load_dwordx4 v6, s[8:11], s38 offen lds
    s_add_u32 s38, s38, 0x40000
    buffer_load_dwordx4 v[56:59], v12, s[4:7], s54 offen offset:2048
    buffer_load_dwordx4 v[60:63], v12, s[4:7], s54 offen offset:3072
    s_add_u32 s54, s54, 4096
    s_add_u32 m0, s39, 0x4400
    s_nop 0
    buffer_load_dwordx4 v6, s[8:11], s38 offen lds
    s_add_u32 s38, s38, 0x40000
    buffer_load_dwordx4 v[64:67], v12, s[4:7], s54 offen offset:0
    buffer_load_dwordx4 v[68:71], v12, s[4:7], s54 offen offset:1024
    s_add_u32 m0, s39, 0x6600
    s_nop 0
    buffer_load_dwordx4 v6, s[8:11], s38 offen lds
    s_add_u32 s38, s38, 0x40000
    buffer_load_dwordx4 v[72:75], v12, s[4:7], s54 offen offset:2048
    buffer_load_dwordx4 v[76:79], v12, s[4:7], s54 offen offset:3072
    s_add_u32 s54, s54, 4096
    v_and_b32 v9, 31, v1
    v_add_u32 v9, s28, v9
    v_lshrrev_b32 v11, 5, v1
    v_lshlrev_b32 v11, 2, v11
    v_sub_u32 v11, v9, v11
    v_bfe_u32 v8, v1, 2, 2
    v_mul_u32_u24 v13, 1088, v8
    v_lshrrev_b32 v8, 5, v1
    v_lshl_add_u32 v13, v8, 9, v13
    v_bfe_u32 v8, v1, 4, 1
    v_lshl_add_u32 v13, v8, 5, v13
    v_and_b32 v8, 3, v1
    v_lshl_add_u32 v13, v8, 3, v13
    v_add_u32 v14, 0x10000, v13
    v_add_u32 v15, 0x20000, v13
    v_and_b32 v8, 31, v1
    v_lshlrev_b32 v8, 4, v8
    v_lshrrev_b32 v9, 5, v1
    v_lshl_add_u32 v2, v9, 10, v8
    v_lshl_add_u32 v3, v9, 11, v8
    v_add_u32 v3, 0x10000, v3
    v_mov_b32 v16, 0
    v_mov_b32 v17, 0
    v_mov_b32 v18, 0
    v_mov_b32 v19, 0
    v_mov_b32 v20, 0
    v_mov_b32 v21, 0
    v_mov_b32 v22, 0
    v_mov_b32 v23, 0
    v_mov_b32 v24, 0
    v_mov_b32 v25, 0
    v_mov_b32 v26, 0
    v_mov_b32 v27, 0
    v_mov_b32 v28, 0
    v_mov_b32 v29, 0
    v_mov_b32 v30, 0
    v_mov_b32 v31, 0
    v_mov_b32 v32, 0
    v_mov_b32 v33, 0
    v_mov_b32 v34, 0
    v_mov_b32 v35, 0
    v_mov_b32 v36, 0
    v_mov_b32 v37, 0
    v_mov_b32 v38, 0
    v_mov_b32 v39, 0
    v_mov_b32 v40, 0
    v_mov_b32 v41, 0
    v_mov_b32 v42, 0
    v_mov_b32 v43, 0
    v_mov_b32 v44, 0
    v_mov_b32 v45, 0
    v_mov_b32 v46, 0
    v_mov_b32 v47, 0
    v_mov_b32 v144, 0
    v_mov_b32 v145, 0
    v_mov_b32 v146, 0
    v_mov_b32 v147, 0
    v_mov_b32 v148, 0
    v_mov_b32 v149, 0
    v_mov_b32 v150, 0
    v_mov_b32 v151, 0
    v_mov_b32 v152, 0
    v_mov_b32 v153, 0
    v_mov_b32 v154, 0
    v_mov_b32 v155, 0
    v_mov_b32 v156, 0
    v_mov_b32 v157, 0
    v_mov_b32 v158, 0
    v_mov_b32 v159, 0
    v_mov_b32 v160, 0
    v_mov_b32 v161, 0
    v_mov_b32 v162, 0
    v_mov_b32 v163, 0
    v_mov_b32 v164, 0
    v_mov_b32 v165, 0
    v_mov_b32 v166, 0
    v_mov_b32 v167, 0
    v_mov_b32 v168, 0
    v_mov_b32 v169, 0
    v_mov_b32 v170, 0
    v_mov_b32 v171, 0
    v_mov_b32 v172, 0
    v_mov_b32 v173, 0
    v_mov_b32 v174, 0
    v_mov_b32 v175, 0
    s_mov_b32 s34, 0
    s_mov_b32 s35, 0
    s_waitcnt vmcnt(9)
    s_barrier
    ds_read_b64_tr_b16 v[192:193], v13 offset:0
    ds_read_b64_tr_b16 v[194:195], v13 offset:256
    ds_read_b64_tr_b16 v[196:197], v13 offset:64
    ds_read_b64_tr_b16 v[198:199], v13 offset:320
    ds_read_b64_tr_b16 v[200:201], v13 offset:128
    ds_read_b64_tr_b16 v[202:203], v13 offset:384
    ds_read_b64_tr_b16 v[204:205], v13 offset:192
    ds_read_b64_tr_b16 v[206:207], v13 offset:448
    ds_read_b64_tr_b16 v[208:209], v13 offset:4352
    ds_read_b64_tr_b16 v[210:211], v13 offset:4608
    ds_read_b64_tr_b16 v[212:213], v13 offset:4416
    ds_read_b64_tr_b16 v[214:215], v13 offset:4672
    s_waitcnt lgkmcnt(10)
    v_mfma_f32_32x32x16_bf16 v[16:31], v[192:195], v[48:51], v[16:31]
    ds_read_b64_tr_b16 v[216:217], v13 offset:4480
    ds_read_b64_tr_b16 v[218:219], v13 offset:4736
    s_waitcnt lgkmcnt(10)
    v_mfma_f32_32x32x16_bf16 v[32:47], v[196:199], v[48:51], v[32:47]
    ds_read_b64_tr_b16 v[220:221], v13 offset:4544
    ds_read_b64_tr_b16 v[222:223], v13 offset:4800
    s_add_u32 m0, s39, 0x8800
    s_nop 0
    buffer_load_dwordx4 v6, s[8:11], s38 offen lds
    s_add_u32 s38, s38, 0x40000
    buffer_load_dwordx4 v[80:83], v12, s[4:7], s54 offen offset:0
    buffer_load_dwordx4 v[84:87], v12, s[4:7], s54 offen offset:1024
    s_waitcnt lgkmcnt(10)
    v_mfma_f32_32x32x16_bf16 v[144:159], v[200:203], v[48:51], v[144:159]
    s_waitcnt lgkmcnt(8)
    v_mfma_f32_32x32x16_bf16 v[160:175], v[204:207], v[48:51], v[160:175]
    s_waitcnt lgkmcnt(6)
    v_mfma_f32_32x32x16_bf16 v[16:31], v[208:211], v[52:55], v[16:31]
    s_waitcnt lgkmcnt(4)
    v_mfma_f32_32x32x16_bf16 v[32:47], v[212:215], v[52:55], v[32:47]
    s_add_u32 m0, s39, 0xaa00
    s_nop 0
    buffer_load_dwordx4 v6, s[8:11], s38 offen lds
    s_add_u32 s38, s38, 0x40000
    buffer_load_dwordx4 v[88:91], v12, s[4:7], s54 offen offset:2048
    buffer_load_dwordx4 v[92:95], v12, s[4:7], s54 offen offset:3072
    s_add_u32 s54, s54, 4096
    s_waitcnt lgkmcnt(2)
    v_mfma_f32_32x32x16_bf16 v[144:159], v[216:219], v[52:55], v[144:159]
    s_waitcnt lgkmcnt(0)
    v_mfma_f32_32x32x16_bf16 v[160:175], v[220:223], v[52:55], v[160:175]
    s_waitcnt vmcnt(12)
    s_barrier
    ds_read_b64_tr_b16 v[192:193], v13 offset:8704
    ds_read_b64_tr_b16 v[194:195], v13 offset:8960
    ds_read_b64_tr_b16 v[196:197], v13 offset:8768
    ds_read_b64_tr_b16 v[198:199], v13 offset:9024
    ds_read_b64_tr_b16 v[200:201], v13 offset:8832
    ds_read_b64_tr_b16 v[202:203], v13 offset:9088
    ds_read_b64_tr_b16 v[204:205], v13 offset:8896
    ds_read_b64_tr_b16 v[206:207], v13 offset:9152
    ds_read_b64_tr_b16 v[208:209], v13 offset:13056
    ds_read_b64_tr_b16 v[210:211], v13 offset:13312
    ds_read_b64_tr_b16 v[212:213], v13 offset:13120
    ds_read_b64_tr_b16 v[214:215], v13 offset:13376
    s_waitcnt lgkmcnt(10)
    v_mfma_f32_32x32x16_bf16 v[16:31], v[192:195], v[56:59], v[16:31]
    ds_read_b64_tr_b16 v[216:217], v13 offset:13184
    ds_read_b64_tr_b16 v[218:219], v13 offset:13440
    s_waitcnt lgkmcnt(10)
    v_mfma_f32_32x32x16_bf16 v[32:47], v[196:199], v[56:59], v[32:47]
    ds_read_b64_tr_b16 v[220:221], v13 offset:13248
    ds_read_b64_tr_b16 v[222:223], v13 offset:13504
    s_add_u32 m0, s39, 0xcc00
    s_nop 0
    buffer_load_dwordx4 v6, s[8:11], s38 offen lds
    s_add_u32 s38, s38, 0x40000
    buffer_load_dwordx4 v[96:99], v12, s[4:7], s54 offen offset:0
    buffer_load_dwordx4 v[100:103], v12, s[4:7], s54 offen offset:1024
    s_waitcnt lgkmcnt(10)
    v_mfma_f32_32x32x16_bf16 v[144:159], v[200:203], v[56:59], v[144:159]
    s_waitcnt lgkmcnt(8)
    v_mfma_f32_32x32x16_bf16 v[160:175], v[204:207], v[56:59], v[160:175]
    s_waitcnt lgkmcnt(6)
    v_mfma_f32_32x32x16_bf16 v[16:31], v[208:211], v[60:63], v[16:31]
    s_waitcnt lgkmcnt(4)
    v_mfma_f32_32x32x16_bf16 v[32:47], v[212:215], v[60:63], v[32:47]
    s_waitcnt lgkmcnt(2)
    v_mfma_f32_32x32x16_bf16 v[144:159], v[216:219], v[60:63], v[144:159]
    s_waitcnt lgkmcnt(0)
    v_mfma_f32_32x32x16_bf16 v[160:175], v[220:223], v[60:63], v[160:175]
    s_waitcnt vmcnt(9)
    s_barrier
    ds_read_b64_tr_b16 v[192:193], v13 offset:17408
    ds_read_b64_tr_b16 v[194:195], v13 offset:17664
    ds_read_b64_tr_b16 v[196:197], v13 offset:17472
    ds_read_b64_tr_b16 v[198:199], v13 offset:17728
    ds_read_b64_tr_b16 v[200:201], v13 offset:17536
    ds_read_b64_tr_b16 v[202:203], v13 offset:17792
    ds_read_b64_tr_b16 v[204:205], v13 offset:17600
    ds_read_b64_tr_b16 v[206:207], v13 offset:17856
    ds_read_b64_tr_b16 v[208:209], v13 offset:21760
    ds_read_b64_tr_b16 v[210:211], v13 offset:22016
    ds_read_b64_tr_b16 v[212:213], v13 offset:21824
    ds_read_b64_tr_b16 v[214:215], v13 offset:22080
    s_waitcnt lgkmcnt(10)
    v_mfma_f32_32x32x16_bf16 v[16:31], v[192:195], v[64:67], v[16:31]
    ds_read_b64_tr_b16 v[216:217], v13 offset:21888
    ds_read_b64_tr_b16 v[218:219], v13 offset:22144
    s_waitcnt lgkmcnt(10)
    v_mfma_f32_32x32x16_bf16 v[32:47], v[196:199], v[64:67], v[32:47]
    ds_read_b64_tr_b16 v[220:221], v13 offset:21952
    ds_read_b64_tr_b16 v[222:223], v13 offset:22208
    s_add_u32 m0, s39, 0xee00
    s_nop 0
    buffer_load_dwordx4 v6, s[8:11], s38 offen lds
    s_add_u32 s38, s38, 0x40000
    buffer_load_dwordx4 v[104:107], v12, s[4:7], s54 offen offset:2048
    buffer_load_dwordx4 v[108:111], v12, s[4:7], s54 offen offset:3072
    s_add_u32 s54, s54, 4096
    s_waitcnt lgkmcnt(10)
    v_mfma_f32_32x32x16_bf16 v[144:159], v[200:203], v[64:67], v[144:159]
    ds_read_b64_tr_b16 v[192:193], v13 offset:26112
    ds_read_b64_tr_b16 v[194:195], v13 offset:26368
    s_waitcnt lgkmcnt(10)
    v_mfma_f32_32x32x16_bf16 v[160:175], v[204:207], v[64:67], v[160:175]
    ds_read_b64_tr_b16 v[196:197], v13 offset:26176
    ds_read_b64_tr_b16 v[198:199], v13 offset:26432
    s_waitcnt lgkmcnt(10)
    v_mfma_f32_32x32x16_bf16 v[16:31], v[208:211], v[68:71], v[16:31]
    ds_read_b64_tr_b16 v[200:201], v13 offset:26240
    ds_read_b64_tr_b16 v[202:203], v13 offset:26496
    s_waitcnt lgkmcnt(10)
    v_mfma_f32_32x32x16_bf16 v[32:47], v[212:215], v[68:71], v[32:47]
    ds_read_b64_tr_b16 v[204:205], v13 offset:26304
    ds_read_b64_tr_b16 v[206:207], v13 offset:26560
    s_add_u32 m0, s39, 0x11000
    s_nop 0
    buffer_load_dwordx4 v6, s[8:11], s38 offen lds
    s_add_u32 s38, s38, 0x40000
    buffer_load_dwordx4 v[176:179], v12, s[4:7], s54 offen offset:0
    buffer_load_dwordx4 v[180:183], v12, s[4:7], s54 offen offset:1024
    s_waitcnt lgkmcnt(10)
    v_mfma_f32_32x32x16_bf16 v[144:159], v[216:219], v[68:71], v[144:159]
    ds_read_b64_tr_b16 v[208:209], v13 offset:30464
    ds_read_b64_tr_b16 v[210:211], v13 offset:30720
    s_waitcnt lgkmcnt(10)
    v_mfma_f32_32x32x16_bf16 v[160:175], v[220:223], v[68:71], v[160:175]
    ds_read_b64_tr_b16 v[212:213], v13 offset:30528
    ds_read_b64_tr_b16 v[214:215], v13 offset:30784
    s_waitcnt lgkmcnt(10)
    v_mfma_f32_32x32x16_bf16 v[16:31], v[192:195], v[72:75], v[16:31]
    ds_read_b64_tr_b16 v[216:217], v13 offset:30592
    ds_read_b64_tr_b16 v[218:219], v13 offset:30848
    s_waitcnt lgkmcnt(10)
    v_mfma_f32_32x32x16_bf16 v[32:47], v[196:199], v[72:75], v[32:47]
    ds_read_b64_tr_b16 v[220:221], v13 offset:30656
    ds_read_b64_tr_b16 v[222:223], v13 offset:30912
    s_add_u32 m0, s39, 0x13200
    s_nop 0
    buffer_load_dwordx4 v6, s[8:11], s38 offen lds
    s_add_u32 s38, s38, 0x40000
    buffer_load_dwordx4 v[184:187], v12, s[4:7], s54 offen offset:2048
    buffer_load_dwordx4 v[188:191], v12, s[4:7], s54 offen offset:3072
    s_add_u32 s54, s54, 4096
    s_waitcnt lgkmcnt(10)
    v_mfma_f32_32x32x16_bf16 v[144:159], v[200:203], v[72:75], v[144:159]
    s_waitcnt lgkmcnt(8)
    v_mfma_f32_32x32x16_bf16 v[160:175], v[204:207], v[72:75], v[160:175]
    s_waitcnt lgkmcnt(6)
    v_mfma_f32_32x32x16_bf16 v[16:31], v[208:211], v[76:79], v[16:31]
    s_waitcnt lgkmcnt(4)
    v_mfma_f32_32x32x16_bf16 v[32:47], v[212:215], v[76:79], v[32:47]
    s_waitcnt lgkmcnt(2)
    v_mfma_f32_32x32x16_bf16 v[144:159], v[216:219], v[76:79], v[144:159]
    s_waitcnt lgkmcnt(0)
    v_mfma_f32_32x32x16_bf16 v[160:175], v[220:223], v[76:79], v[160:175]
    s_waitcnt vmcnt(12)
    s_barrier
    ds_read_b64_tr_b16 v[192:193], v13 offset:34816
    ds_read_b64_tr_b16 v[194:195], v13 offset:35072
    ds_read_b64_tr_b16 v[196:197], v13 offset:34880
    ds_read_b64_tr_b16 v[198:199], v13 offset:35136
    ds_read_b64_tr_b16 v[200:201], v13 offset:34944
    ds_read_b64_tr_b16 v[202:203], v13 offset:35200
    ds_read_b64_tr_b16 v[204:205], v13 offset:35008
    ds_read_b64_tr_b16 v[206:207], v13 offset:35264
    ds_read_b64_tr_b16 v[208:209], v13 offset:39168
    ds_read_b64_tr_b16 v[210:211], v13 offset:39424
    ds_read_b64_tr_b16 v[212:213], v13 offset:39232
    ds_read_b64_tr_b16 v[214:215], v13 offset:39488
    s_waitcnt lgkmcnt(10)
    v_mfma_f32_32x32x16_bf16 v[16:31], v[192:195], v[80:83], v[16:31]
    ds_read_b64_tr_b16 v[216:217], v13 offset:39296
    ds_read_b64_tr_b16 v[218:219], v13 offset:39552
    s_waitcnt lgkmcnt(10)
    v_mfma_f32_32x32x16_bf16 v[32:47], v[196:199], v[80:83], v[32:47]
    ds_read_b64_tr_b16 v[220:221], v13 offset:39360
    ds_read_b64_tr_b16 v[222:223], v13 offset:39616
    s_add_u32 m0, s39, 0x15400
    s_nop 0
    buffer_load_dwordx4 v6, s[8:11], s38 offen lds
    s_add_u32 s38, s38, 0x40000
    buffer_load_dwordx4 v[112:115], v12, s[4:7], s54 offen offset:0
    buffer_load_dwordx4 v[116:119], v12, s[4:7], s54 offen offset:1024
    s_waitcnt lgkmcnt(10)
    v_mfma_f32_32x32x16_bf16 v[144:159], v[200:203], v[80:83], v[144:159]
    ds_read_b64_tr_b16 v[192:193], v13 offset:43520
    ds_read_b64_tr_b16 v[194:195], v13 offset:43776
    s_waitcnt lgkmcnt(10)
    v_mfma_f32_32x32x16_bf16 v[160:175], v[204:207], v[80:83], v[160:175]
    ds_read_b64_tr_b16 v[196:197], v13 offset:43584
    ds_read_b64_tr_b16 v[198:199], v13 offset:43840
    s_waitcnt lgkmcnt(10)
    v_mfma_f32_32x32x16_bf16 v[16:31], v[208:211], v[84:87], v[16:31]
    ds_read_b64_tr_b16 v[200:201], v13 offset:43648
    ds_read_b64_tr_b16 v[202:203], v13 offset:43904
    s_waitcnt lgkmcnt(10)
    v_mfma_f32_32x32x16_bf16 v[32:47], v[212:215], v[84:87], v[32:47]
    ds_read_b64_tr_b16 v[204:205], v13 offset:43712
    ds_read_b64_tr_b16 v[206:207], v13 offset:43968
    s_add_u32 m0, s39, 0x18000
    s_nop 0
    buffer_load_dwordx4 v6, s[8:11], s38 offen lds
    s_add_u32 s38, s38, 0x40000
    buffer_load_dwordx4 v[120:123], v12, s[4:7], s54 offen offset:2048
    buffer_load_dwordx4 v[124:127], v12, s[4:7], s54 offen offset:3072
    s_add_u32 s54, s54, 4096
    s_waitcnt lgkmcnt(10)
    v_mfma_f32_32x32x16_bf16 v[144:159], v[216:219], v[84:87], v[144:159]
    ds_read_b64_tr_b16 v[208:209], v13 offset:47872
    ds_read_b64_tr_b16 v[210:211], v13 offset:48128
    s_waitcnt lgkmcnt(10)
    v_mfma_f32_32x32x16_bf16 v[160:175], v[220:223], v[84:87], v[160:175]
    ds_read_b64_tr_b16 v[212:213], v13 offset:47936
    ds_read_b64_tr_b16 v[214:215], v13 offset:48192
    s_waitcnt lgkmcnt(10)
    v_mfma_f32_32x32x16_bf16 v[16:31], v[192:195], v[88:91], v[16:31]
    ds_read_b64_tr_b16 v[216:217], v13 offset:48000
    ds_read_b64_tr_b16 v[218:219], v13 offset:48256
    s_waitcnt lgkmcnt(10)
    v_mfma_f32_32x32x16_bf16 v[32:47], v[196:199], v[88:91], v[32:47]
    ds_read_b64_tr_b16 v[220:221], v13 offset:48064
    ds_read_b64_tr_b16 v[222:223], v13 offset:48320
    s_waitcnt lgkmcnt(10)
    v_mfma_f32_32x32x16_bf16 v[144:159], v[200:203], v[88:91], v[144:159]
    s_waitcnt lgkmcnt(8)
    v_mfma_f32_32x32x16_bf16 v[160:175], v[204:207], v[88:91], v[160:175]
    s_waitcnt lgkmcnt(6)
    v_mfma_f32_32x32x16_bf16 v[16:31], v[208:211], v[92:95], v[16:31]
    s_waitcnt lgkmcnt(4)
    v_mfma_f32_32x32x16_bf16 v[32:47], v[212:215], v[92:95], v[32:47]
    s_waitcnt lgkmcnt(2)
    v_mfma_f32_32x32x16_bf16 v[144:159], v[216:219], v[92:95], v[144:159]
    s_waitcnt lgkmcnt(0)
    v_mfma_f32_32x32x16_bf16 v[160:175], v[220:223], v[92:95], v[160:175]
    s_waitcnt vmcnt(12)
    s_barrier
    ds_read_b64_tr_b16 v[192:193], v13 offset:52224
    ds_read_b64_tr_b16 v[194:195], v13 offset:52480
    ds_read_b64_tr_b16 v[196:197], v13 offset:52288
    ds_read_b64_tr_b16 v[198:199], v13 offset:52544
    ds_read_b64_tr_b16 v[200:201], v13 offset:52352
    ds_read_b64_tr_b16 v[202:203], v13 offset:52608
    ds_read_b64_tr_b16 v[204:205], v13 offset:52416
    ds_read_b64_tr_b16 v[206:207], v13 offset:52672
    ds_read_b64_tr_b16 v[208:209], v13 offset:56576
    ds_read_b64_tr_b16 v[210:211], v13 offset:56832
    ds_read_b64_tr_b16 v[212:213], v13 offset:56640
    ds_read_b64_tr_b16 v[214:215], v13 offset:56896
    s_waitcnt lgkmcnt(10)
    v_mfma_f32_32x32x16_bf16 v[16:31], v[192:195], v[96:99], v[16:31]
    ds_read_b64_tr_b16 v[216:217], v13 offset:56704
    ds_read_b64_tr_b16 v[218:219], v13 offset:56960
    s_waitcnt lgkmcnt(10)
    v_mfma_f32_32x32x16_bf16 v[32:47], v[196:199], v[96:99], v[32:47]
    ds_read_b64_tr_b16 v[220:221], v13 offset:56768
    ds_read_b64_tr_b16 v[222:223], v13 offset:57024
    s_add_u32 m0, s39, 0x1a200
    s_nop 0
    buffer_load_dwordx4 v6, s[8:11], s38 offen lds
    s_add_u32 s38, s38, 0x40000
    buffer_load_dwordx4 v[128:131], v12, s[4:7], s54 offen offset:0
    buffer_load_dwordx4 v[132:135], v12, s[4:7], s54 offen offset:1024
    s_waitcnt lgkmcnt(10)
    v_mfma_f32_32x32x16_bf16 v[144:159], v[200:203], v[96:99], v[144:159]
    ds_read_b64_tr_b16 v[192:193], v13 offset:60928
    ds_read_b64_tr_b16 v[194:195], v13 offset:61184
    s_waitcnt lgkmcnt(10)
    v_mfma_f32_32x32x16_bf16 v[160:175], v[204:207], v[96:99], v[160:175]
    ds_read_b64_tr_b16 v[196:197], v13 offset:60992
    ds_read_b64_tr_b16 v[198:199], v13 offset:61248
    s_waitcnt lgkmcnt(10)
    v_mfma_f32_32x32x16_bf16 v[16:31], v[208:211], v[100:103], v[16:31]
    ds_read_b64_tr_b16 v[200:201], v13 offset:61056
    ds_read_b64_tr_b16 v[202:203], v13 offset:61312
    s_waitcnt lgkmcnt(10)
    v_mfma_f32_32x32x16_bf16 v[32:47], v[212:215], v[100:103], v[32:47]
    ds_read_b64_tr_b16 v[204:205], v13 offset:61120
    ds_read_b64_tr_b16 v[206:207], v13 offset:61376
    s_add_u32 m0, s39, 0x1c400
    s_nop 0
    buffer_load_dwordx4 v6, s[8:11], s38 offen lds
    s_add_u32 s38, s38, 0x40000
    buffer_load_dwordx4 v[136:139], v12, s[4:7], s54 offen offset:2048
    buffer_load_dwordx4 v[140:143], v12, s[4:7], s54 offen offset:3072
    s_add_u32 s54, s54, 4096
    s_waitcnt lgkmcnt(10)
    v_mfma_f32_32x32x16_bf16 v[144:159], v[216:219], v[100:103], v[144:159]
    ds_read_b64_tr_b16 v[208:209], v13 offset:65280
    ds_read_b64_tr_b16 v[210:211], v14 offset:0
    s_waitcnt lgkmcnt(10)
    v_mfma_f32_32x32x16_bf16 v[160:175], v[220:223], v[100:103], v[160:175]
    ds_read_b64_tr_b16 v[212:213], v13 offset:65344
    ds_read_b64_tr_b16 v[214:215], v14 offset:64
    s_waitcnt lgkmcnt(10)
    v_mfma_f32_32x32x16_bf16 v[16:31], v[192:195], v[104:107], v[16:31]
    ds_read_b64_tr_b16 v[216:217], v13 offset:65408
    ds_read_b64_tr_b16 v[218:219], v14 offset:128
    s_waitcnt lgkmcnt(10)
    v_mfma_f32_32x32x16_bf16 v[32:47], v[196:199], v[104:107], v[32:47]
    ds_read_b64_tr_b16 v[220:221], v13 offset:65472
    ds_read_b64_tr_b16 v[222:223], v14 offset:192
    s_waitcnt lgkmcnt(10)
    v_mfma_f32_32x32x16_bf16 v[144:159], v[200:203], v[104:107], v[144:159]
    s_waitcnt lgkmcnt(8)
    v_mfma_f32_32x32x16_bf16 v[160:175], v[204:207], v[104:107], v[160:175]
    s_waitcnt lgkmcnt(6)
    v_mfma_f32_32x32x16_bf16 v[16:31], v[208:211], v[108:111], v[16:31]
    s_waitcnt lgkmcnt(4)
    v_mfma_f32_32x32x16_bf16 v[32:47], v[212:215], v[108:111], v[32:47]
    s_waitcnt lgkmcnt(2)
    v_mfma_f32_32x32x16_bf16 v[144:159], v[216:219], v[108:111], v[144:159]
    s_waitcnt lgkmcnt(0)
    v_mfma_f32_32x32x16_bf16 v[160:175], v[220:223], v[108:111], v[160:175]
    s_waitcnt vmcnt(9)
    s_barrier
    ds_read_b64_tr_b16 v[192:193], v14 offset:4096
    ds_read_b64_tr_b16 v[194:195], v14 offset:4352
    ds_read_b64_tr_b16 v[196:197], v14 offset:4160
    ds_read_b64_tr_b16 v[198:199], v14 offset:4416
    ds_read_b64_tr_b16 v[200:201], v14 offset:4224
    ds_read_b64_tr_b16 v[202:203], v14 offset:4480
    ds_read_b64_tr_b16 v[204:205], v14 offset:4288
    ds_read_b64_tr_b16 v[206:207], v14 offset:4544
    ds_read_b64_tr_b16 v[208:209], v14 offset:8448
    ds_read_b64_tr_b16 v[210:211], v14 offset:8704
    ds_read_b64_tr_b16 v[212:213], v14 offset:8512
    ds_read_b64_tr_b16 v[214:215], v14 offset:8768
    s_waitcnt lgkmcnt(10)
    v_mfma_f32_32x32x16_bf16 v[16:31], v[192:195], v[176:179], v[16:31]
    ds_read_b64_tr_b16 v[216:217], v14 offset:8576
    ds_read_b64_tr_b16 v[218:219], v14 offset:8832
    s_waitcnt lgkmcnt(10)
    v_mfma_f32_32x32x16_bf16 v[32:47], v[196:199], v[176:179], v[32:47]
    ds_read_b64_tr_b16 v[220:221], v14 offset:8640
    ds_read_b64_tr_b16 v[222:223], v14 offset:8896
    s_add_u32 m0, s39, 0x1e600
    s_nop 0
    buffer_load_dwordx4 v6, s[8:11], s38 offen lds
    s_add_u32 s38, s38, 0x40000
    buffer_load_dwordx4 v[224:227], v12, s[4:7], s54 offen offset:0
    buffer_load_dwordx4 v[228:231], v12, s[4:7], s54 offen offset:1024
    s_waitcnt lgkmcnt(10)
    v_mfma_f32_32x32x16_bf16 v[144:159], v[200:203], v[176:179], v[144:159]
    ds_read_b64_tr_b16 v[192:193], v14 offset:12800
    ds_read_b64_tr_b16 v[194:195], v14 offset:13056
    s_waitcnt lgkmcnt(10)
    v_mfma_f32_32x32x16_bf16 v[160:175], v[204:207], v[176:179], v[160:175]
    ds_read_b64_tr_b16 v[196:197], v14 offset:12864
    ds_read_b64_tr_b16 v[198:199], v14 offset:13120
    s_waitcnt lgkmcnt(10)
    v_mfma_f32_32x32x16_bf16 v[16:31], v[208:211], v[180:183], v[16:31]
    ds_read_b64_tr_b16 v[200:201], v14 offset:12928
    ds_read_b64_tr_b16 v[202:203], v14 offset:13184
    s_waitcnt lgkmcnt(10)
    v_mfma_f32_32x32x16_bf16 v[32:47], v[212:215], v[180:183], v[32:47]
    ds_read_b64_tr_b16 v[204:205], v14 offset:12992
    ds_read_b64_tr_b16 v[206:207], v14 offset:13248
    s_add_u32 m0, s39, 0x20800
    s_nop 0
    buffer_load_dwordx4 v6, s[8:11], s38 offen lds
    s_add_u32 s38, s38, 0x40000
    buffer_load_dwordx4 v[232:235], v12, s[4:7], s54 offen offset:2048
    buffer_load_dwordx4 v[236:239], v12, s[4:7], s54 offen offset:3072
    s_add_u32 s54, s54, 4096
    s_waitcnt lgkmcnt(10)
    v_mfma_f32_32x32x16_bf16 v[144:159], v[216:219], v[180:183], v[144:159]
    ds_read_b64_tr_b16 v[208:209], v14 offset:17152
    ds_read_b64_tr_b16 v[210:211], v14 offset:17408
    s_waitcnt lgkmcnt(10)
    v_mfma_f32_32x32x16_bf16 v[160:175], v[220:223], v[180:183], v[160:175]
    ds_read_b64_tr_b16 v[212:213], v14 offset:17216
    ds_read_b64_tr_b16 v[214:215], v14 offset:17472
    s_waitcnt lgkmcnt(10)
    v_mfma_f32_32x32x16_bf16 v[16:31], v[192:195], v[184:187], v[16:31]
    ds_read_b64_tr_b16 v[216:217], v14 offset:17280
    ds_read_b64_tr_b16 v[218:219], v14 offset:17536
    s_waitcnt lgkmcnt(10)
    v_mfma_f32_32x32x16_bf16 v[32:47], v[196:199], v[184:187], v[32:47]
    ds_read_b64_tr_b16 v[220:221], v14 offset:17344
    ds_read_b64_tr_b16 v[222:223], v14 offset:17600
    s_add_u32 m0, s39, 0x22a00
    s_nop 0
    buffer_load_dwordx4 v6, s[8:11], s38 offen lds
    s_add_u32 s38, s38, 0x40000
    buffer_load_dwordx4 v[240:243], v12, s[4:7], s54 offen offset:0
    buffer_load_dwordx4 v[244:247], v12, s[4:7], s54 offen offset:1024
    s_waitcnt lgkmcnt(10)
    v_mfma_f32_32x32x16_bf16 v[144:159], v[200:203], v[184:187], v[144:159]
    ds_read_b64_tr_b16 v[192:193], v14 offset:21504
    ds_read_b64_tr_b16 v[194:195], v14 offset:21760
    s_waitcnt lgkmcnt(10)
    v_mfma_f32_32x32x16_bf16 v[160:175], v[204:207], v[184:187], v[160:175]
    ds_read_b64_tr_b16 v[196:197], v14 offset:21568
    ds_read_b64_tr_b16 v[198:199], v14 offset:21824
    s_waitcnt lgkmcnt(10)
    v_mfma_f32_32x32x16_bf16 v[16:31], v[208:211], v[188:191], v[16:31]
    ds_read_b64_tr_b16 v[200:201], v14 offset:21632
    ds_read_b64_tr_b16 v[202:203], v14 offset:21888
    s_waitcnt lgkmcnt(10)
    v_mfma_f32_32x32x16_bf16 v[32:47], v[212:215], v[188:191], v[32:47]
    ds_read_b64_tr_b16 v[204:205], v14 offset:21696
    ds_read_b64_tr_b16 v[206:207], v14 offset:21952
    s_add_u32 m0, s39, 0x24c00
    s_nop 0
    buffer_load_dwordx4 v6, s[8:11], s38 offen lds
    s_add_u32 s38, s38, 0x40000
    buffer_load_dwordx4 v[248:251], v12, s[4:7], s54 offen offset:2048
    buffer_load_dwordx4 v[252:255], v12, s[4:7], s54 offen offset:3072
    s_add_u32 s54, s54, 4096
    s_waitcnt lgkmcnt(10)
    v_mfma_f32_32x32x16_bf16 v[144:159], v[216:219], v[188:191], v[144:159]
    ds_read_b64_tr_b16 v[208:209], v14 offset:25856
    ds_read_b64_tr_b16 v[210:211], v14 offset:26112
    s_waitcnt lgkmcnt(10)
    v_mfma_f32_32x32x16_bf16 v[160:175], v[220:223], v[188:191], v[160:175]
    ds_read_b64_tr_b16 v[212:213], v14 offset:25920
    ds_read_b64_tr_b16 v[214:215], v14 offset:26176
    s_waitcnt lgkmcnt(10)
    v_mfma_f32_32x32x16_bf16 v[16:31], v[192:195], v[112:115], v[16:31]
    ds_read_b64_tr_b16 v[216:217], v14 offset:25984
    ds_read_b64_tr_b16 v[218:219], v14 offset:26240
    s_waitcnt lgkmcnt(10)
    v_mfma_f32_32x32x16_bf16 v[32:47], v[196:199], v[112:115], v[32:47]
    ds_read_b64_tr_b16 v[220:221], v14 offset:26048
    ds_read_b64_tr_b16 v[222:223], v14 offset:26304
    s_waitcnt lgkmcnt(10)
    v_mfma_f32_32x32x16_bf16 v[144:159], v[200:203], v[112:115], v[144:159]
    s_waitcnt lgkmcnt(8)
    v_mfma_f32_32x32x16_bf16 v[160:175], v[204:207], v[112:115], v[160:175]
    s_waitcnt lgkmcnt(6)
    v_mfma_f32_32x32x16_bf16 v[16:31], v[208:211], v[116:119], v[16:31]
    s_waitcnt lgkmcnt(4)
    v_mfma_f32_32x32x16_bf16 v[32:47], v[212:215], v[116:119], v[32:47]
    s_waitcnt lgkmcnt(2)
    v_mfma_f32_32x32x16_bf16 v[144:159], v[216:219], v[116:119], v[144:159]
    s_waitcnt lgkmcnt(0)
    v_mfma_f32_32x32x16_bf16 v[160:175], v[220:223], v[116:119], v[160:175]
    s_waitcnt vmcnt(0)
    s_barrier
    s_cmp_eq_u32 s26, 0
    s_cbranch_scc1 L_nold_3
    s_cmp_ge_u32 s34, s30
    s_cbranch_scc1 L_it_4
    s_and_b32 s38, s34, 3
    s_lshl_b32 s38, s38, 14
    s_add_u32 s38, s38, s37
    s_mov_b32 m0, s38
    s_lshl_b32 s39, s34, 14
    s_add_u32 s39, s39, s36
    buffer_load_dwordx4 v12, s[12:15], s39 offen offset:0 lds
    buffer_load_dwordx4 v12, s[12:15], s39 offen offset:1024 lds
    buffer_load_dwordx4 v12, s[12:15], s39 offen offset:2048 lds
    buffer_load_dwordx4 v12, s[12:15], s39 offen offset:3072 lds
L_it_4:
    s_add_u32 s34, s34, 1
    s_cmp_ge_u32 s34, s30
    s_cbranch_scc1 L_it_5
    s_and_b32 s38, s34, 3
    s_lshl_b32 s38, s38, 14
    s_add_u32 s38, s38, s37
    s_mov_b32 m0, s38
    s_lshl_b32 s39, s34, 14
    s_add_u32 s39, s39, s36
    buffer_load_dwordx4 v12, s[12:15], s39 offen offset:0 lds
    buffer_load_dwordx4 v12, s[12:15], s39 offen offset:1024 lds
    buffer_load_dwordx4 v12, s[12:15], s39 offen offset:2048 lds
    buffer_load_dwordx4 v12, s[12:15], s39 offen offset:3072 lds
L_it_5:
    s_add_u32 s34, s34, 1
    s_cmp_ge_u32 s34, s30
    s_cbranch_scc1 L_it_6
    s_and_b32 s38, s34, 3
    s_lshl_b32 s38, s38, 14
    s_add_u32 s38, s38, s37
    s_mov_b32 m0, s38
    s_lshl_b32 s39, s34, 14
    s_add_u32 s39, s39, s36
    buffer_load_dwordx4 v12, s[12:15], s39 offen offset:0 lds
    buffer_load_dwordx4 v12, s[12:15], s39 offen offset:1024 lds
    buffer_load_dwordx4 v12, s[12:15], s39 offen offset:2048 lds
    buffer_load_dwordx4 v12, s[12:15], s39 offen offset:3072 lds
L_it_6:
    s_add_u32 s34, s34, 1
    s_cmp_ge_u32 s35, s30
    s_cbranch_scc1 L_it_7
    s_and_b32 s38, s35, 3
    s_lshl_b32 s38, s38, 14
    s_add_u32 s38, s38, s37
    s_add_u32 m0, s38, 0x10000
    s_lshl_b32 s39, s35, 14
    s_add_u32 s39, s39, s36
    buffer_load_dwordx4 v12, s[16:19], s39 offen offset:0 lds
    buffer_load_dwordx4 v12, s[16:19], s39 offen offset:1024 lds
    buffer_load_dwordx4 v12, s[16:19], s39 offen offset:2048 lds
    buffer_load_dwordx4 v12, s[16:19], s39 offen offset:3072 lds
L_it_7:
    s_add_u32 s35, s35, 1
    s_cmp_ge_u32 s34, s30
    s_cbranch_scc1 L_it_8
    s_and_b32 s38, s34, 3
    s_lshl_b32 s38, s38, 14
    s_add_u32 s38, s38, s37
    s_mov_b32 m0, s38
    s_lshl_b32 s39, s34, 14
    s_add_u32 s39, s39, s36
    buffer_load_dwordx4 v12, s[12:15], s39 offen offset:0 lds
    buffer_load_dwordx4 v12, s[12:15], s39 offen offset:1024 lds
    buffer_load_dwordx4 v12, s[12:15], s39 offen offset:2048 lds
    buffer_load_dwordx4 v12, s[12:15], s39 offen offset:3072 lds
L_it_8:
    s_add_u32 s34, s34, 1
    s_cmp_ge_u32 s35, s30
    s_cbranch_scc1 L_it_9
    s_and_b32 s38, s35, 3
    s_lshl_b32 s38, s38, 14
    s_add_u32 s38, s38, s37
    s_add_u32 m0, s38, 0x10000
    s_lshl_b32 s39, s35, 14
    s_add_u32 s39, s39, s36
    buffer_load_dwordx4 v12, s[16:19], s39 offen offset:0 lds
    buffer_load_dwordx4 v12, s[16:19], s39 offen offset:1024 lds
    buffer_load_dwordx4 v12, s[16:19], s39 offen offset:2048 lds
    buffer_load_dwordx4 v12, s[16:19], s39 offen offset:3072 lds
L_it_9:
    s_add_u32 s35, s35, 1
    s_branch L_nold2_10
L_nold_3:
    s_load_dwordx2 s[56:57], s[0:1], 40
    s_load_dwordx2 s[58:59], s[0:1], 56
    s_load_dwordx2 s[44:45], s[0:1], 72
    s_lshl_b32 s38, s2, 2
    s_add_u32 s38, s38, s25
    s_lshl_b32 s38, s38, 13
    v_lshlrev_b32 v8, 7, v1
    s_waitcnt lgkmcnt(0)
    s_mov_b32 s4, s56
    s_mov_b32 s5, s57
    s_mov_b32 s6, 0x480000
    s_mov_b32 s7, 0x00020000
    buffer_load_dword v0, v8, s[4:7], s38 offen
    s_mov_b32 s4, s58
    s_mov_b32 s5, s59
    s_mov_b32 s6, 0x510000
    s_mov_b32 s7, 0x00020000
    buffer_load_dword v0, v8, s[4:7], s38 offen
    s_mov_b32 s4, s44
    s_mov_b32 s5, s45
    s_mov_b32 s6, 0x510000
    s_mov_b32 s7, 0x00020000
    buffer_load_dword v0, v8, s[4:7], s38 offen
L_nold2_10:
    ds_read_b64_tr_b16 v[192:193], v14 offset:32768
    ds_read_b64_tr_b16 v[194:195], v14 offset:33024
    ds_read_b64_tr_b16 v[196:197], v14 offset:32832
    ds_read_b64_tr_b16 v[198:199], v14 offset:33088
    ds_read_b64_tr_b16 v[200:201], v14 offset:32896
    ds_read_b64_tr_b16 v[202:203], v14 offset:33152
    ds_read_b64_tr_b16 v[204:205], v14 offset:32960
    ds_read_b64_tr_b16 v[206:207], v14 offset:33216
    ds_read_b64_tr_b16 v[208:209], v14 offset:37120
    ds_read_b64_tr_b16 v[210:211], v14 offset:37376
    ds_read_b64_tr_b16 v[212:213], v14 offset:37184
    ds_read_b64_tr_b16 v[214:215], v14 offset:37440
    s_waitcnt lgkmcnt(10)
    v_mfma_f32_32x32x16_bf16 v[16:31], v[192:195], v[120:123], v[16:31]
    ds_read_b64_tr_b16 v[216:217], v14 offset:37248
    ds_read_b64_tr_b16 v[218:219], v14 offset:37504
    s_waitcnt lgkmcnt(10)
    v_mfma_f32_32x32x16_bf16 v[32:47], v[196:199], v[120:123], v[32:47]
    ds_read_b64_tr_b16 v[220:221], v14 offset:37312
    ds_read_b64_tr_b16 v[222:223], v14 offset:37568
    s_waitcnt lgkmcnt(10)
    v_mfma_f32_32x32x16_bf16 v[144:159], v[200:203], v[120:123], v[144:159]
    ds_read_b64_tr_b16 v[192:193], v14 offset:41472
    ds_read_b64_tr_b16 v[194:195], v14 offset:41728
    s_waitcnt lgkmcnt(10)
    v_mfma_f32_32x32x16_bf16 v[160:175], v[204:207], v[120:123], v[160:175]
    ds_read_b64_tr_b16 v[196:197], v14 offset:41536
    ds_read_b64_tr_b16 v[198:199], v14 offset:41792
    s_waitcnt lgkmcnt(10)
    v_mfma_f32_32x32x16_bf16 v[16:31], v[208:211], v[124:127], v[16:31]
    ds_read_b64_tr_b16 v[200:201], v14 offset:41600
    ds_read_b64_tr_b16 v[202:203], v14 offset:41856
    s_waitcnt lgkmcnt(10)
    v_mfma_f32_32x32x16_bf16 v[32:47], v[212:215], v[124:127], v[32:47]
    ds_read_b64_tr_b16 v[204:205], v14 offset:41664
    ds_read_b64_tr_b16 v[206:207], v14 offset:41920
    s_waitcnt lgkmcnt(10)
    v_mfma_f32_32x32x16_bf16 v[144:159], v[216:219], v[124:127], v[144:159]
    ds_read_b64_tr_b16 v[208:209], v14 offset:45824
    ds_read_b64_tr_b16 v[210:211], v14 offset:46080
    s_waitcnt lgkmcnt(10)
    v_mfma_f32_32x32x16_bf16 v[160:175], v[220:223], v[124:127], v[160:175]
    ds_read_b64_tr_b16 v[212:213], v14 offset:45888
    ds_read_b64_tr_b16 v[214:215], v14 offset:46144
    s_waitcnt lgkmcnt(10)
    v_mfma_f32_32x32x16_bf16 v[16:31], v[192:195], v[128:131], v[16:31]
    ds_read_b64_tr_b16 v[216:217], v14 offset:45952
    ds_read_b64_tr_b16 v[218:219], v14 offset:46208
    s_waitcnt lgkmcnt(10)
    v_mfma_f32_32x32x16_bf16 v[32:47], v[196:199], v[128:131], v[32:47]
    ds_read_b64_tr_b16 v[220:221], v14 offset:46016
    ds_read_b64_tr_b16 v[222:223], v14 offset:46272
    s_waitcnt lgkmcnt(10)
    v_mfma_f32_32x32x16_bf16 v[144:159], v[200:203], v[128:131], v[144:159]
    ds_read_b64_tr_b16 v[192:193], v14 offset:50176
    ds_read_b64_tr_b16 v[194:195], v14 offset:50432
    s_waitcnt lgkmcnt(10)
    v_mfma_f32_32x32x16_bf16 v[160:175], v[204:207], v[128:131], v[160:175]
    ds_read_b64_tr_b16 v[196:197], v14 offset:50240
    ds_read_b64_tr_b16 v[198:199], v14 offset:50496
    s_waitcnt lgkmcnt(10)
    v_mfma_f32_32x32x16_bf16 v[16:31], v[208:211], v[132:135], v[16:31]
    ds_read_b64_tr_b16 v[200:201], v14 offset:50304
    ds_read_b64_tr_b16 v[202:203], v14 offset:50560
    s_waitcnt lgkmcnt(10)
    v_mfma_f32_32x32x16_bf16 v[32:47], v[212:215], v[132:135], v[32:47]
    ds_read_b64_tr_b16 v[204:205], v14 offset:50368
    ds_read_b64_tr_b16 v[206:207], v14 offset:50624
    s_waitcnt lgkmcnt(10)
    v_mfma_f32_32x32x16_bf16 v[144:159], v[216:219], v[132:135], v[144:159]
    ds_read_b64_tr_b16 v[208:209], v14 offset:54528
    ds_read_b64_tr_b16 v[210:211], v14 offset:54784
    s_waitcnt lgkmcnt(10)
    v_mfma_f32_32x32x16_bf16 v[160:175], v[220:223], v[132:135], v[160:175]
    ds_read_b64_tr_b16 v[212:213], v14 offset:54592
    ds_read_b64_tr_b16 v[214:215], v14 offset:54848
    s_waitcnt lgkmcnt(10)
    v_mfma_f32_32x32x16_bf16 v[16:31], v[192:195], v[136:139], v[16:31]
    ds_read_b64_tr_b16 v[216:217], v14 offset:54656
    ds_read_b64_tr_b16 v[218:219], v14 offset:54912
    s_waitcnt lgkmcnt(10)
    v_mfma_f32_32x32x16_bf16 v[32:47], v[196:199], v[136:139], v[32:47]
    ds_read_b64_tr_b16 v[220:221], v14 offset:54720
    ds_read_b64_tr_b16 v[222:223], v14 offset:54976
    s_waitcnt lgkmcnt(10)
    v_mfma_f32_32x32x16_bf16 v[144:159], v[200:203], v[136:139], v[144:159]
    ds_read_b64_tr_b16 v[192:193], v14 offset:58880
    ds_read_b64_tr_b16 v[194:195], v14 offset:59136
    s_waitcnt lgkmcnt(10)
    v_mfma_f32_32x32x16_bf16 v[160:175], v[204:207], v[136:139], v[160:175]
    ds_read_b64_tr_b16 v[196:197], v14 offset:58944
    ds_read_b64_tr_b16 v[198:199], v14 offset:59200
    s_waitcnt lgkmcnt(10)
    v_mfma_f32_32x32x16_bf16 v[16:31], v[208:211], v[140:143], v[16:31]
    ds_read_b64_tr_b16 v[200:201], v14 offset:59008
    ds_read_b64_tr_b16 v[202:203], v14 offset:59264
    s_waitcnt lgkmcnt(10)
    v_mfma_f32_32x32x16_bf16 v[32:47], v[212:215], v[140:143], v[32:47]
    ds_read_b64_tr_b16 v[204:205], v14 offset:59072
    ds_read_b64_tr_b16 v[206:207], v14 offset:59328
    s_waitcnt lgkmcnt(10)
    v_mfma_f32_32x32x16_bf16 v[144:159], v[216:219], v[140:143], v[144:159]
    ds_read_b64_tr_b16 v[208:209], v14 offset:63232
    ds_read_b64_tr_b16 v[210:211], v14 offset:63488
    s_waitcnt lgkmcnt(10)
    v_mfma_f32_32x32x16_bf16 v[160:175], v[220:223], v[140:143], v[160:175]
    ds_read_b64_tr_b16 v[212:213], v14 offset:63296
    ds_read_b64_tr_b16 v[214:215], v14 offset:63552
    s_waitcnt lgkmcnt(10)
    v_mfma_f32_32x32x16_bf16 v[16:31], v[192:195], v[224:227], v[16:31]
    ds_read_b64_tr_b16 v[216:217], v14 offset:63360
    ds_read_b64_tr_b16 v[218:219], v14 offset:63616
    s_waitcnt lgkmcnt(10)
    v_mfma_f32_32x32x16_bf16 v[32:47], v[196:199], v[224:227], v[32:47]
    ds_read_b64_tr_b16 v[220:221], v14 offset:63424
    ds_read_b64_tr_b16 v[222:223], v14 offset:63680
    s_waitcnt lgkmcnt(10)
    v_mfma_f32_32x32x16_bf16 v[144:159], v[200:203], v[224:227], v[144:159]
    ds_read_b64_tr_b16 v[192:193], v15 offset:2048
    ds_read_b64_tr_b16 v[194:195], v15 offset:2304
    s_waitcnt lgkmcnt(10)
    v_mfma_f32_32x32x16_bf16 v[160:175], v[204:207], v[224:227], v[160:175]
    ds_read_b64_tr_b16 v[196:197], v15 offset:2112
    ds_read_b64_tr_b16 v[198:199], v15 offset:2368
    s_waitcnt lgkmcnt(10)
    v_mfma_f32_32x32x16_bf16 v[16:31], v[208:211], v[228:231], v[16:31]
    ds_read_b64_tr_b16 v[200:201], v15 offset:2176
    ds_read_b64_tr_b16 v[202:203], v15 offset:2432
    s_waitcnt lgkmcnt(10)
    v_mfma_f32_32x32x16_bf16 v[32:47], v[212:215], v[228:231], v[32:47]
    ds_read_b64_tr_b16 v[204:205], v15 offset:2240
    ds_read_b64_tr_b16 v[206:207], v15 offset:2496
    s_waitcnt lgkmcnt(10)
    v_mfma_f32_32x32x16_bf16 v[144:159], v[216:219], v[228:231], v[144:159]
    ds_read_b64_tr_b16 v[208:209], v15 offset:6400
    ds_read_b64_tr_b16 v[210:211], v15 offset:6656
    s_waitcnt lgkmcnt(10)
    v_mfma_f32_32x32x16_bf16 v[160:175], v[220:223], v[228:231], v[160:175]
    ds_read_b64_tr_b16 v[212:213], v15 offset:6464
    ds_read_b64_tr_b16 v[214:215], v15 offset:6720
    s_waitcnt lgkmcnt(10)
    v_mfma_f32_32x32x16_bf16 v[16:31], v[192:195], v[232:235], v[16:31]
    ds_read_b64_tr_b16 v[216:217], v15 offset:6528
    ds_read_b64_tr_b16 v[218:219], v15 offset:6784
    s_waitcnt lgkmcnt(10)
    v_mfma_f32_32x32x16_bf16 v[32:47], v[196:199], v[232:235], v[32:47]
    ds_read_b64_tr_b16 v[220:221], v15 offset:6592
    ds_read_b64_tr_b16 v[222:223], v15 offset:6848
    s_waitcnt lgkmcnt(10)
    v_mfma_f32_32x32x16_bf16 v[144:159], v[200:203], v[232:235], v[144:159]
    ds_read_b64_tr_b16 v[192:193], v15 offset:10752
    ds_read_b64_tr_b16 v[194:195], v15 offset:11008
    s_waitcnt lgkmcnt(10)
    v_mfma_f32_32x32x16_bf16 v[160:175], v[204:207], v[232:235], v[160:175]
    ds_read_b64_tr_b16 v[196:197], v15 offset:10816
    ds_read_b64_tr_b16 v[198:199], v15 offset:11072
    s_waitcnt lgkmcnt(10)
    v_mfma_f32_32x32x16_bf16 v[16:31], v[208:211], v[236:239], v[16:31]
    ds_read_b64_tr_b16 v[200:201], v15 offset:10880
    ds_read_b64_tr_b16 v[202:203], v15 offset:11136
    s_waitcnt lgkmcnt(10)
    v_mfma_f32_32x32x16_bf16 v[32:47], v[212:215], v[236:239], v[32:47]
    ds_read_b64_tr_b16 v[204:205], v15 offset:10944
    ds_read_b64_tr_b16 v[206:207], v15 offset:11200
    s_waitcnt lgkmcnt(10)
    v_mfma_f32_32x32x16_bf16 v[144:159], v[216:219], v[236:239], v[144:159]
    ds_read_b64_tr_b16 v[208:209], v15 offset:15104
    ds_read_b64_tr_b16 v[210:211], v15 offset:15360
    s_waitcnt lgkmcnt(10)
    v_mfma_f32_32x32x16_bf16 v[160:175], v[220:223], v[236:239], v[160:175]
    ds_read_b64_tr_b16 v[212:213], v15 offset:15168
    ds_read_b64_tr_b16 v[214:215], v15 offset:15424
    s_waitcnt lgkmcnt(10)
    v_mfma_f32_32x32x16_bf16 v[16:31], v[192:195], v[240:243], v[16:31]
    ds_read_b64_tr_b16 v[216:217], v15 offset:15232
    ds_read_b64_tr_b16 v[218:219], v15 offset:15488
    s_waitcnt lgkmcnt(10)
    v_mfma_f32_32x32x16_bf16 v[32:47], v[196:199], v[240:243], v[32:47]
    ds_read_b64_tr_b16 v[220:221], v15 offset:15296
    ds_read_b64_tr_b16 v[222:223], v15 offset:15552
    s_waitcnt lgkmcnt(10)
    v_mfma_f32_32x32x16_bf16 v[144:159], v[200:203], v[240:243], v[144:159]
    ds_read_b64_tr_b16 v[192:193], v15 offset:19456
    ds_read_b64_tr_b16 v[194:195], v15 offset:19712
    s_waitcnt lgkmcnt(10)
    v_mfma_f32_32x32x16_bf16 v[160:175], v[204:207], v[240:243], v[160:175]
    ds_read_b64_tr_b16 v[196:197], v15 offset:19520
    ds_read_b64_tr_b16 v[198:199], v15 offset:19776
    s_waitcnt lgkmcnt(10)
    v_mfma_f32_32x32x16_bf16 v[16:31], v[208:211], v[244:247], v[16:31]
    ds_read_b64_tr_b16 v[200:201], v15 offset:19584
    ds_read_b64_tr_b16 v[202:203], v15 offset:19840
    s_waitcnt lgkmcnt(10)
    v_mfma_f32_32x32x16_bf16 v[32:47], v[212:215], v[244:247], v[32:47]
    ds_read_b64_tr_b16 v[204:205], v15 offset:19648
    ds_read_b64_tr_b16 v[206:207], v15 offset:19904
    s_waitcnt lgkmcnt(10)
    v_mfma_f32_32x32x16_bf16 v[144:159], v[216:219], v[244:247], v[144:159]
    ds_read_b64_tr_b16 v[208:209], v15 offset:23808
    ds_read_b64_tr_b16 v[210:211], v15 offset:24064
    s_waitcnt lgkmcnt(10)
    v_mfma_f32_32x32x16_bf16 v[160:175], v[220:223], v[244:247], v[160:175]
    ds_read_b64_tr_b16 v[212:213], v15 offset:23872
    ds_read_b64_tr_b16 v[214:215], v15 offset:24128
    s_waitcnt lgkmcnt(10)
    v_mfma_f32_32x32x16_bf16 v[16:31], v[192:195], v[248:251], v[16:31]
    ds_read_b64_tr_b16 v[216:217], v15 offset:23936
    ds_read_b64_tr_b16 v[218:219], v15 offset:24192
    s_waitcnt lgkmcnt(10)
    v_mfma_f32_32x32x16_bf16 v[32:47], v[196:199], v[248:251], v[32:47]
    ds_read_b64_tr_b16 v[220:221], v15 offset:24000
    ds_read_b64_tr_b16 v[222:223], v15 offset:24256
    s_waitcnt lgkmcnt(10)
    v_mfma_f32_32x32x16_bf16 v[144:159], v[200:203], v[248:251], v[144:159]
    s_waitcnt lgkmcnt(8)
    v_mfma_f32_32x32x16_bf16 v[160:175], v[204:207], v[248:251], v[160:175]
    s_waitcnt lgkmcnt(6)
    v_mfma_f32_32x32x16_bf16 v[16:31], v[208:211], v[252:255], v[16:31]
    s_waitcnt lgkmcnt(4)
    v_mfma_f32_32x32x16_bf16 v[32:47], v[212:215], v[252:255], v[32:47]
    s_waitcnt lgkmcnt(2)
    v_mfma_f32_32x32x16_bf16 v[144:159], v[216:219], v[252:255], v[144:159]
    s_waitcnt lgkmcnt(0)
    v_mfma_f32_32x32x16_bf16 v[160:175], v[220:223], v[252:255], v[160:175]
    s_nop 15
    v_mul_f32 v16, s53, v16
    v_mul_f32 v17, s53, v17
    v_mul_f32 v18, s53, v18
    v_mul_f32 v19, s53, v19
    v_mul_f32 v20, s53, v20
    v_mul_f32 v21, s53, v21
    v_mul_f32 v22, s53, v22
    v_mul_f32 v23, s53, v23
    v_cvt_pk_bf16_f32 v16, v16, v17
    v_cvt_pk_bf16_f32 v17, v18, v19
    v_cvt_pk_bf16_f32 v18, v20, v21
    v_cvt_pk_bf16_f32 v19, v22, v23
    v_mul_f32 v24, s53, v24
    v_mul_f32 v25, s53, v25
    v_mul_f32 v26, s53, v26
    v_mul_f32 v27, s53, v27
    v_mul_f32 v28, s53, v28
    v_mul_f32 v29, s53, v29
    v_mul_f32 v30, s53, v30
    v_mul_f32 v31, s53, v31
    v_cvt_pk_bf16_f32 v20, v24, v25
    v_cvt_pk_bf16_f32 v21, v26, v27
    v_cvt_pk_bf16_f32 v22, v28, v29
    v_cvt_pk_bf16_f32 v23, v30, v31
    v_mul_f32 v32, s53, v32
    v_mul_f32 v33, s53, v33
    v_mul_f32 v34, s53, v34
    v_mul_f32 v35, s53, v35
    v_mul_f32 v36, s53, v36
    v_mul_f32 v37, s53, v37
    v_mul_f32 v38, s53, v38
    v_mul_f32 v39, s53, v39
    v_cvt_pk_bf16_f32 v24, v32, v33
    v_cvt_pk_bf16_f32 v25, v34, v35
    v_cvt_pk_bf16_f32 v26, v36, v37
    v_cvt_pk_bf16_f32 v27, v38, v39
    v_mul_f32 v40, s53, v40
    v_mul_f32 v41, s53, v41
    v_mul_f32 v42, s53, v42
    v_mul_f32 v43, s53, v43
    v_mul_f32 v44, s53, v44
    v_mul_f32 v45, s53, v45
    v_mul_f32 v46, s53, v46
    v_mul_f32 v47, s53, v47
    v_cvt_pk_bf16_f32 v28, v40, v41
    v_cvt_pk_bf16_f32 v29, v42, v43
    v_cvt_pk_bf16_f32 v30, v44, v45
    v_cvt_pk_bf16_f32 v31, v46, v47
    v_mul_f32 v144, s53, v144
    v_mul_f32 v145, s53, v145
    v_mul_f32 v146, s53, v146
    v_mul_f32 v147, s53, v147
    v_mul_f32 v148, s53, v148
    v_mul_f32 v149, s53, v149
    v_mul_f32 v150, s53, v150
    v_mul_f32 v151, s53, v151
    v_cvt_pk_bf16_f32 v32, v144, v145
    v_cvt_pk_bf16_f32 v33, v146, v147
    v_cvt_pk_bf16_f32 v34, v148, v149
    v_cvt_pk_bf16_f32 v35, v150, v151
    v_mul_f32 v152, s53, v152
    v_mul_f32 v153, s53, v153
    v_mul_f32 v154, s53, v154
    v_mul_f32 v155, s53, v155
    v_mul_f32 v156, s53, v156
    v_mul_f32 v157, s53, v157
    v_mul_f32 v158, s53, v158
    v_mul_f32 v159, s53, v159
    v_cvt_pk_bf16_f32 v36, v152, v153
    v_cvt_pk_bf16_f32 v37, v154, v155
    v_cvt_pk_bf16_f32 v38, v156, v157
    v_cvt_pk_bf16_f32 v39, v158, v159
    v_mul_f32 v160, s53, v160
    v_mul_f32 v161, s53, v161
    v_mul_f32 v162, s53, v162
    v_mul_f32 v163, s53, v163
    v_mul_f32 v164, s53, v164
    v_mul_f32 v165, s53, v165
    v_mul_f32 v166, s53, v166
    v_mul_f32 v167, s53, v167
    v_cvt_pk_bf16_f32 v40, v160, v161
    v_cvt_pk_bf16_f32 v41, v162, v163
    v_cvt_pk_bf16_f32 v42, v164, v165
    v_cvt_pk_bf16_f32 v43, v166, v167
    v_mul_f32 v168, s53, v168
    v_mul_f32 v169, s53, v169
    v_mul_f32 v170, s53, v170
    v_mul_f32 v171, s53, v171
    v_mul_f32 v172, s53, v172
    v_mul_f32 v173, s53, v173
    v_mul_f32 v174, s53, v174
    v_mul_f32 v175, s53, v175
    v_cvt_pk_bf16_f32 v44, v168, v169
    v_cvt_pk_bf16_f32 v45, v170, v171
    v_cvt_pk_bf16_f32 v46, v172, v173
    v_cvt_pk_bf16_f32 v47, v174, v175
    v_mov_b32 v48, 0
    v_mov_b32 v49, 0
    v_mov_b32 v50, 0
    v_mov_b32 v51, 0
    v_mov_b32 v52, 0
    v_mov_b32 v53, 0
    v_mov_b32 v54, 0
    v_mov_b32 v55, 0
    v_mov_b32 v56, 0
    v_mov_b32 v57, 0
    v_mov_b32 v58, 0
    v_mov_b32 v59, 0
    v_mov_b32 v60, 0
    v_mov_b32 v61, 0
    v_mov_b32 v62, 0
    v_mov_b32 v63, 0
    v_mov_b32 v64, 0
    v_mov_b32 v65, 0
    v_mov_b32 v66, 0
    v_mov_b32 v67, 0
    v_mov_b32 v68, 0
    v_mov_b32 v69, 0
    v_mov_b32 v70, 0
    v_mov_b32 v71, 0
    v_mov_b32 v72, 0
    v_mov_b32 v73, 0
    v_mov_b32 v74, 0
    v_mov_b32 v75, 0
    v_mov_b32 v76, 0
    v_mov_b32 v77, 0
    v_mov_b32 v78, 0
    v_mov_b32 v79, 0
    v_mov_b32 v80, 0
    v_mov_b32 v81, 0
    v_mov_b32 v82, 0
    v_mov_b32 v83, 0
    v_mov_b32 v84, 0
    v_mov_b32 v85, 0
    v_mov_b32 v86, 0
    v_mov_b32 v87, 0
    v_mov_b32 v88, 0
    v_mov_b32 v89, 0
    v_mov_b32 v90, 0
    v_mov_b32 v91, 0
    v_mov_b32 v92, 0
    v_mov_b32 v93, 0
    v_mov_b32 v94, 0
    v_mov_b32 v95, 0
    v_mov_b32 v96, 0
    v_mov_b32 v97, 0
    v_mov_b32 v98, 0
    v_mov_b32 v99, 0
    v_mov_b32 v100, 0
    v_mov_b32 v101, 0
    v_mov_b32 v102, 0
    v_mov_b32 v103, 0
    v_mov_b32 v104, 0
    v_mov_b32 v105, 0
    v_mov_b32 v106, 0
    v_mov_b32 v107, 0
    v_mov_b32 v108, 0
    v_mov_b32 v109, 0
    v_mov_b32 v110, 0
    v_mov_b32 v111, 0
    v_mov_b32 v176, 0
    v_mov_b32 v177, 0
    v_mov_b32 v178, 0
    v_mov_b32 v179, 0
    v_mov_b32 v180, 0
    v_mov_b32 v181, 0
    v_mov_b32 v182, 0
    v_mov_b32 v183, 0
    v_mov_b32 v184, 0
    v_mov_b32 v185, 0
    v_mov_b32 v186, 0
    v_mov_b32 v187, 0
    v_mov_b32 v188, 0
    v_mov_b32 v189, 0
    v_mov_b32 v190, 0
    v_mov_b32 v191, 0
    v_mov_b32 v6, 0
    v_mov_b32 v7, 0
    v_mov_b32 v4, v2
    s_mov_b32 s31, -1
    s_mov_b32 s32, 0x4000
    s_mov_b32 s33, 0
    s_waitcnt vmcnt(20)
    s_barrier
    s_cmp_eq_u32 s26, 0
    s_cbranch_scc1 L_attn_B
    ds_read_b128 v[192:195], v4 offset:0
    ds_read_b128 v[196:199], v4 offset:2048
    ds_read_b128 v[200:203], v4 offset:4096
    ds_read_b128 v[204:207], v4 offset:6144
    ds_read_b128 v[208:211], v4 offset:8192
    ds_read_b128 v[212:215], v4 offset:10240
    ds_read_b128 v[216:219], v4 offset:12288
    ds_read_b128 v[220:223], v4 offset:14336
    s_waitcnt lgkmcnt(7)
    v_mfma_f32_32x32x16_bf16 v[112:127], v[192:195], v[16:19], v[176:191]
    ds_read_b128 v[224:227], v4 offset:512
    s_waitcnt lgkmcnt(7)
    v_mfma_f32_32x32x16_bf16 v[112:127], v[196:199], v[20:23], v[112:127]
    ds_read_b128 v[228:231], v4 offset:2560
    s_waitcnt lgkmcnt(7)
    v_mfma_f32_32x32x16_bf16 v[112:127], v[200:203], v[24:27], v[112:127]
    ds_read_b128 v[232:235], v4 offset:4608
    s_waitcnt lgkmcnt(7)
    v_mfma_f32_32x32x16_bf16 v[112:127], v[204:207], v[28:31], v[112:127]
    ds_read_b128 v[236:239], v4 offset:6656
    s_waitcnt lgkmcnt(7)
    v_mfma_f32_32x32x16_bf16 v[112:127], v[208:211], v[32:35], v[112:127]
    ds_read_b128 v[240:243], v4 offset:8704
    s_waitcnt lgkmcnt(7)
    v_mfma_f32_32x32x16_bf16 v[112:127], v[212:215], v[36:39], v[112:127]
    ds_read_b128 v[244:247], v4 offset:10752
    s_waitcnt lgkmcnt(7)
    v_mfma_f32_32x32x16_bf16 v[112:127], v[216:219], v[40:43], v[112:127]
    ds_read_b128 v[248:251], v4 offset:12800
    s_waitcnt lgkmcnt(7)
    v_mfma_f32_32x32x16_bf16 v[112:127], v[220:223], v[44:47], v[112:127]
    ds_read_b128 v[252:255], v4 offset:14848
    s_waitcnt lgkmcnt(7)
    v_mfma_f32_32x32x16_bf16 v[128:143], v[224:227], v[16:19], v[176:191]
    s_waitcnt lgkmcnt(6)
    v_mfma_f32_32x32x16_bf16 v[128:143], v[228:231], v[20:23], v[128:143]
    s_waitcnt lgkmcnt(5)
    v_mfma_f32_32x32x16_bf16 v[128:143], v[232:235], v[24:27], v[128:143]
    s_waitcnt lgkmcnt(4)
    v_mfma_f32_32x32x16_bf16 v[128:143], v[236:239], v[28:31], v[128:143]
    s_waitcnt lgkmcnt(3)
    v_mfma_f32_32x32x16_bf16 v[128:143], v[240:243], v[32:35], v[128:143]
    s_waitcnt lgkmcnt(2)
    v_mfma_f32_32x32x16_bf16 v[128:143], v[244:247], v[36:39], v[128:143]
    s_waitcnt lgkmcnt(1)
    v_mfma_f32_32x32x16_bf16 v[128:143], v[248:251], v[40:43], v[128:143]
    s_waitcnt lgkmcnt(0)
    v_mfma_f32_32x32x16_bf16 v[128:143], v[252:255], v[44:47], v[128:143]
    s_add_u32 s38, s31, 4
    s_cmp_ge_i32 s38, s30
    s_cbranch_scc1 L_w0_11
L_w0b_12:
    s_waitcnt vmcnt(8)
    s_barrier
    s_cmp_ge_u32 s34, s30
    s_cbranch_scc1 L_it_13
    s_and_b32 s38, s34, 3
    s_lshl_b32 s38, s38, 14
    s_add_u32 s38, s38, s37
    s_mov_b32 m0, s38
    s_lshl_b32 s39, s34, 14
    s_add_u32 s39, s39, s36
    buffer_load_dwordx4 v12, s[12:15], s39 offen offset:0 lds
    buffer_load_dwordx4 v12, s[12:15], s39 offen offset:1024 lds
    buffer_load_dwordx4 v12, s[12:15], s39 offen offset:2048 lds
    buffer_load_dwordx4 v12, s[12:15], s39 offen offset:3072 lds
L_it_13:
    s_add_u32 s34, s34, 1
    s_cmp_ge_u32 s35, s30
    s_cbranch_scc1 L_it_14
    s_and_b32 s38, s35, 3
    s_lshl_b32 s38, s38, 14
    s_add_u32 s38, s38, s37
    s_add_u32 m0, s38, 0x10000
    s_lshl_b32 s39, s35, 14
    s_add_u32 s39, s39, s36
    buffer_load_dwordx4 v12, s[16:19], s39 offen offset:0 lds
    buffer_load_dwordx4 v12, s[16:19], s39 offen offset:1024 lds
    buffer_load_dwordx4 v12, s[16:19], s39 offen offset:2048 lds
    buffer_load_dwordx4 v12, s[16:19], s39 offen offset:3072 lds
L_it_14:
    s_add_u32 s35, s35, 1
    v_add_u32 v4, s32, v2
    ds_read_b128 v[192:195], v4 offset:0
    ds_read_b128 v[196:199], v4 offset:2048
    ds_read_b128 v[200:203], v4 offset:4096
    ds_read_b128 v[204:207], v4 offset:6144
    ds_read_b128 v[208:211], v4 offset:8192
    ds_read_b128 v[212:215], v4 offset:10240
    ds_read_b128 v[216:219], v4 offset:12288
    ds_read_b128 v[220:223], v4 offset:14336
    s_add_u32 s32, s32, 0x4000
    s_nop 7
    s_add_u32 s38, s31, 2
    s_cmp_eq_u32 s38, s29
    s_cbranch_scc1 L_mask_15
L_maskb_16:
    v_max3_f32 v8, v112, v113, v114
    v_max3_f32 v8, v8, v115, v116
    v_max3_f32 v8, v8, v117, v118
    v_max3_f32 v8, v8, v119, v120
    v_max3_f32 v8, v8, v121, v122
    v_max3_f32 v8, v8, v123, v124
    v_max3_f32 v8, v8, v125, v126
    v_max_f32 v8, v8, v127
    v_max3_f32 v9, v128, v129, v130
    v_max3_f32 v9, v9, v131, v132
    v_max3_f32 v9, v9, v133, v134
    v_max3_f32 v9, v9, v135, v136
    v_max3_f32 v9, v9, v137, v138
    v_max3_f32 v9, v9, v139, v140
    v_max3_f32 v9, v9, v141, v142
    v_max_f32 v9, v9, v143
    v_max_f32 v8, v8, v9
    v_mov_b32 v9, v8
    s_nop 1
    v_permlane32_swap_b32 v8, v9
    s_nop 1
    v_max_f32 v8, v8, v9
    v_sub_f32 v112, v112, v8
    v_sub_f32 v113, v113, v8
    v_sub_f32 v114, v114, v8
    v_sub_f32 v115, v115, v8
    v_sub_f32 v116, v116, v8
    v_sub_f32 v117, v117, v8
    v_sub_f32 v118, v118, v8
    v_sub_f32 v119, v119, v8
    v_sub_f32 v120, v120, v8
    v_sub_f32 v121, v121, v8
    v_sub_f32 v122, v122, v8
    v_sub_f32 v123, v123, v8
    v_sub_f32 v124, v124, v8
    v_sub_f32 v125, v125, v8
    v_sub_f32 v126, v126, v8
    v_sub_f32 v127, v127, v8
    v_sub_f32 v128, v128, v8
    v_sub_f32 v129, v129, v8
    v_sub_f32 v130, v130, v8
    v_sub_f32 v131, v131, v8
    v_sub_f32 v132, v132, v8
    v_sub_f32 v133, v133, v8
    v_sub_f32 v134, v134, v8
    v_sub_f32 v135, v135, v8
    v_sub_f32 v136, v136, v8
    v_sub_f32 v137, v137, v8
    v_sub_f32 v138, v138, v8
    v_sub_f32 v139, v139, v8
    v_sub_f32 v140, v140, v8
    v_sub_f32 v141, v141, v8
    v_sub_f32 v142, v142, v8
    v_sub_f32 v143, v143, v8
    v_sub_f32 v176, 0, v8
    v_sub_f32 v177, 0, v8
    v_sub_f32 v178, 0, v8
    v_sub_f32 v179, 0, v8
    v_sub_f32 v180, 0, v8
    v_sub_f32 v181, 0, v8
    v_sub_f32 v182, 0, v8
    v_sub_f32 v183, 0, v8
    v_sub_f32 v184, 0, v8
    v_sub_f32 v185, 0, v8
    v_sub_f32 v186, 0, v8
    v_sub_f32 v187, 0, v8
    v_sub_f32 v188, 0, v8
    v_sub_f32 v189, 0, v8
    v_sub_f32 v190, 0, v8
    v_sub_f32 v191, 0, v8
    s_mov_b32 s31, 0
    s_cmp_eq_u32 s29, 1
    s_cbranch_scc1 L_attn_ep0A
L_attn_loopA:
    v_add_u32 v5, s33, v3
    s_waitcnt lgkmcnt(4)
    v_mfma_f32_32x32x16_bf16 v[144:159], v[192:195], v[16:19], v[176:191]
    ds_read_b128 v[224:227], v4 offset:512
    v_exp_f32 v112, v112
    v_exp_f32 v113, v113
    v_exp_f32 v114, v114
    v_exp_f32 v115, v115
    v_mfma_f32_32x32x16_bf16 v[144:159], v[196:199], v[20:23], v[144:159]
    ds_read_b128 v[228:231], v4 offset:2560
    v_exp_f32 v116, v116
    v_exp_f32 v117, v117
    v_exp_f32 v118, v118
    v_mfma_f32_32x32x16_bf16 v[144:159], v[200:203], v[24:27], v[144:159]
    ds_read_b128 v[232:235], v4 offset:4608
    v_exp_f32 v119, v119
    v_add_f32 v6, v6, v112
    v_add_f32 v7, v7, v113
    v_mfma_f32_32x32x16_bf16 v[144:159], v[204:207], v[28:31], v[144:159]
    ds_read_b128 v[236:239], v4 offset:6656
    v_add_f32 v6, v6, v114
    v_add_f32 v7, v7, v115
    v_add_f32 v6, v6, v116
    v_add_f32 v7, v7, v117
    s_waitcnt lgkmcnt(4)
    v_mfma_f32_32x32x16_bf16 v[144:159], v[208:211], v[32:35], v[144:159]
    ds_read_b128 v[240:243], v4 offset:8704
    v_add_f32 v6, v6, v118
    v_add_f32 v7, v7, v119
    v_cvt_pk_bf16_f32 v112, v112, v113
    v_mfma_f32_32x32x16_bf16 v[144:159], v[212:215], v[36:39], v[144:159]
    ds_read_b128 v[244:247], v4 offset:10752
    v_cvt_pk_bf16_f32 v113, v114, v115
    v_cvt_pk_bf16_f32 v114, v116, v117
    v_cvt_pk_bf16_f32 v115, v118, v119
    v_mfma_f32_32x32x16_bf16 v[144:159], v[216:219], v[40:43], v[144:159]
    ds_read_b128 v[248:251], v4 offset:12800
    v_exp_f32 v120, v120
    v_exp_f32 v121, v121
    v_exp_f32 v122, v122
    v_exp_f32 v123, v123
    v_mfma_f32_32x32x16_bf16 v[144:159], v[220:223], v[44:47], v[144:159]
    ds_read_b128 v[252:255], v4 offset:14848
    v_exp_f32 v124, v124
    v_exp_f32 v125, v125
    v_exp_f32 v126, v126
    s_waitcnt lgkmcnt(4)
    v_mfma_f32_32x32x16_bf16 v[160:175], v[224:227], v[16:19], v[176:191]
    ds_read_b128 v[192:195], v5 offset:0
    v_exp_f32 v127, v127
    v_add_f32 v6, v6, v120
    v_add_f32 v7, v7, v121
    v_mfma_f32_32x32x16_bf16 v[160:175], v[228:231], v[20:23], v[160:175]
    ds_read_b128 v[196:199], v5 offset:512
    v_add_f32 v6, v6, v122
    v_add_f32 v7, v7, v123
    v_add_f32 v6, v6, v124
    v_add_f32 v7, v7, v125
    v_mfma_f32_32x32x16_bf16 v[160:175], v[232:235], v[24:27], v[160:175]
    ds_read_b128 v[200:203], v5 offset:1024
    v_add_f32 v6, v6, v126
    v_add_f32 v7, v7, v127
    v_cvt_pk_bf16_f32 v116, v120, v121
    v_mfma_f32_32x32x16_bf16 v[160:175], v[236:239], v[28:31], v[160:175]
    ds_read_b128 v[204:207], v5 offset:1536
    v_cvt_pk_bf16_f32 v117, v122, v123
    v_cvt_pk_bf16_f32 v118, v124, v125
    v_cvt_pk_bf16_f32 v119, v126, v127
    s_waitcnt lgkmcnt(4)
    v_mfma_f32_32x32x16_bf16 v[160:175], v[240:243], v[32:35], v[160:175]
    ds_read_b128 v[208:211], v5 offset:4096
    v_exp_f32 v128, v128
    v_exp_f32 v129, v129
    v_exp_f32 v130, v130
    v_exp_f32 v131, v131
    v_mfma_f32_32x32x16_bf16 v[160:175], v[244:247], v[36:39], v[160:175]
    ds_read_b128 v[212:215], v5 offset:4608
    v_exp_f32 v132, v132
    v_exp_f32 v133, v133
    v_exp_f32 v134, v134
    v_mfma_f32_32x32x16_bf16 v[160:175], v[248:251], v[40:43], v[160:175]
    ds_read_b128 v[216:219], v5 offset:5120
    v_exp_f32 v135, v135
    v_add_f32 v6, v6, v128
    v_add_f32 v7, v7, v129
    v_mfma_f32_32x32x16_bf16 v[160:175], v[252:255], v[44:47], v[160:175]
    ds_read_b128 v[220:223], v5 offset:5632
    v_add_f32 v6, v6, v130
    v_add_f32 v7, v7, v131
    v_add_f32 v6, v6, v132
    v_add_f32 v7, v7, v133
    s_add_u32 s38, s31, 4
    s_cmp_ge_i32 s38, s30
    s_cbranch_scc1 L_w0_17
L_w0b_18:
    s_waitcnt vmcnt(8)
    s_barrier
    s_cmp_ge_u32 s34, s30
    s_cbranch_scc1 L_it_19
    s_and_b32 s38, s34, 3
    s_lshl_b32 s38, s38, 14
    s_add_u32 s38, s38, s37
    s_mov_b32 m0, s38
    s_lshl_b32 s39, s34, 14
    s_add_u32 s39, s39, s36
    buffer_load_dwordx4 v12, s[12:15], s39 offen offset:0 lds
    buffer_load_dwordx4 v12, s[12:15], s39 offen offset:1024 lds
    buffer_load_dwordx4 v12, s[12:15], s39 offen offset:2048 lds
    buffer_load_dwordx4 v12, s[12:15], s39 offen offset:3072 lds
L_it_19:
    s_add_u32 s34, s34, 1
    s_cmp_ge_u32 s35, s30
    s_cbranch_scc1 L_it_20
    s_and_b32 s38, s35, 3
    s_lshl_b32 s38, s38, 14
    s_add_u32 s38, s38, s37
    s_add_u32 m0, s38, 0x10000
    s_lshl_b32 s39, s35, 14
    s_add_u32 s39, s39, s36
    buffer_load_dwordx4 v12, s[16:19], s39 offen offset:0 lds
    buffer_load_dwordx4 v12, s[16:19], s39 offen offset:1024 lds
    buffer_load_dwordx4 v12, s[16:19], s39 offen offset:2048 lds
    buffer_load_dwordx4 v12, s[16:19], s39 offen offset:3072 lds
L_it_20:
    s_add_u32 s35, s35, 1
    v_add_u32 v4, s32, v2
    s_waitcnt lgkmcnt(4)
    v_mfma_f32_32x32x16_bf16 v[48:63], v[192:195], v[112:115], v[48:63]
    ds_read_b128 v[224:227], v5 offset:8192
    v_add_f32 v6, v6, v134
    v_add_f32 v7, v7, v135
    v_cvt_pk_bf16_f32 v128, v128, v129
    v_mfma_f32_32x32x16_bf16 v[64:79], v[196:199], v[112:115], v[64:79]
    ds_read_b128 v[228:231], v5 offset:8704
    v_cvt_pk_bf16_f32 v129, v130, v131
    v_cvt_pk_bf16_f32 v130, v132, v133
    v_cvt_pk_bf16_f32 v131, v134, v135
    v_mfma_f32_32x32x16_bf16 v[80:95], v[200:203], v[112:115], v[80:95]
    ds_read_b128 v[232:235], v5 offset:9216
    v_exp_f32 v136, v136
    v_exp_f32 v137, v137
    v_exp_f32 v138, v138
    v_exp_f32 v139, v139
    v_mfma_f32_32x32x16_bf16 v[96:111], v[204:207], v[112:115], v[96:111]
    ds_read_b128 v[236:239], v5 offset:9728
    v_exp_f32 v140, v140
    v_exp_f32 v141, v141
    v_exp_f32 v142, v142
    s_waitcnt lgkmcnt(4)
    v_mfma_f32_32x32x16_bf16 v[48:63], v[208:211], v[116:119], v[48:63]
    ds_read_b128 v[240:243], v5 offset:12288
    v_exp_f32 v143, v143
    v_add_f32 v6, v6, v136
    v_add_f32 v7, v7, v137
    v_mfma_f32_32x32x16_bf16 v[64:79], v[212:215], v[116:119], v[64:79]
    ds_read_b128 v[244:247], v5 offset:12800
    v_add_f32 v6, v6, v138
    v_add_f32 v7, v7, v139
    v_add_f32 v6, v6, v140
    v_add_f32 v7, v7, v141
    v_mfma_f32_32x32x16_bf16 v[80:95], v[216:219], v[116:119], v[80:95]
    ds_read_b128 v[248:251], v5 offset:13312
    v_add_f32 v6, v6, v142
    v_add_f32 v7, v7, v143
    v_cvt_pk_bf16_f32 v132, v136, v137
    v_mfma_f32_32x32x16_bf16 v[96:111], v[220:223], v[116:119], v[96:111]
    ds_read_b128 v[252:255], v5 offset:13824
    v_cvt_pk_bf16_f32 v133, v138, v139
    v_cvt_pk_bf16_f32 v134, v140, v141
    v_cvt_pk_bf16_f32 v135, v142, v143
    s_add_u32 s38, s31, 2
    s_cmp_eq_u32 s38, s29
    s_cbranch_scc1 L_mask_21
L_maskb_22:
    s_waitcnt lgkmcnt(4)
    v_mfma_f32_32x32x16_bf16 v[48:63], v[224:227], v[128:131], v[48:63]
    ds_read_b128 v[192:195], v4 offset:0
    v_max3_f32 v8, v144, v145, v146
    v_max3_f32 v8, v8, v147, v148
    v_max3_f32 v8, v8, v149, v150
    v_mfma_f32_32x32x16_bf16 v[64:79], v[228:231], v[128:131], v[64:79]
    ds_read_b128 v[196:199], v4 offset:2048
    v_max3_f32 v8, v8, v151, v152
    v_max3_f32 v8, v8, v153, v154
    v_max3_f32 v8, v8, v155, v156
    v_mfma_f32_32x32x16_bf16 v[80:95], v[232:235], v[128:131], v[80:95]
    ds_read_b128 v[200:203], v4 offset:4096
    v_max3_f32 v8, v8, v157, v158
    v_max_f32 v8, v8, v159
    v_max3_f32 v9, v160, v161, v162
    v_mfma_f32_32x32x16_bf16 v[96:111], v[236:239], v[128:131], v[96:111]
    ds_read_b128 v[204:207], v4 offset:6144
    v_max3_f32 v9, v9, v163, v164
    v_max3_f32 v9, v9, v165, v166
    s_waitcnt lgkmcnt(4)
    v_mfma_f32_32x32x16_bf16 v[48:63], v[240:243], v[132:135], v[48:63]
    ds_read_b128 v[208:211], v4 offset:8192
    v_max3_f32 v9, v9, v167, v168
    v_max3_f32 v9, v9, v169, v170
    v_max3_f32 v9, v9, v171, v172
    v_mfma_f32_32x32x16_bf16 v[64:79], v[244:247], v[132:135], v[64:79]
    ds_read_b128 v[212:215], v4 offset:10240
    v_max3_f32 v9, v9, v173, v174
    v_max_f32 v9, v9, v175
    v_max_f32 v8, v8, v9
    v_mfma_f32_32x32x16_bf16 v[80:95], v[248:251], v[132:135], v[80:95]
    ds_read_b128 v[216:219], v4 offset:12288
    v_mov_b32 v9, v8
    s_nop 1
    v_permlane32_swap_b32 v8, v9
    v_mfma_f32_32x32x16_bf16 v[96:111], v[252:255], v[132:135], v[96:111]
    ds_read_b128 v[220:223], v4 offset:14336
    s_nop 1
    v_max_f32 v8, v8, v9
    s_add_u32 s32, s32, 0x4000
    s_and_b32 s32, s32, 0xffff
    s_add_u32 s33, s33, 0x4000
    s_and_b32 s33, s33, 0xffff
    v_cmp_lt_f32 vcc, s52, v8
    s_nop 1
    s_cbranch_vccnz L_rs_23
L_rsb_24:
    s_add_u32 s31, s31, 1
    s_add_u32 s38, s31, 1
    s_cmp_eq_u32 s38, s29
    s_cbranch_scc1 L_attn_ep1A
    v_add_u32 v5, s33, v3
    s_waitcnt lgkmcnt(4)
    v_mfma_f32_32x32x16_bf16 v[112:127], v[192:195], v[16:19], v[176:191]
    ds_read_b128 v[224:227], v4 offset:512
    v_exp_f32 v144, v144
    v_exp_f32 v145, v145
    v_exp_f32 v146, v146
    v_exp_f32 v147, v147
    v_mfma_f32_32x32x16_bf16 v[112:127], v[196:199], v[20:23], v[112:127]
    ds_read_b128 v[228:231], v4 offset:2560
    v_exp_f32 v148, v148
    v_exp_f32 v149, v149
    v_exp_f32 v150, v150
    v_mfma_f32_32x32x16_bf16 v[112:127], v[200:203], v[24:27], v[112:127]
    ds_read_b128 v[232:235], v4 offset:4608
    v_exp_f32 v151, v151
    v_add_f32 v6, v6, v144
    v_add_f32 v7, v7, v145
    v_mfma_f32_32x32x16_bf16 v[112:127], v[204:207], v[28:31], v[112:127]
    ds_read_b128 v[236:239], v4 offset:6656
    v_add_f32 v6, v6, v146
    v_add_f32 v7, v7, v147
    v_add_f32 v6, v6, v148
    v_add_f32 v7, v7, v149
    s_waitcnt lgkmcnt(4)
    v_mfma_f32_32x32x16_bf16 v[112:127], v[208:211], v[32:35], v[112:127]
    ds_read_b128 v[240:243], v4 offset:8704
    v_add_f32 v6, v6, v150
    v_add_f32 v7, v7, v151
    v_cvt_pk_bf16_f32 v144, v144, v145
    v_mfma_f32_32x32x16_bf16 v[112:127], v[212:215], v[36:39], v[112:127]
    ds_read_b128 v[244:247], v4 offset:10752
    v_cvt_pk_bf16_f32 v145, v146, v147
    v_cvt_pk_bf16_f32 v146, v148, v149
    v_cvt_pk_bf16_f32 v147, v150, v151
    v_mfma_f32_32x32x16_bf16 v[112:127], v[216:219], v[40:43], v[112:127]
    ds_read_b128 v[248:251], v4 offset:12800
    v_exp_f32 v152, v152
    v_exp_f32 v153, v153
    v_exp_f32 v154, v154
    v_exp_f32 v155, v155
    v_mfma_f32_32x32x16_bf16 v[112:127], v[220:223], v[44:47], v[112:127]
    ds_read_b128 v[252:255], v4 offset:14848
    v_exp_f32 v156, v156
    v_exp_f32 v157, v157
    v_exp_f32 v158, v158
    s_waitcnt lgkmcnt(4)
    v_mfma_f32_32x32x16_bf16 v[128:143], v[224:227], v[16:19], v[176:191]
    ds_read_b128 v[192:195], v5 offset:0
    v_exp_f32 v159, v159
    v_add_f32 v6, v6, v152
    v_add_f32 v7, v7, v153
    v_mfma_f32_32x32x16_bf16 v[128:143], v[228:231], v[20:23], v[128:143]
    ds_read_b128 v[196:199], v5 offset:512
    v_add_f32 v6, v6, v154
    v_add_f32 v7, v7, v155
    v_add_f32 v6, v6, v156
    v_add_f32 v7, v7, v157
    v_mfma_f32_32x32x16_bf16 v[128:143], v[232:235], v[24:27], v[128:143]
    ds_read_b128 v[200:203], v5 offset:1024
    v_add_f32 v6, v6, v158
    v_add_f32 v7, v7, v159
    v_cvt_pk_bf16_f32 v148, v152, v153
    v_mfma_f32_32x32x16_bf16 v[128:143], v[236:239], v[28:31], v[128:143]
    ds_read_b128 v[204:207], v5 offset:1536
    v_cvt_pk_bf16_f32 v149, v154, v155
    v_cvt_pk_bf16_f32 v150, v156, v157
    v_cvt_pk_bf16_f32 v151, v158, v159
    s_waitcnt lgkmcnt(4)
    v_mfma_f32_32x32x16_bf16 v[128:143], v[240:243], v[32:35], v[128:143]
    ds_read_b128 v[208:211], v5 offset:4096
    v_exp_f32 v160, v160
    v_exp_f32 v161, v161
    v_exp_f32 v162, v162
    v_exp_f32 v163, v163
    v_mfma_f32_32x32x16_bf16 v[128:143], v[244:247], v[36:39], v[128:143]
    ds_read_b128 v[212:215], v5 offset:4608
    v_exp_f32 v164, v164
    v_exp_f32 v165, v165
    v_exp_f32 v166, v166
    v_mfma_f32_32x32x16_bf16 v[128:143], v[248:251], v[40:43], v[128:143]
    ds_read_b128 v[216:219], v5 offset:5120
    v_exp_f32 v167, v167
    v_add_f32 v6, v6, v160
    v_add_f32 v7, v7, v161
    v_mfma_f32_32x32x16_bf16 v[128:143], v[252:255], v[44:47], v[128:143]
    ds_read_b128 v[220:223], v5 offset:5632
    v_add_f32 v6, v6, v162
    v_add_f32 v7, v7, v163
    v_add_f32 v6, v6, v164
    v_add_f32 v7, v7, v165
    s_add_u32 s38, s31, 4
    s_cmp_ge_i32 s38, s30
    s_cbranch_scc1 L_w0_25
L_w0b_26:
    s_waitcnt vmcnt(8)
    s_barrier
    s_cmp_ge_u32 s34, s30
    s_cbranch_scc1 L_it_27
    s_and_b32 s38, s34, 3
    s_lshl_b32 s38, s38, 14
    s_add_u32 s38, s38, s37
    s_mov_b32 m0, s38
    s_lshl_b32 s39, s34, 14
    s_add_u32 s39, s39, s36
    buffer_load_dwordx4 v12, s[12:15], s39 offen offset:0 lds
    buffer_load_dwordx4 v12, s[12:15], s39 offen offset:1024 lds
    buffer_load_dwordx4 v12, s[12:15], s39 offen offset:2048 lds
    buffer_load_dwordx4 v12, s[12:15], s39 offen offset:3072 lds
L_it_27:
    s_add_u32 s34, s34, 1
    s_cmp_ge_u32 s35, s30
    s_cbranch_scc1 L_it_28
    s_and_b32 s38, s35, 3
    s_lshl_b32 s38, s38, 14
    s_add_u32 s38, s38, s37
    s_add_u32 m0, s38, 0x10000
    s_lshl_b32 s39, s35, 14
    s_add_u32 s39, s39, s36
    buffer_load_dwordx4 v12, s[16:19], s39 offen offset:0 lds
    buffer_load_dwordx4 v12, s[16:19], s39 offen offset:1024 lds
    buffer_load_dwordx4 v12, s[16:19], s39 offen offset:2048 lds
    buffer_load_dwordx4 v12, s[16:19], s39 offen offset:3072 lds
L_it_28:
    s_add_u32 s35, s35, 1
    v_add_u32 v4, s32, v2
    s_waitcnt lgkmcnt(4)
    v_mfma_f32_32x32x16_bf16 v[48:63], v[192:195], v[144:147], v[48:63]
    ds_read_b128 v[224:227], v5 offset:8192
    v_add_f32 v6, v6, v166
    v_add_f32 v7, v7, v167
    v_cvt_pk_bf16_f32 v160, v160, v161
    v_mfma_f32_32x32x16_bf16 v[64:79], v[196:199], v[144:147], v[64:79]
    ds_read_b128 v[228:231], v5 offset:8704
    v_cvt_pk_bf16_f32 v161, v162, v163
    v_cvt_pk_bf16_f32 v162, v164, v165
    v_cvt_pk_bf16_f32 v163, v166, v167
    v_mfma_f32_32x32x16_bf16 v[80:95], v[200:203], v[144:147], v[80:95]
    ds_read_b128 v[232:235], v5 offset:9216
    v_exp_f32 v168, v168
    v_exp_f32 v169, v169
    v_exp_f32 v170, v170
    v_exp_f32 v171, v171
    v_mfma_f32_32x32x16_bf16 v[96:111], v[204:207], v[144:147], v[96:111]
    ds_read_b128 v[236:239], v5 offset:9728
    v_exp_f32 v172, v172
    v_exp_f32 v173, v173
    v_exp_f32 v174, v174
    s_waitcnt lgkmcnt(4)
    v_mfma_f32_32x32x16_bf16 v[48:63], v[208:211], v[148:151], v[48:63]
    ds_read_b128 v[240:243], v5 offset:12288
    v_exp_f32 v175, v175
    v_add_f32 v6, v6, v168
    v_add_f32 v7, v7, v169
    v_mfma_f32_32x32x16_bf16 v[64:79], v[212:215], v[148:151], v[64:79]
    ds_read_b128 v[244:247], v5 offset:12800
    v_add_f32 v6, v6, v170
    v_add_f32 v7, v7, v171
    v_add_f32 v6, v6, v172
    v_add_f32 v7, v7, v173
    v_mfma_f32_32x32x16_bf16 v[80:95], v[216:219], v[148:151], v[80:95]
    ds_read_b128 v[248:251], v5 offset:13312
    v_add_f32 v6, v6, v174
    v_add_f32 v7, v7, v175
    v_cvt_pk_bf16_f32 v164, v168, v169
    v_mfma_f32_32x32x16_bf16 v[96:111], v[220:223], v[148:151], v[96:111]
    ds_read_b128 v[252:255], v5 offset:13824
    v_cvt_pk_bf16_f32 v165, v170, v171
    v_cvt_pk_bf16_f32 v166, v172, v173
    v_cvt_pk_bf16_f32 v167, v174, v175
    s_add_u32 s38, s31, 2
    s_cmp_eq_u32 s38, s29
    s_cbranch_scc1 L_mask_29
L_maskb_30:
    s_waitcnt lgkmcnt(4)
    v_mfma_f32_32x32x16_bf16 v[48:63], v[224:227], v[160:163], v[48:63]
    ds_read_b128 v[192:195], v4 offset:0
    v_max3_f32 v8, v112, v113, v114
    v_max3_f32 v8, v8, v115, v116
    v_max3_f32 v8, v8, v117, v118
    v_mfma_f32_32x32x16_bf16 v[64:79], v[228:231], v[160:163], v[64:79]
    ds_read_b128 v[196:199], v4 offset:2048
    v_max3_f32 v8, v8, v119, v120
    v_max3_f32 v8, v8, v121, v122
    v_max3_f32 v8, v8, v123, v124
    v_mfma_f32_32x32x16_bf16 v[80:95], v[232:235], v[160:163], v[80:95]
    ds_read_b128 v[200:203], v4 offset:4096
    v_max3_f32 v8, v8, v125, v126
    v_max_f32 v8, v8, v127
    v_max3_f32 v9, v128, v129, v130
    v_mfma_f32_32x32x16_bf16 v[96:111], v[236:239], v[160:163], v[96:111]
    ds_read_b128 v[204:207], v4 offset:6144
    v_max3_f32 v9, v9, v131, v132
    v_max3_f32 v9, v9, v133, v134
    s_waitcnt lgkmcnt(4)
    v_mfma_f32_32x32x16_bf16 v[48:63], v[240:243], v[164:167], v[48:63]
    ds_read_b128 v[208:211], v4 offset:8192
    v_max3_f32 v9, v9, v135, v136
    v_max3_f32 v9, v9, v137, v138
    v_max3_f32 v9, v9, v139, v140
    v_mfma_f32_32x32x16_bf16 v[64:79], v[244:247], v[164:167], v[64:79]
    ds_read_b128 v[212:215], v4 offset:10240
    v_max3_f32 v9, v9, v141, v142
    v_max_f32 v9, v9, v143
    v_max_f32 v8, v8, v9
    v_mfma_f32_32x32x16_bf16 v[80:95], v[248:251], v[164:167], v[80:95]
    ds_read_b128 v[216:219], v4 offset:12288
    v_mov_b32 v9, v8
    s_nop 1
    v_permlane32_swap_b32 v8, v9
    v_mfma_f32_32x32x16_bf16 v[96:111], v[252:255], v[164:167], v[96:111]
    ds_read_b128 v[220:223], v4 offset:14336
    s_nop 1
    v_max_f32 v8, v8, v9
    s_add_u32 s32, s32, 0x4000
    s_and_b32 s32, s32, 0xffff
    s_add_u32 s33, s33, 0x4000
    s_and_b32 s33, s33, 0xffff
    v_cmp_lt_f32 vcc, s52, v8
    s_nop 1
    s_cbranch_vccnz L_rs_31
L_rsb_32:
    s_add_u32 s31, s31, 1
    s_add_u32 s38, s31, 1
    s_cmp_lg_u32 s38, s29
    s_cbranch_scc1 L_attn_loopA
L_attn_ep0A:
    s_add_u32 s38, s31, 4
    s_cmp_ge_i32 s38, s30
    s_cbranch_scc1 L_w0_33
L_w0b_34:
    s_waitcnt vmcnt(8)
    s_barrier
    s_cmp_ge_u32 s34, s30
    s_cbranch_scc1 L_it_35
    s_and_b32 s38, s34, 3
    s_lshl_b32 s38, s38, 14
    s_add_u32 s38, s38, s37
    s_mov_b32 m0, s38
    s_lshl_b32 s39, s34, 14
    s_add_u32 s39, s39, s36
    buffer_load_dwordx4 v12, s[12:15], s39 offen offset:0 lds
    buffer_load_dwordx4 v12, s[12:15], s39 offen offset:1024 lds
    buffer_load_dwordx4 v12, s[12:15], s39 offen offset:2048 lds
    buffer_load_dwordx4 v12, s[12:15], s39 offen offset:3072 lds
L_it_35:
    s_add_u32 s34, s34, 1
    s_cmp_ge_u32 s35, s30
    s_cbranch_scc1 L_it_36
    s_and_b32 s38, s35, 3
    s_lshl_b32 s38, s38, 14
    s_add_u32 s38, s38, s37
    s_add_u32 m0, s38, 0x10000
    s_lshl_b32 s39, s35, 14
    s_add_u32 s39, s39, s36
    buffer_load_dwordx4 v12, s[16:19], s39 offen offset:0 lds
    buffer_load_dwordx4 v12, s[16:19], s39 offen offset:1024 lds
    buffer_load_dwordx4 v12, s[16:19], s39 offen offset:2048 lds
    buffer_load_dwordx4 v12, s[16:19], s39 offen offset:3072 lds
L_it_36:
    s_add_u32 s35, s35, 1
    s_add_u32 s31, s31, 1
    s_waitcnt lgkmcnt(0)
    v_add_u32 v5, s33, v3
    ds_read_b128 v[192:195], v5 offset:0
    ds_read_b128 v[196:199], v5 offset:512
    ds_read_b128 v[200:203], v5 offset:1024
    ds_read_b128 v[204:207], v5 offset:1536
    ds_read_b128 v[208:211], v5 offset:4096
    ds_read_b128 v[212:215], v5 offset:4608
    ds_read_b128 v[216:219], v5 offset:5120
    ds_read_b128 v[220:223], v5 offset:5632
    v_exp_f32 v112, v112
    v_exp_f32 v113, v113
    v_exp_f32 v114, v114
    v_exp_f32 v115, v115
    v_exp_f32 v116, v116
    v_exp_f32 v117, v117
    v_exp_f32 v118, v118
    v_exp_f32 v119, v119
    v_add_f32 v6, v6, v112
    v_add_f32 v7, v7, v113
    v_add_f32 v6, v6, v114
    v_add_f32 v7, v7, v115
    v_add_f32 v6, v6, v116
    v_add_f32 v7, v7, v117
    v_add_f32 v6, v6, v118
    v_add_f32 v7, v7, v119
    v_cvt_pk_bf16_f32 v112, v112, v113
    v_cvt_pk_bf16_f32 v113, v114, v115
    v_cvt_pk_bf16_f32 v114, v116, v117
    v_cvt_pk_bf16_f32 v115, v118, v119
    v_exp_f32 v120, v120
    v_exp_f32 v121, v121
    v_exp_f32 v122, v122
    v_exp_f32 v123, v123
    v_exp_f32 v124, v124
    v_exp_f32 v125, v125
    v_exp_f32 v126, v126
    v_exp_f32 v127, v127
    v_add_f32 v6, v6, v120
    v_add_f32 v7, v7, v121
    v_add_f32 v6, v6, v122
    v_add_f32 v7, v7, v123
    v_add_f32 v6, v6, v124
    v_add_f32 v7, v7, v125
    v_add_f32 v6, v6, v126
    v_add_f32 v7, v7, v127
    v_cvt_pk_bf16_f32 v116, v120, v121
    v_cvt_pk_bf16_f32 v117, v122, v123
    v_cvt_pk_bf16_f32 v118, v124, v125
    v_cvt_pk_bf16_f32 v119, v126, v127
    v_exp_f32 v128, v128
    v_exp_f32 v129, v129
    v_exp_f32 v130, v130
    v_exp_f32 v131, v131
    v_exp_f32 v132, v132
    v_exp_f32 v133, v133
    v_exp_f32 v134, v134
    v_exp_f32 v135, v135
    v_add_f32 v6, v6, v128
    v_add_f32 v7, v7, v129
    v_add_f32 v6, v6, v130
    v_add_f32 v7, v7, v131
    v_add_f32 v6, v6, v132
    v_add_f32 v7, v7, v133
    v_add_f32 v6, v6, v134
    v_add_f32 v7, v7, v135
    v_cvt_pk_bf16_f32 v128, v128, v129
    v_cvt_pk_bf16_f32 v129, v130, v131
    v_cvt_pk_bf16_f32 v130, v132, v133
    v_cvt_pk_bf16_f32 v131, v134, v135
    v_exp_f32 v136, v136
    v_exp_f32 v137, v137
    v_exp_f32 v138, v138
    v_exp_f32 v139, v139
    v_exp_f32 v140, v140
    v_exp_f32 v141, v141
    v_exp_f32 v142, v142
    v_exp_f32 v143, v143
    v_add_f32 v6, v6, v136
    v_add_f32 v7, v7, v137
    v_add_f32 v6, v6, v138
    v_add_f32 v7, v7, v139
    v_add_f32 v6, v6, v140
    v_add_f32 v7, v7, v141
    v_add_f32 v6, v6, v142
    v_add_f32 v7, v7, v143
    v_cvt_pk_bf16_f32 v132, v136, v137
    v_cvt_pk_bf16_f32 v133, v138, v139
    v_cvt_pk_bf16_f32 v134, v140, v141
    v_cvt_pk_bf16_f32 v135, v142, v143
    s_waitcnt lgkmcnt(7)
    v_mfma_f32_32x32x16_bf16 v[48:63], v[192:195], v[112:115], v[48:63]
    ds_read_b128 v[224:227], v5 offset:8192
    s_waitcnt lgkmcnt(7)
    v_mfma_f32_32x32x16_bf16 v[64:79], v[196:199], v[112:115], v[64:79]
    ds_read_b128 v[228:231], v5 offset:8704
    s_waitcnt lgkmcnt(7)
    v_mfma_f32_32x32x16_bf16 v[80:95], v[200:203], v[112:115], v[80:95]
    ds_read_b128 v[232:235], v5 offset:9216
    s_waitcnt lgkmcnt(7)
    v_mfma_f32_32x32x16_bf16 v[96:111], v[204:207], v[112:115], v[96:111]
    ds_read_b128 v[236:239], v5 offset:9728
    s_waitcnt lgkmcnt(7)
    v_mfma_f32_32x32x16_bf16 v[48:63], v[208:211], v[116:119], v[48:63]
    ds_read_b128 v[240:243], v5 offset:12288
    s_waitcnt lgkmcnt(7)
    v_mfma_f32_32x32x16_bf16 v[64:79], v[212:215], v[116:119], v[64:79]
    ds_read_b128 v[244:247], v5 offset:12800
    s_waitcnt lgkmcnt(7)
    v_mfma_f32_32x32x16_bf16 v[80:95], v[216:219], v[116:119], v[80:95]
    ds_read_b128 v[248:251], v5 offset:13312
    s_waitcnt lgkmcnt(7)
    v_mfma_f32_32x32x16_bf16 v[96:111], v[220:223], v[116:119], v[96:111]
    ds_read_b128 v[252:255], v5 offset:13824
    s_waitcnt lgkmcnt(7)
    v_mfma_f32_32x32x16_bf16 v[48:63], v[224:227], v[128:131], v[48:63]
    s_waitcnt lgkmcnt(6)
    v_mfma_f32_32x32x16_bf16 v[64:79], v[228:231], v[128:131], v[64:79]
    s_waitcnt lgkmcnt(5)
    v_mfma_f32_32x32x16_bf16 v[80:95], v[232:235], v[128:131], v[80:95]
    s_waitcnt lgkmcnt(4)
    v_mfma_f32_32x32x16_bf16 v[96:111], v[236:239], v[128:131], v[96:111]
    s_waitcnt lgkmcnt(3)
    v_mfma_f32_32x32x16_bf16 v[48:63], v[240:243], v[132:135], v[48:63]
    s_waitcnt lgkmcnt(2)
    v_mfma_f32_32x32x16_bf16 v[64:79], v[244:247], v[132:135], v[64:79]
    s_waitcnt lgkmcnt(1)
    v_mfma_f32_32x32x16_bf16 v[80:95], v[248:251], v[132:135], v[80:95]
    s_waitcnt lgkmcnt(0)
    v_mfma_f32_32x32x16_bf16 v[96:111], v[252:255], v[132:135], v[96:111]
    v_add_f32 v6, v6, v7
    v_mov_b32 v7, v6
    s_nop 1
    v_permlane32_swap_b32 v6, v7
    s_nop 1
    v_add_f32 v6, v6, v7
    v_rcp_f32 v6, v6
    v_and_b32 v8, 31, v1
    v_add_u32 v8, s28, v8
    v_lshrrev_b32 v9, 4, v8
    v_lshlrev_b32 v9, 17, v9
    v_and_b32 v8, 15, v8
    v_lshl_add_u32 v8, v8, 4, v9
    v_lshrrev_b32 v9, 5, v1
    v_lshl_add_u32 v8, v9, 8, v8
    s_lshl_b32 s38, s27, 12
    s_nop 7
    v_mul_f32 v48, v48, v6
    v_mul_f32 v49, v49, v6
    v_mul_f32 v50, v50, v6
    v_mul_f32 v51, v51, v6
    v_mul_f32 v52, v52, v6
    v_mul_f32 v53, v53, v6
    v_mul_f32 v54, v54, v6
    v_mul_f32 v55, v55, v6
    v_cvt_pk_bf16_f32 v48, v48, v49
    v_cvt_pk_bf16_f32 v49, v50, v51
    v_cvt_pk_bf16_f32 v50, v52, v53
    v_cvt_pk_bf16_f32 v51, v54, v55
    buffer_store_dwordx4 v[48:51], v8, s[20:23], s38 offen offset:0 sc0 sc1
    v_mul_f32 v56, v56, v6
    v_mul_f32 v57, v57, v6
    v_mul_f32 v58, v58, v6
    v_mul_f32 v59, v59, v6
    v_mul_f32 v60, v60, v6
    v_mul_f32 v61, v61, v6
    v_mul_f32 v62, v62, v6
    v_mul_f32 v63, v63, v6
    v_cvt_pk_bf16_f32 v56, v56, v57
    v_cvt_pk_bf16_f32 v57, v58, v59
    v_cvt_pk_bf16_f32 v58, v60, v61
    v_cvt_pk_bf16_f32 v59, v62, v63
    buffer_store_dwordx4 v[56:59], v8, s[20:23], s38 offen offset:512 sc0 sc1
    v_mul_f32 v64, v64, v6
    v_mul_f32 v65, v65, v6
    v_mul_f32 v66, v66, v6
    v_mul_f32 v67, v67, v6
    v_mul_f32 v68, v68, v6
    v_mul_f32 v69, v69, v6
    v_mul_f32 v70, v70, v6
    v_mul_f32 v71, v71, v6
    v_cvt_pk_bf16_f32 v64, v64, v65
    v_cvt_pk_bf16_f32 v65, v66, v67
    v_cvt_pk_bf16_f32 v66, v68, v69
    v_cvt_pk_bf16_f32 v67, v70, v71
    buffer_store_dwordx4 v[64:67], v8, s[20:23], s38 offen offset:1024 sc0 sc1
    v_mul_f32 v72, v72, v6
    v_mul_f32 v73, v73, v6
    v_mul_f32 v74, v74, v6
    v_mul_f32 v75, v75, v6
    v_mul_f32 v76, v76, v6
    v_mul_f32 v77, v77, v6
    v_mul_f32 v78, v78, v6
    v_mul_f32 v79, v79, v6
    v_cvt_pk_bf16_f32 v72, v72, v73
    v_cvt_pk_bf16_f32 v73, v74, v75
    v_cvt_pk_bf16_f32 v74, v76, v77
    v_cvt_pk_bf16_f32 v75, v78, v79
    buffer_store_dwordx4 v[72:75], v8, s[20:23], s38 offen offset:1536 sc0 sc1
    v_mul_f32 v80, v80, v6
    v_mul_f32 v81, v81, v6
    v_mul_f32 v82, v82, v6
    v_mul_f32 v83, v83, v6
    v_mul_f32 v84, v84, v6
    v_mul_f32 v85, v85, v6
    v_mul_f32 v86, v86, v6
    v_mul_f32 v87, v87, v6
    v_cvt_pk_bf16_f32 v80, v80, v81
    v_cvt_pk_bf16_f32 v81, v82, v83
    v_cvt_pk_bf16_f32 v82, v84, v85
    v_cvt_pk_bf16_f32 v83, v86, v87
    buffer_store_dwordx4 v[80:83], v8, s[20:23], s38 offen offset:2048 sc0 sc1
    v_mul_f32 v88, v88, v6
    v_mul_f32 v89, v89, v6
    v_mul_f32 v90, v90, v6
    v_mul_f32 v91, v91, v6
    v_mul_f32 v92, v92, v6
    v_mul_f32 v93, v93, v6
    v_mul_f32 v94, v94, v6
    v_mul_f32 v95, v95, v6
    v_cvt_pk_bf16_f32 v88, v88, v89
    v_cvt_pk_bf16_f32 v89, v90, v91
    v_cvt_pk_bf16_f32 v90, v92, v93
    v_cvt_pk_bf16_f32 v91, v94, v95
    buffer_store_dwordx4 v[88:91], v8, s[20:23], s38 offen offset:2560 sc0 sc1
    v_mul_f32 v96, v96, v6
    v_mul_f32 v97, v97, v6
    v_mul_f32 v98, v98, v6
    v_mul_f32 v99, v99, v6
    v_mul_f32 v100, v100, v6
    v_mul_f32 v101, v101, v6
    v_mul_f32 v102, v102, v6
    v_mul_f32 v103, v103, v6
    v_cvt_pk_bf16_f32 v96, v96, v97
    v_cvt_pk_bf16_f32 v97, v98, v99
    v_cvt_pk_bf16_f32 v98, v100, v101
    v_cvt_pk_bf16_f32 v99, v102, v103
    buffer_store_dwordx4 v[96:99], v8, s[20:23], s38 offen offset:3072 sc0 sc1
    v_mul_f32 v104, v104, v6
    v_mul_f32 v105, v105, v6
    v_mul_f32 v106, v106, v6
    v_mul_f32 v107, v107, v6
    v_mul_f32 v108, v108, v6
    v_mul_f32 v109, v109, v6
    v_mul_f32 v110, v110, v6
    v_mul_f32 v111, v111, v6
    v_cvt_pk_bf16_f32 v104, v104, v105
    v_cvt_pk_bf16_f32 v105, v106, v107
    v_cvt_pk_bf16_f32 v106, v108, v109
    v_cvt_pk_bf16_f32 v107, v110, v111
    buffer_store_dwordx4 v[104:107], v8, s[20:23], s38 offen offset:3584 sc0 sc1
    s_branch L_attn_doneA
L_attn_ep1A:
    s_add_u32 s38, s31, 4
    s_cmp_ge_i32 s38, s30
    s_cbranch_scc1 L_w0_37
L_w0b_38:
    s_waitcnt vmcnt(8)
    s_barrier
    s_cmp_ge_u32 s34, s30
    s_cbranch_scc1 L_it_39
    s_and_b32 s38, s34, 3
    s_lshl_b32 s38, s38, 14
    s_add_u32 s38, s38, s37
    s_mov_b32 m0, s38
    s_lshl_b32 s39, s34, 14
    s_add_u32 s39, s39, s36
    buffer_load_dwordx4 v12, s[12:15], s39 offen offset:0 lds
    buffer_load_dwordx4 v12, s[12:15], s39 offen offset:1024 lds
    buffer_load_dwordx4 v12, s[12:15], s39 offen offset:2048 lds
    buffer_load_dwordx4 v12, s[12:15], s39 offen offset:3072 lds
L_it_39:
    s_add_u32 s34, s34, 1
    s_cmp_ge_u32 s35, s30
    s_cbranch_scc1 L_it_40
    s_and_b32 s38, s35, 3
    s_lshl_b32 s38, s38, 14
    s_add_u32 s38, s38, s37
    s_add_u32 m0, s38, 0x10000
    s_lshl_b32 s39, s35, 14
    s_add_u32 s39, s39, s36
    buffer_load_dwordx4 v12, s[16:19], s39 offen offset:0 lds
    buffer_load_dwordx4 v12, s[16:19], s39 offen offset:1024 lds
    buffer_load_dwordx4 v12, s[16:19], s39 offen offset:2048 lds
    buffer_load_dwordx4 v12, s[16:19], s39 offen offset:3072 lds
L_it_40:
    s_add_u32 s35, s35, 1
    s_add_u32 s31, s31, 1
    s_waitcnt lgkmcnt(0)
    v_add_u32 v5, s33, v3
    ds_read_b128 v[192:195], v5 offset:0
    ds_read_b128 v[196:199], v5 offset:512
    ds_read_b128 v[200:203], v5 offset:1024
    ds_read_b128 v[204:207], v5 offset:1536
    ds_read_b128 v[208:211], v5 offset:4096
    ds_read_b128 v[212:215], v5 offset:4608
    ds_read_b128 v[216:219], v5 offset:5120
    ds_read_b128 v[220:223], v5 offset:5632
    v_exp_f32 v144, v144
    v_exp_f32 v145, v145
    v_exp_f32 v146, v146
    v_exp_f32 v147, v147
    v_exp_f32 v148, v148
    v_exp_f32 v149, v149
    v_exp_f32 v150, v150
    v_exp_f32 v151, v151
    v_add_f32 v6, v6, v144
    v_add_f32 v7, v7, v145
    v_add_f32 v6, v6, v146
    v_add_f32 v7, v7, v147
    v_add_f32 v6, v6, v148
    v_add_f32 v7, v7, v149
    v_add_f32 v6, v6, v150
    v_add_f32 v7, v7, v151
    v_cvt_pk_bf16_f32 v144, v144, v145
    v_cvt_pk_bf16_f32 v145, v146, v147
    v_cvt_pk_bf16_f32 v146, v148, v149
    v_cvt_pk_bf16_f32 v147, v150, v151
    v_exp_f32 v152, v152
    v_exp_f32 v153, v153
    v_exp_f32 v154, v154
    v_exp_f32 v155, v155
    v_exp_f32 v156, v156
    v_exp_f32 v157, v157
    v_exp_f32 v158, v158
    v_exp_f32 v159, v159
    v_add_f32 v6, v6, v152
    v_add_f32 v7, v7, v153
    v_add_f32 v6, v6, v154
    v_add_f32 v7, v7, v155
    v_add_f32 v6, v6, v156
    v_add_f32 v7, v7, v157
    v_add_f32 v6, v6, v158
    v_add_f32 v7, v7, v159
    v_cvt_pk_bf16_f32 v148, v152, v153
    v_cvt_pk_bf16_f32 v149, v154, v155
    v_cvt_pk_bf16_f32 v150, v156, v157
    v_cvt_pk_bf16_f32 v151, v158, v159
    v_exp_f32 v160, v160
    v_exp_f32 v161, v161
    v_exp_f32 v162, v162
    v_exp_f32 v163, v163
    v_exp_f32 v164, v164
    v_exp_f32 v165, v165
    v_exp_f32 v166, v166
    v_exp_f32 v167, v167
    v_add_f32 v6, v6, v160
    v_add_f32 v7, v7, v161
    v_add_f32 v6, v6, v162
    v_add_f32 v7, v7, v163
    v_add_f32 v6, v6, v164
    v_add_f32 v7, v7, v165
    v_add_f32 v6, v6, v166
    v_add_f32 v7, v7, v167
    v_cvt_pk_bf16_f32 v160, v160, v161
    v_cvt_pk_bf16_f32 v161, v162, v163
    v_cvt_pk_bf16_f32 v162, v164, v165
    v_cvt_pk_bf16_f32 v163, v166, v167
    v_exp_f32 v168, v168
    v_exp_f32 v169, v169
    v_exp_f32 v170, v170
    v_exp_f32 v171, v171
    v_exp_f32 v172, v172
    v_exp_f32 v173, v173
    v_exp_f32 v174, v174
    v_exp_f32 v175, v175
    v_add_f32 v6, v6, v168
    v_add_f32 v7, v7, v169
    v_add_f32 v6, v6, v170
    v_add_f32 v7, v7, v171
    v_add_f32 v6, v6, v172
    v_add_f32 v7, v7, v173
    v_add_f32 v6, v6, v174
    v_add_f32 v7, v7, v175
    v_cvt_pk_bf16_f32 v164, v168, v169
    v_cvt_pk_bf16_f32 v165, v170, v171
    v_cvt_pk_bf16_f32 v166, v172, v173
    v_cvt_pk_bf16_f32 v167, v174, v175
    s_waitcnt lgkmcnt(7)
    v_mfma_f32_32x32x16_bf16 v[48:63], v[192:195], v[144:147], v[48:63]
    ds_read_b128 v[224:227], v5 offset:8192
    s_waitcnt lgkmcnt(7)
    v_mfma_f32_32x32x16_bf16 v[64:79], v[196:199], v[144:147], v[64:79]
    ds_read_b128 v[228:231], v5 offset:8704
    s_waitcnt lgkmcnt(7)
    v_mfma_f32_32x32x16_bf16 v[80:95], v[200:203], v[144:147], v[80:95]
    ds_read_b128 v[232:235], v5 offset:9216
    s_waitcnt lgkmcnt(7)
    v_mfma_f32_32x32x16_bf16 v[96:111], v[204:207], v[144:147], v[96:111]
    ds_read_b128 v[236:239], v5 offset:9728
    s_waitcnt lgkmcnt(7)
    v_mfma_f32_32x32x16_bf16 v[48:63], v[208:211], v[148:151], v[48:63]
    ds_read_b128 v[240:243], v5 offset:12288
    s_waitcnt lgkmcnt(7)
    v_mfma_f32_32x32x16_bf16 v[64:79], v[212:215], v[148:151], v[64:79]
    ds_read_b128 v[244:247], v5 offset:12800
    s_waitcnt lgkmcnt(7)
    v_mfma_f32_32x32x16_bf16 v[80:95], v[216:219], v[148:151], v[80:95]
    ds_read_b128 v[248:251], v5 offset:13312
    s_waitcnt lgkmcnt(7)
    v_mfma_f32_32x32x16_bf16 v[96:111], v[220:223], v[148:151], v[96:111]
    ds_read_b128 v[252:255], v5 offset:13824
    s_waitcnt lgkmcnt(7)
    v_mfma_f32_32x32x16_bf16 v[48:63], v[224:227], v[160:163], v[48:63]
    s_waitcnt lgkmcnt(6)
    v_mfma_f32_32x32x16_bf16 v[64:79], v[228:231], v[160:163], v[64:79]
    s_waitcnt lgkmcnt(5)
    v_mfma_f32_32x32x16_bf16 v[80:95], v[232:235], v[160:163], v[80:95]
    s_waitcnt lgkmcnt(4)
    v_mfma_f32_32x32x16_bf16 v[96:111], v[236:239], v[160:163], v[96:111]
    s_waitcnt lgkmcnt(3)
    v_mfma_f32_32x32x16_bf16 v[48:63], v[240:243], v[164:167], v[48:63]
    s_waitcnt lgkmcnt(2)
    v_mfma_f32_32x32x16_bf16 v[64:79], v[244:247], v[164:167], v[64:79]
    s_waitcnt lgkmcnt(1)
    v_mfma_f32_32x32x16_bf16 v[80:95], v[248:251], v[164:167], v[80:95]
    s_waitcnt lgkmcnt(0)
    v_mfma_f32_32x32x16_bf16 v[96:111], v[252:255], v[164:167], v[96:111]
    v_add_f32 v6, v6, v7
    v_mov_b32 v7, v6
    s_nop 1
    v_permlane32_swap_b32 v6, v7
    s_nop 1
    v_add_f32 v6, v6, v7
    v_rcp_f32 v6, v6
    v_and_b32 v8, 31, v1
    v_add_u32 v8, s28, v8
    v_lshrrev_b32 v9, 4, v8
    v_lshlrev_b32 v9, 17, v9
    v_and_b32 v8, 15, v8
    v_lshl_add_u32 v8, v8, 4, v9
    v_lshrrev_b32 v9, 5, v1
    v_lshl_add_u32 v8, v9, 8, v8
    s_lshl_b32 s38, s27, 12
    s_nop 7
    v_mul_f32 v48, v48, v6
    v_mul_f32 v49, v49, v6
    v_mul_f32 v50, v50, v6
    v_mul_f32 v51, v51, v6
    v_mul_f32 v52, v52, v6
    v_mul_f32 v53, v53, v6
    v_mul_f32 v54, v54, v6
    v_mul_f32 v55, v55, v6
    v_cvt_pk_bf16_f32 v48, v48, v49
    v_cvt_pk_bf16_f32 v49, v50, v51
    v_cvt_pk_bf16_f32 v50, v52, v53
    v_cvt_pk_bf16_f32 v51, v54, v55
    buffer_store_dwordx4 v[48:51], v8, s[20:23], s38 offen offset:0 sc0 sc1
    v_mul_f32 v56, v56, v6
    v_mul_f32 v57, v57, v6
    v_mul_f32 v58, v58, v6
    v_mul_f32 v59, v59, v6
    v_mul_f32 v60, v60, v6
    v_mul_f32 v61, v61, v6
    v_mul_f32 v62, v62, v6
    v_mul_f32 v63, v63, v6
    v_cvt_pk_bf16_f32 v56, v56, v57
    v_cvt_pk_bf16_f32 v57, v58, v59
    v_cvt_pk_bf16_f32 v58, v60, v61
    v_cvt_pk_bf16_f32 v59, v62, v63
    buffer_store_dwordx4 v[56:59], v8, s[20:23], s38 offen offset:512 sc0 sc1
    v_mul_f32 v64, v64, v6
    v_mul_f32 v65, v65, v6
    v_mul_f32 v66, v66, v6
    v_mul_f32 v67, v67, v6
    v_mul_f32 v68, v68, v6
    v_mul_f32 v69, v69, v6
    v_mul_f32 v70, v70, v6
    v_mul_f32 v71, v71, v6
    v_cvt_pk_bf16_f32 v64, v64, v65
    v_cvt_pk_bf16_f32 v65, v66, v67
    v_cvt_pk_bf16_f32 v66, v68, v69
    v_cvt_pk_bf16_f32 v67, v70, v71
    buffer_store_dwordx4 v[64:67], v8, s[20:23], s38 offen offset:1024 sc0 sc1
    v_mul_f32 v72, v72, v6
    v_mul_f32 v73, v73, v6
    v_mul_f32 v74, v74, v6
    v_mul_f32 v75, v75, v6
    v_mul_f32 v76, v76, v6
    v_mul_f32 v77, v77, v6
    v_mul_f32 v78, v78, v6
    v_mul_f32 v79, v79, v6
    v_cvt_pk_bf16_f32 v72, v72, v73
    v_cvt_pk_bf16_f32 v73, v74, v75
    v_cvt_pk_bf16_f32 v74, v76, v77
    v_cvt_pk_bf16_f32 v75, v78, v79
    buffer_store_dwordx4 v[72:75], v8, s[20:23], s38 offen offset:1536 sc0 sc1
    v_mul_f32 v80, v80, v6
    v_mul_f32 v81, v81, v6
    v_mul_f32 v82, v82, v6
    v_mul_f32 v83, v83, v6
    v_mul_f32 v84, v84, v6
    v_mul_f32 v85, v85, v6
    v_mul_f32 v86, v86, v6
    v_mul_f32 v87, v87, v6
    v_cvt_pk_bf16_f32 v80, v80, v81
    v_cvt_pk_bf16_f32 v81, v82, v83
    v_cvt_pk_bf16_f32 v82, v84, v85
    v_cvt_pk_bf16_f32 v83, v86, v87
    buffer_store_dwordx4 v[80:83], v8, s[20:23], s38 offen offset:2048 sc0 sc1
    v_mul_f32 v88, v88, v6
    v_mul_f32 v89, v89, v6
    v_mul_f32 v90, v90, v6
    v_mul_f32 v91, v91, v6
    v_mul_f32 v92, v92, v6
    v_mul_f32 v93, v93, v6
    v_mul_f32 v94, v94, v6
    v_mul_f32 v95, v95, v6
    v_cvt_pk_bf16_f32 v88, v88, v89
    v_cvt_pk_bf16_f32 v89, v90, v91
    v_cvt_pk_bf16_f32 v90, v92, v93
    v_cvt_pk_bf16_f32 v91, v94, v95
    buffer_store_dwordx4 v[88:91], v8, s[20:23], s38 offen offset:2560 sc0 sc1
    v_mul_f32 v96, v96, v6
    v_mul_f32 v97, v97, v6
    v_mul_f32 v98, v98, v6
    v_mul_f32 v99, v99, v6
    v_mul_f32 v100, v100, v6
    v_mul_f32 v101, v101, v6
    v_mul_f32 v102, v102, v6
    v_mul_f32 v103, v103, v6
    v_cvt_pk_bf16_f32 v96, v96, v97
    v_cvt_pk_bf16_f32 v97, v98, v99
    v_cvt_pk_bf16_f32 v98, v100, v101
    v_cvt_pk_bf16_f32 v99, v102, v103
    buffer_store_dwordx4 v[96:99], v8, s[20:23], s38 offen offset:3072 sc0 sc1
    v_mul_f32 v104, v104, v6
    v_mul_f32 v105, v105, v6
    v_mul_f32 v106, v106, v6
    v_mul_f32 v107, v107, v6
    v_mul_f32 v108, v108, v6
    v_mul_f32 v109, v109, v6
    v_mul_f32 v110, v110, v6
    v_mul_f32 v111, v111, v6
    v_cvt_pk_bf16_f32 v104, v104, v105
    v_cvt_pk_bf16_f32 v105, v106, v107
    v_cvt_pk_bf16_f32 v106, v108, v109
    v_cvt_pk_bf16_f32 v107, v110, v111
    buffer_store_dwordx4 v[104:107], v8, s[20:23], s38 offen offset:3584 sc0 sc1
    s_branch L_attn_doneA
L_attn_doneA:
L_attn_ldloop:
    s_add_u32 s38, s31, 1
    s_cmp_ge_u32 s38, s30
    s_cbranch_scc1 L_attn_finA
    s_add_u32 s38, s31, 4
    s_cmp_ge_i32 s38, s30
    s_cbranch_scc1 L_w0_41
L_w0b_42:
    s_waitcnt vmcnt(8)
    s_barrier
    s_cmp_ge_u32 s34, s30
    s_cbranch_scc1 L_it_43
    s_and_b32 s38, s34, 3
    s_lshl_b32 s38, s38, 14
    s_add_u32 s38, s38, s37
    s_mov_b32 m0, s38
    s_lshl_b32 s39, s34, 14
    s_add_u32 s39, s39, s36
    buffer_load_dwordx4 v12, s[12:15], s39 offen offset:0 lds
    buffer_load_dwordx4 v12, s[12:15], s39 offen offset:1024 lds
    buffer_load_dwordx4 v12, s[12:15], s39 offen offset:2048 lds
    buffer_load_dwordx4 v12, s[12:15], s39 offen offset:3072 lds
L_it_43:
    s_add_u32 s34, s34, 1
    s_cmp_ge_u32 s35, s30
    s_cbranch_scc1 L_it_44
    s_and_b32 s38, s35, 3
    s_lshl_b32 s38, s38, 14
    s_add_u32 s38, s38, s37
    s_add_u32 m0, s38, 0x10000
    s_lshl_b32 s39, s35, 14
    s_add_u32 s39, s39, s36
    buffer_load_dwordx4 v12, s[16:19], s39 offen offset:0 lds
    buffer_load_dwordx4 v12, s[16:19], s39 offen offset:1024 lds
    buffer_load_dwordx4 v12, s[16:19], s39 offen offset:2048 lds
    buffer_load_dwordx4 v12, s[16:19], s39 offen offset:3072 lds
L_it_44:
    s_add_u32 s35, s35, 1
    s_add_u32 s31, s31, 1
    s_branch L_attn_ldloop
L_attn_finA:
    s_endpgm
L_w0_11:
    s_waitcnt vmcnt(0)
    s_branch L_w0b_12
L_mask_15:
    s_nop 15
    s_add_u32 s38, s31, 1
    s_lshl_b32 s38, s38, 6
    v_subrev_u32 v9, s38, v11
    v_mov_b32 v10, 0xff800000
    v_cmp_gt_i32 vcc, 0, v9
    v_cmp_gt_i32 s[40:41], 1, v9
    v_cmp_gt_i32 s[42:43], 2, v9
    v_cndmask_b32 v112, v112, v10, vcc
    v_cndmask_b32 v113, v113, v10, s[40:41]
    v_cndmask_b32 v114, v114, v10, s[42:43]
    v_cmp_gt_i32 vcc, 3, v9
    v_cmp_gt_i32 s[40:41], 8, v9
    v_cmp_gt_i32 s[42:43], 9, v9
    v_cndmask_b32 v115, v115, v10, vcc
    v_cndmask_b32 v116, v116, v10, s[40:41]
    v_cndmask_b32 v117, v117, v10, s[42:43]
    v_cmp_gt_i32 vcc, 10, v9
    v_cmp_gt_i32 s[40:41], 11, v9
    v_cmp_gt_i32 s[42:43], 16, v9
    v_cndmask_b32 v118, v118, v10, vcc
    v_cndmask_b32 v119, v119, v10, s[40:41]
    v_cndmask_b32 v120, v120, v10, s[42:43]
    v_cmp_gt_i32 vcc, 17, v9
    v_cmp_gt_i32 s[40:41], 18, v9
    v_cmp_gt_i32 s[42:43], 19, v9
    v_cndmask_b32 v121, v121, v10, vcc
    v_cndmask_b32 v122, v122, v10, s[40:41]
    v_cndmask_b32 v123, v123, v10, s[42:43]
    v_cmp_gt_i32 vcc, 24, v9
    v_cmp_gt_i32 s[40:41], 25, v9
    v_cmp_gt_i32 s[42:43], 26, v9
    v_cndmask_b32 v124, v124, v10, vcc
    v_cndmask_b32 v125, v125, v10, s[40:41]
    v_cndmask_b32 v126, v126, v10, s[42:43]
    v_cmp_gt_i32 vcc, 27, v9
    v_cmp_gt_i32 s[40:41], 32, v9
    v_cmp_gt_i32 s[42:43], 33, v9
    v_cndmask_b32 v127, v127, v10, vcc
    v_cndmask_b32 v128, v128, v10, s[40:41]
    v_cndmask_b32 v129, v129, v10, s[42:43]
    v_cmp_gt_i32 vcc, 34, v9
    v_cmp_gt_i32 s[40:41], 35, v9
    v_cmp_gt_i32 s[42:43], 40, v9
    v_cndmask_b32 v130, v130, v10, vcc
    v_cndmask_b32 v131, v131, v10, s[40:41]
    v_cndmask_b32 v132, v132, v10, s[42:43]
    v_cmp_gt_i32 vcc, 41, v9
    v_cmp_gt_i32 s[40:41], 42, v9
    v_cmp_gt_i32 s[42:43], 43, v9
    v_cndmask_b32 v133, v133, v10, vcc
    v_cndmask_b32 v134, v134, v10, s[40:41]
    v_cndmask_b32 v135, v135, v10, s[42:43]
    v_cmp_gt_i32 vcc, 48, v9
    v_cmp_gt_i32 s[40:41], 49, v9
    v_cmp_gt_i32 s[42:43], 50, v9
    v_cndmask_b32 v136, v136, v10, vcc
    v_cndmask_b32 v137, v137, v10, s[40:41]
    v_cndmask_b32 v138, v138, v10, s[42:43]
    v_cmp_gt_i32 vcc, 51, v9
    v_cmp_gt_i32 s[40:41], 56, v9
    v_cmp_gt_i32 s[42:43], 57, v9
    v_cndmask_b32 v139, v139, v10, vcc
    v_cndmask_b32 v140, v140, v10, s[40:41]
    v_cndmask_b32 v141, v141, v10, s[42:43]
    v_cmp_gt_i32 vcc, 58, v9
    v_cmp_gt_i32 s[40:41], 59, v9
    s_nop 1
    v_cndmask_b32 v142, v142, v10, vcc
    v_cndmask_b32 v143, v143, v10, s[40:41]
    s_branch L_maskb_16
L_w0_17:
    s_waitcnt vmcnt(0)
    s_branch L_w0b_18
L_mask_21:
    s_add_u32 s38, s31, 1
    s_lshl_b32 s38, s38, 6
    v_subrev_u32 v9, s38, v11
    v_mov_b32 v10, 0xff800000
    v_cmp_gt_i32 vcc, 0, v9
    v_cmp_gt_i32 s[40:41], 1, v9
    v_cmp_gt_i32 s[42:43], 2, v9
    v_cndmask_b32 v144, v144, v10, vcc
    v_cndmask_b32 v145, v145, v10, s[40:41]
    v_cndmask_b32 v146, v146, v10, s[42:43]
    v_cmp_gt_i32 vcc, 3, v9
    v_cmp_gt_i32 s[40:41], 8, v9
    v_cmp_gt_i32 s[42:43], 9, v9
    v_cndmask_b32 v147, v147, v10, vcc
    v_cndmask_b32 v148, v148, v10, s[40:41]
    v_cndmask_b32 v149, v149, v10, s[42:43]
    v_cmp_gt_i32 vcc, 10, v9
    v_cmp_gt_i32 s[40:41], 11, v9
    v_cmp_gt_i32 s[42:43], 16, v9
    v_cndmask_b32 v150, v150, v10, vcc
    v_cndmask_b32 v151, v151, v10, s[40:41]
    v_cndmask_b32 v152, v152, v10, s[42:43]
    v_cmp_gt_i32 vcc, 17, v9
    v_cmp_gt_i32 s[40:41], 18, v9
    v_cmp_gt_i32 s[42:43], 19, v9
    v_cndmask_b32 v153, v153, v10, vcc
    v_cndmask_b32 v154, v154, v10, s[40:41]
    v_cndmask_b32 v155, v155, v10, s[42:43]
    v_cmp_gt_i32 vcc, 24, v9
    v_cmp_gt_i32 s[40:41], 25, v9
    v_cmp_gt_i32 s[42:43], 26, v9
    v_cndmask_b32 v156, v156, v10, vcc
    v_cndmask_b32 v157, v157, v10, s[40:41]
    v_cndmask_b32 v158, v158, v10, s[42:43]
    v_cmp_gt_i32 vcc, 27, v9
    v_cmp_gt_i32 s[40:41], 32, v9
    v_cmp_gt_i32 s[42:43], 33, v9
    v_cndmask_b32 v159, v159, v10, vcc
    v_cndmask_b32 v160, v160, v10, s[40:41]
    v_cndmask_b32 v161, v161, v10, s[42:43]
    v_cmp_gt_i32 vcc, 34, v9
    v_cmp_gt_i32 s[40:41], 35, v9
    v_cmp_gt_i32 s[42:43], 40, v9
    v_cndmask_b32 v162, v162, v10, vcc
    v_cndmask_b32 v163, v163, v10, s[40:41]
    v_cndmask_b32 v164, v164, v10, s[42:43]
    v_cmp_gt_i32 vcc, 41, v9
    v_cmp_gt_i32 s[40:41], 42, v9
    v_cmp_gt_i32 s[42:43], 43, v9
    v_cndmask_b32 v165, v165, v10, vcc
    v_cndmask_b32 v166, v166, v10, s[40:41]
    v_cndmask_b32 v167, v167, v10, s[42:43]
    v_cmp_gt_i32 vcc, 48, v9
    v_cmp_gt_i32 s[40:41], 49, v9
    v_cmp_gt_i32 s[42:43], 50, v9
    v_cndmask_b32 v168, v168, v10, vcc
    v_cndmask_b32 v169, v169, v10, s[40:41]
    v_cndmask_b32 v170, v170, v10, s[42:43]
    v_cmp_gt_i32 vcc, 51, v9
    v_cmp_gt_i32 s[40:41], 56, v9
    v_cmp_gt_i32 s[42:43], 57, v9
    v_cndmask_b32 v171, v171, v10, vcc
    v_cndmask_b32 v172, v172, v10, s[40:41]
    v_cndmask_b32 v173, v173, v10, s[42:43]
    v_cmp_gt_i32 vcc, 58, v9
    v_cmp_gt_i32 s[40:41], 59, v9
    s_nop 1
    v_cndmask_b32 v174, v174, v10, vcc
    v_cndmask_b32 v175, v175, v10, s[40:41]
    s_branch L_maskb_22
L_rs_23:
    s_nop 15
    v_max_f32 v8, 0, v8
    v_sub_f32 v9, 0, v8
    v_exp_f32 v9, v9
    s_nop 0
    v_mul_f32 v6, v6, v9
    v_mul_f32 v7, v7, v9
    v_mul_f32 v48, v48, v9
    v_mul_f32 v49, v49, v9
    v_mul_f32 v50, v50, v9
    v_mul_f32 v51, v51, v9
    v_mul_f32 v52, v52, v9
    v_mul_f32 v53, v53, v9
    v_mul_f32 v54, v54, v9
    v_mul_f32 v55, v55, v9
    v_mul_f32 v56, v56, v9
    v_mul_f32 v57, v57, v9
    v_mul_f32 v58, v58, v9
    v_mul_f32 v59, v59, v9
    v_mul_f32 v60, v60, v9
    v_mul_f32 v61, v61, v9
    v_mul_f32 v62, v62, v9
    v_mul_f32 v63, v63, v9
    v_mul_f32 v64, v64, v9
    v_mul_f32 v65, v65, v9
    v_mul_f32 v66, v66, v9
    v_mul_f32 v67, v67, v9
    v_mul_f32 v68, v68, v9
    v_mul_f32 v69, v69, v9
    v_mul_f32 v70, v70, v9
    v_mul_f32 v71, v71, v9
    v_mul_f32 v72, v72, v9
    v_mul_f32 v73, v73, v9
    v_mul_f32 v74, v74, v9
    v_mul_f32 v75, v75, v9
    v_mul_f32 v76, v76, v9
    v_mul_f32 v77, v77, v9
    v_mul_f32 v78, v78, v9
    v_mul_f32 v79, v79, v9
    v_mul_f32 v80, v80, v9
    v_mul_f32 v81, v81, v9
    v_mul_f32 v82, v82, v9
    v_mul_f32 v83, v83, v9
    v_mul_f32 v84, v84, v9
    v_mul_f32 v85, v85, v9
    v_mul_f32 v86, v86, v9
    v_mul_f32 v87, v87, v9
    v_mul_f32 v88, v88, v9
    v_mul_f32 v89, v89, v9
    v_mul_f32 v90, v90, v9
    v_mul_f32 v91, v91, v9
    v_mul_f32 v92, v92, v9
    v_mul_f32 v93, v93, v9
    v_mul_f32 v94, v94, v9
    v_mul_f32 v95, v95, v9
    v_mul_f32 v96, v96, v9
    v_mul_f32 v97, v97, v9
    v_mul_f32 v98, v98, v9
    v_mul_f32 v99, v99, v9
    v_mul_f32 v100, v100, v9
    v_mul_f32 v101, v101, v9
    v_mul_f32 v102, v102, v9
    v_mul_f32 v103, v103, v9
    v_mul_f32 v104, v104, v9
    v_mul_f32 v105, v105, v9
    v_mul_f32 v106, v106, v9
    v_mul_f32 v107, v107, v9
    v_mul_f32 v108, v108, v9
    v_mul_f32 v109, v109, v9
    v_mul_f32 v110, v110, v9
    v_mul_f32 v111, v111, v9
    v_sub_f32 v144, v144, v8
    v_sub_f32 v145, v145, v8
    v_sub_f32 v146, v146, v8
    v_sub_f32 v147, v147, v8
    v_sub_f32 v148, v148, v8
    v_sub_f32 v149, v149, v8
    v_sub_f32 v150, v150, v8
    v_sub_f32 v151, v151, v8
    v_sub_f32 v152, v152, v8
    v_sub_f32 v153, v153, v8
    v_sub_f32 v154, v154, v8
    v_sub_f32 v155, v155, v8
    v_sub_f32 v156, v156, v8
    v_sub_f32 v157, v157, v8
    v_sub_f32 v158, v158, v8
    v_sub_f32 v159, v159, v8
    v_sub_f32 v160, v160, v8
    v_sub_f32 v161, v161, v8
    v_sub_f32 v162, v162, v8
    v_sub_f32 v163, v163, v8
    v_sub_f32 v164, v164, v8
    v_sub_f32 v165, v165, v8
    v_sub_f32 v166, v166, v8
    v_sub_f32 v167, v167, v8
    v_sub_f32 v168, v168, v8
    v_sub_f32 v169, v169, v8
    v_sub_f32 v170, v170, v8
    v_sub_f32 v171, v171, v8
    v_sub_f32 v172, v172, v8
    v_sub_f32 v173, v173, v8
    v_sub_f32 v174, v174, v8
    v_sub_f32 v175, v175, v8
    v_sub_f32 v176, v176, v8
    v_sub_f32 v177, v177, v8
    v_sub_f32 v178, v178, v8
    v_sub_f32 v179, v179, v8
    v_sub_f32 v180, v180, v8
    v_sub_f32 v181, v181, v8
    v_sub_f32 v182, v182, v8
    v_sub_f32 v183, v183, v8
    v_sub_f32 v184, v184, v8
    v_sub_f32 v185, v185, v8
    v_sub_f32 v186, v186, v8
    v_sub_f32 v187, v187, v8
    v_sub_f32 v188, v188, v8
    v_sub_f32 v189, v189, v8
    v_sub_f32 v190, v190, v8
    v_sub_f32 v191, v191, v8
    s_nop 1
    s_branch L_rsb_24
L_w0_25:
    s_waitcnt vmcnt(0)
    s_branch L_w0b_26
L_mask_29:
    s_add_u32 s38, s31, 1
    s_lshl_b32 s38, s38, 6
    v_subrev_u32 v9, s38, v11
    v_mov_b32 v10, 0xff800000
    v_cmp_gt_i32 vcc, 0, v9
    v_cmp_gt_i32 s[40:41], 1, v9
    v_cmp_gt_i32 s[42:43], 2, v9
    v_cndmask_b32 v112, v112, v10, vcc
    v_cndmask_b32 v113, v113, v10, s[40:41]
    v_cndmask_b32 v114, v114, v10, s[42:43]
    v_cmp_gt_i32 vcc, 3, v9
    v_cmp_gt_i32 s[40:41], 8, v9
    v_cmp_gt_i32 s[42:43], 9, v9
    v_cndmask_b32 v115, v115, v10, vcc
    v_cndmask_b32 v116, v116, v10, s[40:41]
    v_cndmask_b32 v117, v117, v10, s[42:43]
    v_cmp_gt_i32 vcc, 10, v9
    v_cmp_gt_i32 s[40:41], 11, v9
    v_cmp_gt_i32 s[42:43], 16, v9
    v_cndmask_b32 v118, v118, v10, vcc
    v_cndmask_b32 v119, v119, v10, s[40:41]
    v_cndmask_b32 v120, v120, v10, s[42:43]
    v_cmp_gt_i32 vcc, 17, v9
    v_cmp_gt_i32 s[40:41], 18, v9
    v_cmp_gt_i32 s[42:43], 19, v9
    v_cndmask_b32 v121, v121, v10, vcc
    v_cndmask_b32 v122, v122, v10, s[40:41]
    v_cndmask_b32 v123, v123, v10, s[42:43]
    v_cmp_gt_i32 vcc, 24, v9
    v_cmp_gt_i32 s[40:41], 25, v9
    v_cmp_gt_i32 s[42:43], 26, v9
    v_cndmask_b32 v124, v124, v10, vcc
    v_cndmask_b32 v125, v125, v10, s[40:41]
    v_cndmask_b32 v126, v126, v10, s[42:43]
    v_cmp_gt_i32 vcc, 27, v9
    v_cmp_gt_i32 s[40:41], 32, v9
    v_cmp_gt_i32 s[42:43], 33, v9
    v_cndmask_b32 v127, v127, v10, vcc
    v_cndmask_b32 v128, v128, v10, s[40:41]
    v_cndmask_b32 v129, v129, v10, s[42:43]
    v_cmp_gt_i32 vcc, 34, v9
    v_cmp_gt_i32 s[40:41], 35, v9
    v_cmp_gt_i32 s[42:43], 40, v9
    v_cndmask_b32 v130, v130, v10, vcc
    v_cndmask_b32 v131, v131, v10, s[40:41]
    v_cndmask_b32 v132, v132, v10, s[42:43]
    v_cmp_gt_i32 vcc, 41, v9
    v_cmp_gt_i32 s[40:41], 42, v9
    v_cmp_gt_i32 s[42:43], 43, v9
    v_cndmask_b32 v133, v133, v10, vcc
    v_cndmask_b32 v134, v134, v10, s[40:41]
    v_cndmask_b32 v135, v135, v10, s[42:43]
    v_cmp_gt_i32 vcc, 48, v9
    v_cmp_gt_i32 s[40:41], 49, v9
    v_cmp_gt_i32 s[42:43], 50, v9
    v_cndmask_b32 v136, v136, v10, vcc
    v_cndmask_b32 v137, v137, v10, s[40:41]
    v_cndmask_b32 v138, v138, v10, s[42:43]
    v_cmp_gt_i32 vcc, 51, v9
    v_cmp_gt_i32 s[40:41], 56, v9
    v_cmp_gt_i32 s[42:43], 57, v9
    v_cndmask_b32 v139, v139, v10, vcc
    v_cndmask_b32 v140, v140, v10, s[40:41]
    v_cndmask_b32 v141, v141, v10, s[42:43]
    v_cmp_gt_i32 vcc, 58, v9
    v_cmp_gt_i32 s[40:41], 59, v9
    s_nop 1
    v_cndmask_b32 v142, v142, v10, vcc
    v_cndmask_b32 v143, v143, v10, s[40:41]
    s_branch L_maskb_30
L_rs_31:
    s_nop 15
    v_max_f32 v8, 0, v8
    v_sub_f32 v9, 0, v8
    v_exp_f32 v9, v9
    s_nop 0
    v_mul_f32 v6, v6, v9
    v_mul_f32 v7, v7, v9
    v_mul_f32 v48, v48, v9
    v_mul_f32 v49, v49, v9
    v_mul_f32 v50, v50, v9
    v_mul_f32 v51, v51, v9
    v_mul_f32 v52, v52, v9
    v_mul_f32 v53, v53, v9
    v_mul_f32 v54, v54, v9
    v_mul_f32 v55, v55, v9
    v_mul_f32 v56, v56, v9
    v_mul_f32 v57, v57, v9
    v_mul_f32 v58, v58, v9
    v_mul_f32 v59, v59, v9
    v_mul_f32 v60, v60, v9
    v_mul_f32 v61, v61, v9
    v_mul_f32 v62, v62, v9
    v_mul_f32 v63, v63, v9
    v_mul_f32 v64, v64, v9
    v_mul_f32 v65, v65, v9
    v_mul_f32 v66, v66, v9
    v_mul_f32 v67, v67, v9
    v_mul_f32 v68, v68, v9
    v_mul_f32 v69, v69, v9
    v_mul_f32 v70, v70, v9
    v_mul_f32 v71, v71, v9
    v_mul_f32 v72, v72, v9
    v_mul_f32 v73, v73, v9
    v_mul_f32 v74, v74, v9
    v_mul_f32 v75, v75, v9
    v_mul_f32 v76, v76, v9
    v_mul_f32 v77, v77, v9
    v_mul_f32 v78, v78, v9
    v_mul_f32 v79, v79, v9
    v_mul_f32 v80, v80, v9
    v_mul_f32 v81, v81, v9
    v_mul_f32 v82, v82, v9
    v_mul_f32 v83, v83, v9
    v_mul_f32 v84, v84, v9
    v_mul_f32 v85, v85, v9
    v_mul_f32 v86, v86, v9
    v_mul_f32 v87, v87, v9
    v_mul_f32 v88, v88, v9
    v_mul_f32 v89, v89, v9
    v_mul_f32 v90, v90, v9
    v_mul_f32 v91, v91, v9
    v_mul_f32 v92, v92, v9
    v_mul_f32 v93, v93, v9
    v_mul_f32 v94, v94, v9
    v_mul_f32 v95, v95, v9
    v_mul_f32 v96, v96, v9
    v_mul_f32 v97, v97, v9
    v_mul_f32 v98, v98, v9
    v_mul_f32 v99, v99, v9
    v_mul_f32 v100, v100, v9
    v_mul_f32 v101, v101, v9
    v_mul_f32 v102, v102, v9
    v_mul_f32 v103, v103, v9
    v_mul_f32 v104, v104, v9
    v_mul_f32 v105, v105, v9
    v_mul_f32 v106, v106, v9
    v_mul_f32 v107, v107, v9
    v_mul_f32 v108, v108, v9
    v_mul_f32 v109, v109, v9
    v_mul_f32 v110, v110, v9
    v_mul_f32 v111, v111, v9
    v_sub_f32 v112, v112, v8
    v_sub_f32 v113, v113, v8
    v_sub_f32 v114, v114, v8
    v_sub_f32 v115, v115, v8
    v_sub_f32 v116, v116, v8
    v_sub_f32 v117, v117, v8
    v_sub_f32 v118, v118, v8
    v_sub_f32 v119, v119, v8
    v_sub_f32 v120, v120, v8
    v_sub_f32 v121, v121, v8
    v_sub_f32 v122, v122, v8
    v_sub_f32 v123, v123, v8
    v_sub_f32 v124, v124, v8
    v_sub_f32 v125, v125, v8
    v_sub_f32 v126, v126, v8
    v_sub_f32 v127, v127, v8
    v_sub_f32 v128, v128, v8
    v_sub_f32 v129, v129, v8
    v_sub_f32 v130, v130, v8
    v_sub_f32 v131, v131, v8
    v_sub_f32 v132, v132, v8
    v_sub_f32 v133, v133, v8
    v_sub_f32 v134, v134, v8
    v_sub_f32 v135, v135, v8
    v_sub_f32 v136, v136, v8
    v_sub_f32 v137, v137, v8
    v_sub_f32 v138, v138, v8
    v_sub_f32 v139, v139, v8
    v_sub_f32 v140, v140, v8
    v_sub_f32 v141, v141, v8
    v_sub_f32 v142, v142, v8
    v_sub_f32 v143, v143, v8
    v_sub_f32 v176, v176, v8
    v_sub_f32 v177, v177, v8
    v_sub_f32 v178, v178, v8
    v_sub_f32 v179, v179, v8
    v_sub_f32 v180, v180, v8
    v_sub_f32 v181, v181, v8
    v_sub_f32 v182, v182, v8
    v_sub_f32 v183, v183, v8
    v_sub_f32 v184, v184, v8
    v_sub_f32 v185, v185, v8
    v_sub_f32 v186, v186, v8
    v_sub_f32 v187, v187, v8
    v_sub_f32 v188, v188, v8
    v_sub_f32 v189, v189, v8
    v_sub_f32 v190, v190, v8
    v_sub_f32 v191, v191, v8
    s_nop 1
    s_branch L_rsb_32
L_w0_33:
    s_waitcnt vmcnt(0)
    s_branch L_w0b_34
L_w0_37:
    s_waitcnt vmcnt(0)
    s_branch L_w0b_38
L_w0_41:
    s_waitcnt vmcnt(0)
    s_branch L_w0b_42
L_attn_B:
    ds_read_b128 v[192:195], v4 offset:0
    ds_read_b128 v[196:199], v4 offset:2048
    ds_read_b128 v[200:203], v4 offset:4096
    ds_read_b128 v[204:207], v4 offset:6144
    ds_read_b128 v[208:211], v4 offset:8192
    ds_read_b128 v[212:215], v4 offset:10240
    ds_read_b128 v[216:219], v4 offset:12288
    ds_read_b128 v[220:223], v4 offset:14336
    s_waitcnt lgkmcnt(7)
    v_mfma_f32_32x32x16_bf16 v[112:127], v[192:195], v[16:19], v[176:191]
    ds_read_b128 v[224:227], v4 offset:512
    s_waitcnt lgkmcnt(7)
    v_mfma_f32_32x32x16_bf16 v[112:127], v[196:199], v[20:23], v[112:127]
    ds_read_b128 v[228:231], v4 offset:2560
    s_waitcnt lgkmcnt(7)
    v_mfma_f32_32x32x16_bf16 v[112:127], v[200:203], v[24:27], v[112:127]
    ds_read_b128 v[232:235], v4 offset:4608
    s_waitcnt lgkmcnt(7)
    v_mfma_f32_32x32x16_bf16 v[112:127], v[204:207], v[28:31], v[112:127]
    ds_read_b128 v[236:239], v4 offset:6656
    s_waitcnt lgkmcnt(7)
    v_mfma_f32_32x32x16_bf16 v[112:127], v[208:211], v[32:35], v[112:127]
    ds_read_b128 v[240:243], v4 offset:8704
    s_waitcnt lgkmcnt(7)
    v_mfma_f32_32x32x16_bf16 v[112:127], v[212:215], v[36:39], v[112:127]
    ds_read_b128 v[244:247], v4 offset:10752
    s_waitcnt lgkmcnt(7)
    v_mfma_f32_32x32x16_bf16 v[112:127], v[216:219], v[40:43], v[112:127]
    ds_read_b128 v[248:251], v4 offset:12800
    s_waitcnt lgkmcnt(7)
    v_mfma_f32_32x32x16_bf16 v[112:127], v[220:223], v[44:47], v[112:127]
    ds_read_b128 v[252:255], v4 offset:14848
    s_waitcnt lgkmcnt(7)
    v_mfma_f32_32x32x16_bf16 v[128:143], v[224:227], v[16:19], v[176:191]
    s_waitcnt lgkmcnt(6)
    v_mfma_f32_32x32x16_bf16 v[128:143], v[228:231], v[20:23], v[128:143]
    s_waitcnt lgkmcnt(5)
    v_mfma_f32_32x32x16_bf16 v[128:143], v[232:235], v[24:27], v[128:143]
    s_waitcnt lgkmcnt(4)
    v_mfma_f32_32x32x16_bf16 v[128:143], v[236:239], v[28:31], v[128:143]
    s_waitcnt lgkmcnt(3)
    v_mfma_f32_32x32x16_bf16 v[128:143], v[240:243], v[32:35], v[128:143]
    s_waitcnt lgkmcnt(2)
    v_mfma_f32_32x32x16_bf16 v[128:143], v[244:247], v[36:39], v[128:143]
    s_waitcnt lgkmcnt(1)
    v_mfma_f32_32x32x16_bf16 v[128:143], v[248:251], v[40:43], v[128:143]
    s_waitcnt lgkmcnt(0)
    v_mfma_f32_32x32x16_bf16 v[128:143], v[252:255], v[44:47], v[128:143]
    s_barrier
    v_add_u32 v4, s32, v2
    ds_read_b128 v[192:195], v4 offset:0
    ds_read_b128 v[196:199], v4 offset:2048
    ds_read_b128 v[200:203], v4 offset:4096
    ds_read_b128 v[204:207], v4 offset:6144
    ds_read_b128 v[208:211], v4 offset:8192
    ds_read_b128 v[212:215], v4 offset:10240
    ds_read_b128 v[216:219], v4 offset:12288
    ds_read_b128 v[220:223], v4 offset:14336
    s_add_u32 s32, s32, 0x4000
    s_nop 7
    s_add_u32 s38, s31, 2
    s_cmp_eq_u32 s38, s29
    s_cbranch_scc1 L_mask_45
L_maskb_46:
    v_max3_f32 v8, v112, v113, v114
    v_max3_f32 v8, v8, v115, v116
    v_max3_f32 v8, v8, v117, v118
    v_max3_f32 v8, v8, v119, v120
    v_max3_f32 v8, v8, v121, v122
    v_max3_f32 v8, v8, v123, v124
    v_max3_f32 v8, v8, v125, v126
    v_max_f32 v8, v8, v127
    v_max3_f32 v9, v128, v129, v130
    v_max3_f32 v9, v9, v131, v132
    v_max3_f32 v9, v9, v133, v134
    v_max3_f32 v9, v9, v135, v136
    v_max3_f32 v9, v9, v137, v138
    v_max3_f32 v9, v9, v139, v140
    v_max3_f32 v9, v9, v141, v142
    v_max_f32 v9, v9, v143
    v_max_f32 v8, v8, v9
    v_mov_b32 v9, v8
    s_nop 1
    v_permlane32_swap_b32 v8, v9
    s_nop 1
    v_max_f32 v8, v8, v9
    v_sub_f32 v112, v112, v8
    v_sub_f32 v113, v113, v8
    v_sub_f32 v114, v114, v8
    v_sub_f32 v115, v115, v8
    v_sub_f32 v116, v116, v8
    v_sub_f32 v117, v117, v8
    v_sub_f32 v118, v118, v8
    v_sub_f32 v119, v119, v8
    v_sub_f32 v120, v120, v8
    v_sub_f32 v121, v121, v8
    v_sub_f32 v122, v122, v8
    v_sub_f32 v123, v123, v8
    v_sub_f32 v124, v124, v8
    v_sub_f32 v125, v125, v8
    v_sub_f32 v126, v126, v8
    v_sub_f32 v127, v127, v8
    v_sub_f32 v128, v128, v8
    v_sub_f32 v129, v129, v8
    v_sub_f32 v130, v130, v8
    v_sub_f32 v131, v131, v8
    v_sub_f32 v132, v132, v8
    v_sub_f32 v133, v133, v8
    v_sub_f32 v134, v134, v8
    v_sub_f32 v135, v135, v8
    v_sub_f32 v136, v136, v8
    v_sub_f32 v137, v137, v8
    v_sub_f32 v138, v138, v8
    v_sub_f32 v139, v139, v8
    v_sub_f32 v140, v140, v8
    v_sub_f32 v141, v141, v8
    v_sub_f32 v142, v142, v8
    v_sub_f32 v143, v143, v8
    v_sub_f32 v176, 0, v8
    v_sub_f32 v177, 0, v8
    v_sub_f32 v178, 0, v8
    v_sub_f32 v179, 0, v8
    v_sub_f32 v180, 0, v8
    v_sub_f32 v181, 0, v8
    v_sub_f32 v182, 0, v8
    v_sub_f32 v183, 0, v8
    v_sub_f32 v184, 0, v8
    v_sub_f32 v185, 0, v8
    v_sub_f32 v186, 0, v8
    v_sub_f32 v187, 0, v8
    v_sub_f32 v188, 0, v8
    v_sub_f32 v189, 0, v8
    v_sub_f32 v190, 0, v8
    v_sub_f32 v191, 0, v8
    s_mov_b32 s31, 0
    s_cmp_eq_u32 s29, 1
    s_cbranch_scc1 L_attn_ep0B
L_attn_loopB:
    v_add_u32 v5, s33, v3
    s_waitcnt lgkmcnt(4)
    v_mfma_f32_32x32x16_bf16 v[144:159], v[192:195], v[16:19], v[176:191]
    ds_read_b128 v[224:227], v4 offset:512
    v_exp_f32 v112, v112
    v_exp_f32 v113, v113
    v_exp_f32 v114, v114
    v_exp_f32 v115, v115
    v_mfma_f32_32x32x16_bf16 v[144:159], v[196:199], v[20:23], v[144:159]
    ds_read_b128 v[228:231], v4 offset:2560
    v_exp_f32 v116, v116
    v_exp_f32 v117, v117
    v_exp_f32 v118, v118
    v_mfma_f32_32x32x16_bf16 v[144:159], v[200:203], v[24:27], v[144:159]
    ds_read_b128 v[232:235], v4 offset:4608
    v_exp_f32 v119, v119
    v_add_f32 v6, v6, v112
    v_add_f32 v7, v7, v113
    v_mfma_f32_32x32x16_bf16 v[144:159], v[204:207], v[28:31], v[144:159]
    ds_read_b128 v[236:239], v4 offset:6656
    v_add_f32 v6, v6, v114
    v_add_f32 v7, v7, v115
    v_add_f32 v6, v6, v116
    v_add_f32 v7, v7, v117
    s_waitcnt lgkmcnt(4)
    v_mfma_f32_32x32x16_bf16 v[144:159], v[208:211], v[32:35], v[144:159]
    ds_read_b128 v[240:243], v4 offset:8704
    v_add_f32 v6, v6, v118
    v_add_f32 v7, v7, v119
    v_cvt_pk_bf16_f32 v112, v112, v113
    v_mfma_f32_32x32x16_bf16 v[144:159], v[212:215], v[36:39], v[144:159]
    ds_read_b128 v[244:247], v4 offset:10752
    v_cvt_pk_bf16_f32 v113, v114, v115
    v_cvt_pk_bf16_f32 v114, v116, v117
    v_cvt_pk_bf16_f32 v115, v118, v119
    v_mfma_f32_32x32x16_bf16 v[144:159], v[216:219], v[40:43], v[144:159]
    ds_read_b128 v[248:251], v4 offset:12800
    v_exp_f32 v120, v120
    v_exp_f32 v121, v121
    v_exp_f32 v122, v122
    v_exp_f32 v123, v123
    v_mfma_f32_32x32x16_bf16 v[144:159], v[220:223], v[44:47], v[144:159]
    ds_read_b128 v[252:255], v4 offset:14848
    v_exp_f32 v124, v124
    v_exp_f32 v125, v125
    v_exp_f32 v126, v126
    s_waitcnt lgkmcnt(4)
    v_mfma_f32_32x32x16_bf16 v[160:175], v[224:227], v[16:19], v[176:191]
    ds_read_b128 v[192:195], v5 offset:0
    v_exp_f32 v127, v127
    v_add_f32 v6, v6, v120
    v_add_f32 v7, v7, v121
    v_mfma_f32_32x32x16_bf16 v[160:175], v[228:231], v[20:23], v[160:175]
    ds_read_b128 v[196:199], v5 offset:512
    v_add_f32 v6, v6, v122
    v_add_f32 v7, v7, v123
    v_add_f32 v6, v6, v124
    v_add_f32 v7, v7, v125
    v_mfma_f32_32x32x16_bf16 v[160:175], v[232:235], v[24:27], v[160:175]
    ds_read_b128 v[200:203], v5 offset:1024
    v_add_f32 v6, v6, v126
    v_add_f32 v7, v7, v127
    v_cvt_pk_bf16_f32 v116, v120, v121
    v_mfma_f32_32x32x16_bf16 v[160:175], v[236:239], v[28:31], v[160:175]
    ds_read_b128 v[204:207], v5 offset:1536
    v_cvt_pk_bf16_f32 v117, v122, v123
    v_cvt_pk_bf16_f32 v118, v124, v125
    v_cvt_pk_bf16_f32 v119, v126, v127
    s_waitcnt lgkmcnt(4)
    v_mfma_f32_32x32x16_bf16 v[160:175], v[240:243], v[32:35], v[160:175]
    ds_read_b128 v[208:211], v5 offset:4096
    v_exp_f32 v128, v128
    v_exp_f32 v129, v129
    v_exp_f32 v130, v130
    v_exp_f32 v131, v131
    v_mfma_f32_32x32x16_bf16 v[160:175], v[244:247], v[36:39], v[160:175]
    ds_read_b128 v[212:215], v5 offset:4608
    v_exp_f32 v132, v132
    v_exp_f32 v133, v133
    v_exp_f32 v134, v134
    v_mfma_f32_32x32x16_bf16 v[160:175], v[248:251], v[40:43], v[160:175]
    ds_read_b128 v[216:219], v5 offset:5120
    v_exp_f32 v135, v135
    v_add_f32 v6, v6, v128
    v_add_f32 v7, v7, v129
    v_mfma_f32_32x32x16_bf16 v[160:175], v[252:255], v[44:47], v[160:175]
    ds_read_b128 v[220:223], v5 offset:5632
    v_add_f32 v6, v6, v130
    v_add_f32 v7, v7, v131
    v_add_f32 v6, v6, v132
    v_add_f32 v7, v7, v133
    s_barrier
    v_add_u32 v4, s32, v2
    s_waitcnt lgkmcnt(4)
    v_mfma_f32_32x32x16_bf16 v[48:63], v[192:195], v[112:115], v[48:63]
    ds_read_b128 v[224:227], v5 offset:8192
    v_add_f32 v6, v6, v134
    v_add_f32 v7, v7, v135
    v_cvt_pk_bf16_f32 v128, v128, v129
    v_mfma_f32_32x32x16_bf16 v[64:79], v[196:199], v[112:115], v[64:79]
    ds_read_b128 v[228:231], v5 offset:8704
    v_cvt_pk_bf16_f32 v129, v130, v131
    v_cvt_pk_bf16_f32 v130, v132, v133
    v_cvt_pk_bf16_f32 v131, v134, v135
    v_mfma_f32_32x32x16_bf16 v[80:95], v[200:203], v[112:115], v[80:95]
    ds_read_b128 v[232:235], v5 offset:9216
    v_exp_f32 v136, v136
    v_exp_f32 v137, v137
    v_exp_f32 v138, v138
    v_exp_f32 v139, v139
    v_mfma_f32_32x32x16_bf16 v[96:111], v[204:207], v[112:115], v[96:111]
    ds_read_b128 v[236:239], v5 offset:9728
    v_exp_f32 v140, v140
    v_exp_f32 v141, v141
    v_exp_f32 v142, v142
    s_waitcnt lgkmcnt(4)
    v_mfma_f32_32x32x16_bf16 v[48:63], v[208:211], v[116:119], v[48:63]
    ds_read_b128 v[240:243], v5 offset:12288
    v_exp_f32 v143, v143
    v_add_f32 v6, v6, v136
    v_add_f32 v7, v7, v137
    v_mfma_f32_32x32x16_bf16 v[64:79], v[212:215], v[116:119], v[64:79]
    ds_read_b128 v[244:247], v5 offset:12800
    v_add_f32 v6, v6, v138
    v_add_f32 v7, v7, v139
    v_add_f32 v6, v6, v140
    v_add_f32 v7, v7, v141
    v_mfma_f32_32x32x16_bf16 v[80:95], v[216:219], v[116:119], v[80:95]
    ds_read_b128 v[248:251], v5 offset:13312
    v_add_f32 v6, v6, v142
    v_add_f32 v7, v7, v143
    v_cvt_pk_bf16_f32 v132, v136, v137
    v_mfma_f32_32x32x16_bf16 v[96:111], v[220:223], v[116:119], v[96:111]
    ds_read_b128 v[252:255], v5 offset:13824
    v_cvt_pk_bf16_f32 v133, v138, v139
    v_cvt_pk_bf16_f32 v134, v140, v141
    v_cvt_pk_bf16_f32 v135, v142, v143
    s_add_u32 s38, s31, 2
    s_cmp_eq_u32 s38, s29
    s_cbranch_scc1 L_mask_47
L_maskb_48:
    s_waitcnt lgkmcnt(4)
    v_mfma_f32_32x32x16_bf16 v[48:63], v[224:227], v[128:131], v[48:63]
    ds_read_b128 v[192:195], v4 offset:0
    v_max3_f32 v8, v144, v145, v146
    v_max3_f32 v8, v8, v147, v148
    v_max3_f32 v8, v8, v149, v150
    v_mfma_f32_32x32x16_bf16 v[64:79], v[228:231], v[128:131], v[64:79]
    ds_read_b128 v[196:199], v4 offset:2048
    v_max3_f32 v8, v8, v151, v152
    v_max3_f32 v8, v8, v153, v154
    v_max3_f32 v8, v8, v155, v156
    v_mfma_f32_32x32x16_bf16 v[80:95], v[232:235], v[128:131], v[80:95]
    ds_read_b128 v[200:203], v4 offset:4096
    v_max3_f32 v8, v8, v157, v158
    v_max_f32 v8, v8, v159
    v_max3_f32 v9, v160, v161, v162
    v_mfma_f32_32x32x16_bf16 v[96:111], v[236:239], v[128:131], v[96:111]
    ds_read_b128 v[204:207], v4 offset:6144
    v_max3_f32 v9, v9, v163, v164
    v_max3_f32 v9, v9, v165, v166
    s_waitcnt lgkmcnt(4)
    v_mfma_f32_32x32x16_bf16 v[48:63], v[240:243], v[132:135], v[48:63]
    ds_read_b128 v[208:211], v4 offset:8192
    v_max3_f32 v9, v9, v167, v168
    v_max3_f32 v9, v9, v169, v170
    v_max3_f32 v9, v9, v171, v172
    v_mfma_f32_32x32x16_bf16 v[64:79], v[244:247], v[132:135], v[64:79]
    ds_read_b128 v[212:215], v4 offset:10240
    v_max3_f32 v9, v9, v173, v174
    v_max_f32 v9, v9, v175
    v_max_f32 v8, v8, v9
    v_mfma_f32_32x32x16_bf16 v[80:95], v[248:251], v[132:135], v[80:95]
    ds_read_b128 v[216:219], v4 offset:12288
    v_mov_b32 v9, v8
    s_nop 1
    v_permlane32_swap_b32 v8, v9
    v_mfma_f32_32x32x16_bf16 v[96:111], v[252:255], v[132:135], v[96:111]
    ds_read_b128 v[220:223], v4 offset:14336
    s_nop 1
    v_max_f32 v8, v8, v9
    s_add_u32 s32, s32, 0x4000
    s_and_b32 s32, s32, 0xffff
    s_add_u32 s33, s33, 0x4000
    s_and_b32 s33, s33, 0xffff
    v_cmp_lt_f32 vcc, s52, v8
    s_nop 1
    s_cbranch_vccnz L_rs_49
L_rsb_50:
    s_add_u32 s31, s31, 1
    s_add_u32 s38, s31, 1
    s_cmp_eq_u32 s38, s29
    s_cbranch_scc1 L_attn_ep1B
    v_add_u32 v5, s33, v3
    s_waitcnt lgkmcnt(4)
    v_mfma_f32_32x32x16_bf16 v[112:127], v[192:195], v[16:19], v[176:191]
    ds_read_b128 v[224:227], v4 offset:512
    v_exp_f32 v144, v144
    v_exp_f32 v145, v145
    v_exp_f32 v146, v146
    v_exp_f32 v147, v147
    v_mfma_f32_32x32x16_bf16 v[112:127], v[196:199], v[20:23], v[112:127]
    ds_read_b128 v[228:231], v4 offset:2560
    v_exp_f32 v148, v148
    v_exp_f32 v149, v149
    v_exp_f32 v150, v150
    v_mfma_f32_32x32x16_bf16 v[112:127], v[200:203], v[24:27], v[112:127]
    ds_read_b128 v[232:235], v4 offset:4608
    v_exp_f32 v151, v151
    v_add_f32 v6, v6, v144
    v_add_f32 v7, v7, v145
    v_mfma_f32_32x32x16_bf16 v[112:127], v[204:207], v[28:31], v[112:127]
    ds_read_b128 v[236:239], v4 offset:6656
    v_add_f32 v6, v6, v146
    v_add_f32 v7, v7, v147
    v_add_f32 v6, v6, v148
    v_add_f32 v7, v7, v149
    s_waitcnt lgkmcnt(4)
    v_mfma_f32_32x32x16_bf16 v[112:127], v[208:211], v[32:35], v[112:127]
    ds_read_b128 v[240:243], v4 offset:8704
    v_add_f32 v6, v6, v150
    v_add_f32 v7, v7, v151
    v_cvt_pk_bf16_f32 v144, v144, v145
    v_mfma_f32_32x32x16_bf16 v[112:127], v[212:215], v[36:39], v[112:127]
    ds_read_b128 v[244:247], v4 offset:10752
    v_cvt_pk_bf16_f32 v145, v146, v147
    v_cvt_pk_bf16_f32 v146, v148, v149
    v_cvt_pk_bf16_f32 v147, v150, v151
    v_mfma_f32_32x32x16_bf16 v[112:127], v[216:219], v[40:43], v[112:127]
    ds_read_b128 v[248:251], v4 offset:12800
    v_exp_f32 v152, v152
    v_exp_f32 v153, v153
    v_exp_f32 v154, v154
    v_exp_f32 v155, v155
    v_mfma_f32_32x32x16_bf16 v[112:127], v[220:223], v[44:47], v[112:127]
    ds_read_b128 v[252:255], v4 offset:14848
    v_exp_f32 v156, v156
    v_exp_f32 v157, v157
    v_exp_f32 v158, v158
    s_waitcnt lgkmcnt(4)
    v_mfma_f32_32x32x16_bf16 v[128:143], v[224:227], v[16:19], v[176:191]
    ds_read_b128 v[192:195], v5 offset:0
    v_exp_f32 v159, v159
    v_add_f32 v6, v6, v152
    v_add_f32 v7, v7, v153
    v_mfma_f32_32x32x16_bf16 v[128:143], v[228:231], v[20:23], v[128:143]
    ds_read_b128 v[196:199], v5 offset:512
    v_add_f32 v6, v6, v154
    v_add_f32 v7, v7, v155
    v_add_f32 v6, v6, v156
    v_add_f32 v7, v7, v157
    v_mfma_f32_32x32x16_bf16 v[128:143], v[232:235], v[24:27], v[128:143]
    ds_read_b128 v[200:203], v5 offset:1024
    v_add_f32 v6, v6, v158
    v_add_f32 v7, v7, v159
    v_cvt_pk_bf16_f32 v148, v152, v153
    v_mfma_f32_32x32x16_bf16 v[128:143], v[236:239], v[28:31], v[128:143]
    ds_read_b128 v[204:207], v5 offset:1536
    v_cvt_pk_bf16_f32 v149, v154, v155
    v_cvt_pk_bf16_f32 v150, v156, v157
    v_cvt_pk_bf16_f32 v151, v158, v159
    s_waitcnt lgkmcnt(4)
    v_mfma_f32_32x32x16_bf16 v[128:143], v[240:243], v[32:35], v[128:143]
    ds_read_b128 v[208:211], v5 offset:4096
    v_exp_f32 v160, v160
    v_exp_f32 v161, v161
    v_exp_f32 v162, v162
    v_exp_f32 v163, v163
    v_mfma_f32_32x32x16_bf16 v[128:143], v[244:247], v[36:39], v[128:143]
    ds_read_b128 v[212:215], v5 offset:4608
    v_exp_f32 v164, v164
    v_exp_f32 v165, v165
    v_exp_f32 v166, v166
    v_mfma_f32_32x32x16_bf16 v[128:143], v[248:251], v[40:43], v[128:143]
    ds_read_b128 v[216:219], v5 offset:5120
    v_exp_f32 v167, v167
    v_add_f32 v6, v6, v160
    v_add_f32 v7, v7, v161
    v_mfma_f32_32x32x16_bf16 v[128:143], v[252:255], v[44:47], v[128:143]
    ds_read_b128 v[220:223], v5 offset:5632
    v_add_f32 v6, v6, v162
    v_add_f32 v7, v7, v163
    v_add_f32 v6, v6, v164
    v_add_f32 v7, v7, v165
    s_barrier
    v_add_u32 v4, s32, v2
    s_waitcnt lgkmcnt(4)
    v_mfma_f32_32x32x16_bf16 v[48:63], v[192:195], v[144:147], v[48:63]
    ds_read_b128 v[224:227], v5 offset:8192
    v_add_f32 v6, v6, v166
    v_add_f32 v7, v7, v167
    v_cvt_pk_bf16_f32 v160, v160, v161
    v_mfma_f32_32x32x16_bf16 v[64:79], v[196:199], v[144:147], v[64:79]
    ds_read_b128 v[228:231], v5 offset:8704
    v_cvt_pk_bf16_f32 v161, v162, v163
    v_cvt_pk_bf16_f32 v162, v164, v165
    v_cvt_pk_bf16_f32 v163, v166, v167
    v_mfma_f32_32x32x16_bf16 v[80:95], v[200:203], v[144:147], v[80:95]
    ds_read_b128 v[232:235], v5 offset:9216
    v_exp_f32 v168, v168
    v_exp_f32 v169, v169
    v_exp_f32 v170, v170
    v_exp_f32 v171, v171
    v_mfma_f32_32x32x16_bf16 v[96:111], v[204:207], v[144:147], v[96:111]
    ds_read_b128 v[236:239], v5 offset:9728
    v_exp_f32 v172, v172
    v_exp_f32 v173, v173
    v_exp_f32 v174, v174
    s_waitcnt lgkmcnt(4)
    v_mfma_f32_32x32x16_bf16 v[48:63], v[208:211], v[148:151], v[48:63]
    ds_read_b128 v[240:243], v5 offset:12288
    v_exp_f32 v175, v175
    v_add_f32 v6, v6, v168
    v_add_f32 v7, v7, v169
    v_mfma_f32_32x32x16_bf16 v[64:79], v[212:215], v[148:151], v[64:79]
    ds_read_b128 v[244:247], v5 offset:12800
    v_add_f32 v6, v6, v170
    v_add_f32 v7, v7, v171
    v_add_f32 v6, v6, v172
    v_add_f32 v7, v7, v173
    v_mfma_f32_32x32x16_bf16 v[80:95], v[216:219], v[148:151], v[80:95]
    ds_read_b128 v[248:251], v5 offset:13312
    v_add_f32 v6, v6, v174
    v_add_f32 v7, v7, v175
    v_cvt_pk_bf16_f32 v164, v168, v169
    v_mfma_f32_32x32x16_bf16 v[96:111], v[220:223], v[148:151], v[96:111]
    ds_read_b128 v[252:255], v5 offset:13824
    v_cvt_pk_bf16_f32 v165, v170, v171
    v_cvt_pk_bf16_f32 v166, v172, v173
    v_cvt_pk_bf16_f32 v167, v174, v175
    s_add_u32 s38, s31, 2
    s_cmp_eq_u32 s38, s29
    s_cbranch_scc1 L_mask_51
L_maskb_52:
    s_waitcnt lgkmcnt(4)
    v_mfma_f32_32x32x16_bf16 v[48:63], v[224:227], v[160:163], v[48:63]
    ds_read_b128 v[192:195], v4 offset:0
    v_max3_f32 v8, v112, v113, v114
    v_max3_f32 v8, v8, v115, v116
    v_max3_f32 v8, v8, v117, v118
    v_mfma_f32_32x32x16_bf16 v[64:79], v[228:231], v[160:163], v[64:79]
    ds_read_b128 v[196:199], v4 offset:2048
    v_max3_f32 v8, v8, v119, v120
    v_max3_f32 v8, v8, v121, v122
    v_max3_f32 v8, v8, v123, v124
    v_mfma_f32_32x32x16_bf16 v[80:95], v[232:235], v[160:163], v[80:95]
    ds_read_b128 v[200:203], v4 offset:4096
    v_max3_f32 v8, v8, v125, v126
    v_max_f32 v8, v8, v127
    v_max3_f32 v9, v128, v129, v130
    v_mfma_f32_32x32x16_bf16 v[96:111], v[236:239], v[160:163], v[96:111]
    ds_read_b128 v[204:207], v4 offset:6144
    v_max3_f32 v9, v9, v131, v132
    v_max3_f32 v9, v9, v133, v134
    s_waitcnt lgkmcnt(4)
    v_mfma_f32_32x32x16_bf16 v[48:63], v[240:243], v[164:167], v[48:63]
    ds_read_b128 v[208:211], v4 offset:8192
    v_max3_f32 v9, v9, v135, v136
    v_max3_f32 v9, v9, v137, v138
    v_max3_f32 v9, v9, v139, v140
    v_mfma_f32_32x32x16_bf16 v[64:79], v[244:247], v[164:167], v[64:79]
    ds_read_b128 v[212:215], v4 offset:10240
    v_max3_f32 v9, v9, v141, v142
    v_max_f32 v9, v9, v143
    v_max_f32 v8, v8, v9
    v_mfma_f32_32x32x16_bf16 v[80:95], v[248:251], v[164:167], v[80:95]
    ds_read_b128 v[216:219], v4 offset:12288
    v_mov_b32 v9, v8
    s_nop 1
    v_permlane32_swap_b32 v8, v9
    v_mfma_f32_32x32x16_bf16 v[96:111], v[252:255], v[164:167], v[96:111]
    ds_read_b128 v[220:223], v4 offset:14336
    s_nop 1
    v_max_f32 v8, v8, v9
    s_add_u32 s32, s32, 0x4000
    s_and_b32 s32, s32, 0xffff
    s_add_u32 s33, s33, 0x4000
    s_and_b32 s33, s33, 0xffff
    v_cmp_lt_f32 vcc, s52, v8
    s_nop 1
    s_cbranch_vccnz L_rs_53
L_rsb_54:
    s_add_u32 s31, s31, 1
    s_add_u32 s38, s31, 1
    s_cmp_lg_u32 s38, s29
    s_cbranch_scc1 L_attn_loopB
L_attn_ep0B:
    s_waitcnt lgkmcnt(0)
    v_add_u32 v5, s33, v3
    ds_read_b128 v[192:195], v5 offset:0
    ds_read_b128 v[196:199], v5 offset:512
    ds_read_b128 v[200:203], v5 offset:1024
    ds_read_b128 v[204:207], v5 offset:1536
    ds_read_b128 v[208:211], v5 offset:4096
    ds_read_b128 v[212:215], v5 offset:4608
    ds_read_b128 v[216:219], v5 offset:5120
    ds_read_b128 v[220:223], v5 offset:5632
    v_exp_f32 v112, v112
    v_exp_f32 v113, v113
    v_exp_f32 v114, v114
    v_exp_f32 v115, v115
    v_exp_f32 v116, v116
    v_exp_f32 v117, v117
    v_exp_f32 v118, v118
    v_exp_f32 v119, v119
    v_add_f32 v6, v6, v112
    v_add_f32 v7, v7, v113
    v_add_f32 v6, v6, v114
    v_add_f32 v7, v7, v115
    v_add_f32 v6, v6, v116
    v_add_f32 v7, v7, v117
    v_add_f32 v6, v6, v118
    v_add_f32 v7, v7, v119
    v_cvt_pk_bf16_f32 v112, v112, v113
    v_cvt_pk_bf16_f32 v113, v114, v115
    v_cvt_pk_bf16_f32 v114, v116, v117
    v_cvt_pk_bf16_f32 v115, v118, v119
    v_exp_f32 v120, v120
    v_exp_f32 v121, v121
    v_exp_f32 v122, v122
    v_exp_f32 v123, v123
    v_exp_f32 v124, v124
    v_exp_f32 v125, v125
    v_exp_f32 v126, v126
    v_exp_f32 v127, v127
    v_add_f32 v6, v6, v120
    v_add_f32 v7, v7, v121
    v_add_f32 v6, v6, v122
    v_add_f32 v7, v7, v123
    v_add_f32 v6, v6, v124
    v_add_f32 v7, v7, v125
    v_add_f32 v6, v6, v126
    v_add_f32 v7, v7, v127
    v_cvt_pk_bf16_f32 v116, v120, v121
    v_cvt_pk_bf16_f32 v117, v122, v123
    v_cvt_pk_bf16_f32 v118, v124, v125
    v_cvt_pk_bf16_f32 v119, v126, v127
    v_exp_f32 v128, v128
    v_exp_f32 v129, v129
    v_exp_f32 v130, v130
    v_exp_f32 v131, v131
    v_exp_f32 v132, v132
    v_exp_f32 v133, v133
    v_exp_f32 v134, v134
    v_exp_f32 v135, v135
    v_add_f32 v6, v6, v128
    v_add_f32 v7, v7, v129
    v_add_f32 v6, v6, v130
    v_add_f32 v7, v7, v131
    v_add_f32 v6, v6, v132
    v_add_f32 v7, v7, v133
    v_add_f32 v6, v6, v134
    v_add_f32 v7, v7, v135
    v_cvt_pk_bf16_f32 v128, v128, v129
    v_cvt_pk_bf16_f32 v129, v130, v131
    v_cvt_pk_bf16_f32 v130, v132, v133
    v_cvt_pk_bf16_f32 v131, v134, v135
    v_exp_f32 v136, v136
    v_exp_f32 v137, v137
    v_exp_f32 v138, v138
    v_exp_f32 v139, v139
    v_exp_f32 v140, v140
    v_exp_f32 v141, v141
    v_exp_f32 v142, v142
    v_exp_f32 v143, v143
    v_add_f32 v6, v6, v136
    v_add_f32 v7, v7, v137
    v_add_f32 v6, v6, v138
    v_add_f32 v7, v7, v139
    v_add_f32 v6, v6, v140
    v_add_f32 v7, v7, v141
    v_add_f32 v6, v6, v142
    v_add_f32 v7, v7, v143
    v_cvt_pk_bf16_f32 v132, v136, v137
    v_cvt_pk_bf16_f32 v133, v138, v139
    v_cvt_pk_bf16_f32 v134, v140, v141
    v_cvt_pk_bf16_f32 v135, v142, v143
    s_waitcnt lgkmcnt(7)
    v_mfma_f32_32x32x16_bf16 v[48:63], v[192:195], v[112:115], v[48:63]
    ds_read_b128 v[224:227], v5 offset:8192
    s_waitcnt lgkmcnt(7)
    v_mfma_f32_32x32x16_bf16 v[64:79], v[196:199], v[112:115], v[64:79]
    ds_read_b128 v[228:231], v5 offset:8704
    s_waitcnt lgkmcnt(7)
    v_mfma_f32_32x32x16_bf16 v[80:95], v[200:203], v[112:115], v[80:95]
    ds_read_b128 v[232:235], v5 offset:9216
    s_waitcnt lgkmcnt(7)
    v_mfma_f32_32x32x16_bf16 v[96:111], v[204:207], v[112:115], v[96:111]
    ds_read_b128 v[236:239], v5 offset:9728
    s_waitcnt lgkmcnt(7)
    v_mfma_f32_32x32x16_bf16 v[48:63], v[208:211], v[116:119], v[48:63]
    ds_read_b128 v[240:243], v5 offset:12288
    s_waitcnt lgkmcnt(7)
    v_mfma_f32_32x32x16_bf16 v[64:79], v[212:215], v[116:119], v[64:79]
    ds_read_b128 v[244:247], v5 offset:12800
    s_waitcnt lgkmcnt(7)
    v_mfma_f32_32x32x16_bf16 v[80:95], v[216:219], v[116:119], v[80:95]
    ds_read_b128 v[248:251], v5 offset:13312
    s_waitcnt lgkmcnt(7)
    v_mfma_f32_32x32x16_bf16 v[96:111], v[220:223], v[116:119], v[96:111]
    ds_read_b128 v[252:255], v5 offset:13824
    s_waitcnt lgkmcnt(7)
    v_mfma_f32_32x32x16_bf16 v[48:63], v[224:227], v[128:131], v[48:63]
    s_waitcnt lgkmcnt(6)
    v_mfma_f32_32x32x16_bf16 v[64:79], v[228:231], v[128:131], v[64:79]
    s_waitcnt lgkmcnt(5)
    v_mfma_f32_32x32x16_bf16 v[80:95], v[232:235], v[128:131], v[80:95]
    s_waitcnt lgkmcnt(4)
    v_mfma_f32_32x32x16_bf16 v[96:111], v[236:239], v[128:131], v[96:111]
    s_waitcnt lgkmcnt(3)
    v_mfma_f32_32x32x16_bf16 v[48:63], v[240:243], v[132:135], v[48:63]
    s_waitcnt lgkmcnt(2)
    v_mfma_f32_32x32x16_bf16 v[64:79], v[244:247], v[132:135], v[64:79]
    s_waitcnt lgkmcnt(1)
    v_mfma_f32_32x32x16_bf16 v[80:95], v[248:251], v[132:135], v[80:95]
    s_waitcnt lgkmcnt(0)
    v_mfma_f32_32x32x16_bf16 v[96:111], v[252:255], v[132:135], v[96:111]
    v_add_f32 v6, v6, v7
    v_mov_b32 v7, v6
    s_nop 1
    v_permlane32_swap_b32 v6, v7
    s_nop 1
    v_add_f32 v6, v6, v7
    v_rcp_f32 v6, v6
    v_and_b32 v8, 31, v1
    v_add_u32 v8, s28, v8
    v_lshrrev_b32 v9, 4, v8
    v_lshlrev_b32 v9, 17, v9
    v_and_b32 v8, 15, v8
    v_lshl_add_u32 v8, v8, 4, v9
    v_lshrrev_b32 v9, 5, v1
    v_lshl_add_u32 v8, v9, 8, v8
    s_lshl_b32 s38, s27, 12
    s_nop 7
    v_mul_f32 v48, v48, v6
    v_mul_f32 v49, v49, v6
    v_mul_f32 v50, v50, v6
    v_mul_f32 v51, v51, v6
    v_mul_f32 v52, v52, v6
    v_mul_f32 v53, v53, v6
    v_mul_f32 v54, v54, v6
    v_mul_f32 v55, v55, v6
    v_cvt_pk_bf16_f32 v48, v48, v49
    v_cvt_pk_bf16_f32 v49, v50, v51
    v_cvt_pk_bf16_f32 v50, v52, v53
    v_cvt_pk_bf16_f32 v51, v54, v55
    buffer_store_dwordx4 v[48:51], v8, s[20:23], s38 offen offset:0 sc0 sc1
    v_mul_f32 v56, v56, v6
    v_mul_f32 v57, v57, v6
    v_mul_f32 v58, v58, v6
    v_mul_f32 v59, v59, v6
    v_mul_f32 v60, v60, v6
    v_mul_f32 v61, v61, v6
    v_mul_f32 v62, v62, v6
    v_mul_f32 v63, v63, v6
    v_cvt_pk_bf16_f32 v56, v56, v57
    v_cvt_pk_bf16_f32 v57, v58, v59
    v_cvt_pk_bf16_f32 v58, v60, v61
    v_cvt_pk_bf16_f32 v59, v62, v63
    buffer_store_dwordx4 v[56:59], v8, s[20:23], s38 offen offset:512 sc0 sc1
    v_mul_f32 v64, v64, v6
    v_mul_f32 v65, v65, v6
    v_mul_f32 v66, v66, v6
    v_mul_f32 v67, v67, v6
    v_mul_f32 v68, v68, v6
    v_mul_f32 v69, v69, v6
    v_mul_f32 v70, v70, v6
    v_mul_f32 v71, v71, v6
    v_cvt_pk_bf16_f32 v64, v64, v65
    v_cvt_pk_bf16_f32 v65, v66, v67
    v_cvt_pk_bf16_f32 v66, v68, v69
    v_cvt_pk_bf16_f32 v67, v70, v71
    buffer_store_dwordx4 v[64:67], v8, s[20:23], s38 offen offset:1024 sc0 sc1
    v_mul_f32 v72, v72, v6
    v_mul_f32 v73, v73, v6
    v_mul_f32 v74, v74, v6
    v_mul_f32 v75, v75, v6
    v_mul_f32 v76, v76, v6
    v_mul_f32 v77, v77, v6
    v_mul_f32 v78, v78, v6
    v_mul_f32 v79, v79, v6
    v_cvt_pk_bf16_f32 v72, v72, v73
    v_cvt_pk_bf16_f32 v73, v74, v75
    v_cvt_pk_bf16_f32 v74, v76, v77
    v_cvt_pk_bf16_f32 v75, v78, v79
    buffer_store_dwordx4 v[72:75], v8, s[20:23], s38 offen offset:1536 sc0 sc1
    v_mul_f32 v80, v80, v6
    v_mul_f32 v81, v81, v6
    v_mul_f32 v82, v82, v6
    v_mul_f32 v83, v83, v6
    v_mul_f32 v84, v84, v6
    v_mul_f32 v85, v85, v6
    v_mul_f32 v86, v86, v6
    v_mul_f32 v87, v87, v6
    v_cvt_pk_bf16_f32 v80, v80, v81
    v_cvt_pk_bf16_f32 v81, v82, v83
    v_cvt_pk_bf16_f32 v82, v84, v85
    v_cvt_pk_bf16_f32 v83, v86, v87
    buffer_store_dwordx4 v[80:83], v8, s[20:23], s38 offen offset:2048 sc0 sc1
    v_mul_f32 v88, v88, v6
    v_mul_f32 v89, v89, v6
    v_mul_f32 v90, v90, v6
    v_mul_f32 v91, v91, v6
    v_mul_f32 v92, v92, v6
    v_mul_f32 v93, v93, v6
    v_mul_f32 v94, v94, v6
    v_mul_f32 v95, v95, v6
    v_cvt_pk_bf16_f32 v88, v88, v89
    v_cvt_pk_bf16_f32 v89, v90, v91
    v_cvt_pk_bf16_f32 v90, v92, v93
    v_cvt_pk_bf16_f32 v91, v94, v95
    buffer_store_dwordx4 v[88:91], v8, s[20:23], s38 offen offset:2560 sc0 sc1
    v_mul_f32 v96, v96, v6
    v_mul_f32 v97, v97, v6
    v_mul_f32 v98, v98, v6
    v_mul_f32 v99, v99, v6
    v_mul_f32 v100, v100, v6
    v_mul_f32 v101, v101, v6
    v_mul_f32 v102, v102, v6
    v_mul_f32 v103, v103, v6
    v_cvt_pk_bf16_f32 v96, v96, v97
    v_cvt_pk_bf16_f32 v97, v98, v99
    v_cvt_pk_bf16_f32 v98, v100, v101
    v_cvt_pk_bf16_f32 v99, v102, v103
    buffer_store_dwordx4 v[96:99], v8, s[20:23], s38 offen offset:3072 sc0 sc1
    v_mul_f32 v104, v104, v6
    v_mul_f32 v105, v105, v6
    v_mul_f32 v106, v106, v6
    v_mul_f32 v107, v107, v6
    v_mul_f32 v108, v108, v6
    v_mul_f32 v109, v109, v6
    v_mul_f32 v110, v110, v6
    v_mul_f32 v111, v111, v6
    v_cvt_pk_bf16_f32 v104, v104, v105
    v_cvt_pk_bf16_f32 v105, v106, v107
    v_cvt_pk_bf16_f32 v106, v108, v109
    v_cvt_pk_bf16_f32 v107, v110, v111
    buffer_store_dwordx4 v[104:107], v8, s[20:23], s38 offen offset:3584 sc0 sc1
    s_branch L_attn_doneB
L_attn_ep1B:
    s_waitcnt lgkmcnt(0)
    v_add_u32 v5, s33, v3
    ds_read_b128 v[192:195], v5 offset:0
    ds_read_b128 v[196:199], v5 offset:512
    ds_read_b128 v[200:203], v5 offset:1024
    ds_read_b128 v[204:207], v5 offset:1536
    ds_read_b128 v[208:211], v5 offset:4096
    ds_read_b128 v[212:215], v5 offset:4608
    ds_read_b128 v[216:219], v5 offset:5120
    ds_read_b128 v[220:223], v5 offset:5632
    v_exp_f32 v144, v144
    v_exp_f32 v145, v145
    v_exp_f32 v146, v146
    v_exp_f32 v147, v147
    v_exp_f32 v148, v148
    v_exp_f32 v149, v149
    v_exp_f32 v150, v150
    v_exp_f32 v151, v151
    v_add_f32 v6, v6, v144
    v_add_f32 v7, v7, v145
    v_add_f32 v6, v6, v146
    v_add_f32 v7, v7, v147
    v_add_f32 v6, v6, v148
    v_add_f32 v7, v7, v149
    v_add_f32 v6, v6, v150
    v_add_f32 v7, v7, v151
    v_cvt_pk_bf16_f32 v144, v144, v145
    v_cvt_pk_bf16_f32 v145, v146, v147
    v_cvt_pk_bf16_f32 v146, v148, v149
    v_cvt_pk_bf16_f32 v147, v150, v151
    v_exp_f32 v152, v152
    v_exp_f32 v153, v153
    v_exp_f32 v154, v154
    v_exp_f32 v155, v155
    v_exp_f32 v156, v156
    v_exp_f32 v157, v157
    v_exp_f32 v158, v158
    v_exp_f32 v159, v159
    v_add_f32 v6, v6, v152
    v_add_f32 v7, v7, v153
    v_add_f32 v6, v6, v154
    v_add_f32 v7, v7, v155
    v_add_f32 v6, v6, v156
    v_add_f32 v7, v7, v157
    v_add_f32 v6, v6, v158
    v_add_f32 v7, v7, v159
    v_cvt_pk_bf16_f32 v148, v152, v153
    v_cvt_pk_bf16_f32 v149, v154, v155
    v_cvt_pk_bf16_f32 v150, v156, v157
    v_cvt_pk_bf16_f32 v151, v158, v159
    v_exp_f32 v160, v160
    v_exp_f32 v161, v161
    v_exp_f32 v162, v162
    v_exp_f32 v163, v163
    v_exp_f32 v164, v164
    v_exp_f32 v165, v165
    v_exp_f32 v166, v166
    v_exp_f32 v167, v167
    v_add_f32 v6, v6, v160
    v_add_f32 v7, v7, v161
    v_add_f32 v6, v6, v162
    v_add_f32 v7, v7, v163
    v_add_f32 v6, v6, v164
    v_add_f32 v7, v7, v165
    v_add_f32 v6, v6, v166
    v_add_f32 v7, v7, v167
    v_cvt_pk_bf16_f32 v160, v160, v161
    v_cvt_pk_bf16_f32 v161, v162, v163
    v_cvt_pk_bf16_f32 v162, v164, v165
    v_cvt_pk_bf16_f32 v163, v166, v167
    v_exp_f32 v168, v168
    v_exp_f32 v169, v169
    v_exp_f32 v170, v170
    v_exp_f32 v171, v171
    v_exp_f32 v172, v172
    v_exp_f32 v173, v173
    v_exp_f32 v174, v174
    v_exp_f32 v175, v175
    v_add_f32 v6, v6, v168
    v_add_f32 v7, v7, v169
    v_add_f32 v6, v6, v170
    v_add_f32 v7, v7, v171
    v_add_f32 v6, v6, v172
    v_add_f32 v7, v7, v173
    v_add_f32 v6, v6, v174
    v_add_f32 v7, v7, v175
    v_cvt_pk_bf16_f32 v164, v168, v169
    v_cvt_pk_bf16_f32 v165, v170, v171
    v_cvt_pk_bf16_f32 v166, v172, v173
    v_cvt_pk_bf16_f32 v167, v174, v175
    s_waitcnt lgkmcnt(7)
    v_mfma_f32_32x32x16_bf16 v[48:63], v[192:195], v[144:147], v[48:63]
    ds_read_b128 v[224:227], v5 offset:8192
    s_waitcnt lgkmcnt(7)
    v_mfma_f32_32x32x16_bf16 v[64:79], v[196:199], v[144:147], v[64:79]
    ds_read_b128 v[228:231], v5 offset:8704
    s_waitcnt lgkmcnt(7)
    v_mfma_f32_32x32x16_bf16 v[80:95], v[200:203], v[144:147], v[80:95]
    ds_read_b128 v[232:235], v5 offset:9216
    s_waitcnt lgkmcnt(7)
    v_mfma_f32_32x32x16_bf16 v[96:111], v[204:207], v[144:147], v[96:111]
    ds_read_b128 v[236:239], v5 offset:9728
    s_waitcnt lgkmcnt(7)
    v_mfma_f32_32x32x16_bf16 v[48:63], v[208:211], v[148:151], v[48:63]
    ds_read_b128 v[240:243], v5 offset:12288
    s_waitcnt lgkmcnt(7)
    v_mfma_f32_32x32x16_bf16 v[64:79], v[212:215], v[148:151], v[64:79]
    ds_read_b128 v[244:247], v5 offset:12800
    s_waitcnt lgkmcnt(7)
    v_mfma_f32_32x32x16_bf16 v[80:95], v[216:219], v[148:151], v[80:95]
    ds_read_b128 v[248:251], v5 offset:13312
    s_waitcnt lgkmcnt(7)
    v_mfma_f32_32x32x16_bf16 v[96:111], v[220:223], v[148:151], v[96:111]
    ds_read_b128 v[252:255], v5 offset:13824
    s_waitcnt lgkmcnt(7)
    v_mfma_f32_32x32x16_bf16 v[48:63], v[224:227], v[160:163], v[48:63]
    s_waitcnt lgkmcnt(6)
    v_mfma_f32_32x32x16_bf16 v[64:79], v[228:231], v[160:163], v[64:79]
    s_waitcnt lgkmcnt(5)
    v_mfma_f32_32x32x16_bf16 v[80:95], v[232:235], v[160:163], v[80:95]
    s_waitcnt lgkmcnt(4)
    v_mfma_f32_32x32x16_bf16 v[96:111], v[236:239], v[160:163], v[96:111]
    s_waitcnt lgkmcnt(3)
    v_mfma_f32_32x32x16_bf16 v[48:63], v[240:243], v[164:167], v[48:63]
    s_waitcnt lgkmcnt(2)
    v_mfma_f32_32x32x16_bf16 v[64:79], v[244:247], v[164:167], v[64:79]
    s_waitcnt lgkmcnt(1)
    v_mfma_f32_32x32x16_bf16 v[80:95], v[248:251], v[164:167], v[80:95]
    s_waitcnt lgkmcnt(0)
    v_mfma_f32_32x32x16_bf16 v[96:111], v[252:255], v[164:167], v[96:111]
    v_add_f32 v6, v6, v7
    v_mov_b32 v7, v6
    s_nop 1
    v_permlane32_swap_b32 v6, v7
    s_nop 1
    v_add_f32 v6, v6, v7
    v_rcp_f32 v6, v6
    v_and_b32 v8, 31, v1
    v_add_u32 v8, s28, v8
    v_lshrrev_b32 v9, 4, v8
    v_lshlrev_b32 v9, 17, v9
    v_and_b32 v8, 15, v8
    v_lshl_add_u32 v8, v8, 4, v9
    v_lshrrev_b32 v9, 5, v1
    v_lshl_add_u32 v8, v9, 8, v8
    s_lshl_b32 s38, s27, 12
    s_nop 7
    v_mul_f32 v48, v48, v6
    v_mul_f32 v49, v49, v6
    v_mul_f32 v50, v50, v6
    v_mul_f32 v51, v51, v6
    v_mul_f32 v52, v52, v6
    v_mul_f32 v53, v53, v6
    v_mul_f32 v54, v54, v6
    v_mul_f32 v55, v55, v6
    v_cvt_pk_bf16_f32 v48, v48, v49
    v_cvt_pk_bf16_f32 v49, v50, v51
    v_cvt_pk_bf16_f32 v50, v52, v53
    v_cvt_pk_bf16_f32 v51, v54, v55
    buffer_store_dwordx4 v[48:51], v8, s[20:23], s38 offen offset:0 sc0 sc1
    v_mul_f32 v56, v56, v6
    v_mul_f32 v57, v57, v6
    v_mul_f32 v58, v58, v6
    v_mul_f32 v59, v59, v6
    v_mul_f32 v60, v60, v6
    v_mul_f32 v61, v61, v6
    v_mul_f32 v62, v62, v6
    v_mul_f32 v63, v63, v6
    v_cvt_pk_bf16_f32 v56, v56, v57
    v_cvt_pk_bf16_f32 v57, v58, v59
    v_cvt_pk_bf16_f32 v58, v60, v61
    v_cvt_pk_bf16_f32 v59, v62, v63
    buffer_store_dwordx4 v[56:59], v8, s[20:23], s38 offen offset:512 sc0 sc1
    v_mul_f32 v64, v64, v6
    v_mul_f32 v65, v65, v6
    v_mul_f32 v66, v66, v6
    v_mul_f32 v67, v67, v6
    v_mul_f32 v68, v68, v6
    v_mul_f32 v69, v69, v6
    v_mul_f32 v70, v70, v6
    v_mul_f32 v71, v71, v6
    v_cvt_pk_bf16_f32 v64, v64, v65
    v_cvt_pk_bf16_f32 v65, v66, v67
    v_cvt_pk_bf16_f32 v66, v68, v69
    v_cvt_pk_bf16_f32 v67, v70, v71
    buffer_store_dwordx4 v[64:67], v8, s[20:23], s38 offen offset:1024 sc0 sc1
    v_mul_f32 v72, v72, v6
    v_mul_f32 v73, v73, v6
    v_mul_f32 v74, v74, v6
    v_mul_f32 v75, v75, v6
    v_mul_f32 v76, v76, v6
    v_mul_f32 v77, v77, v6
    v_mul_f32 v78, v78, v6
    v_mul_f32 v79, v79, v6
    v_cvt_pk_bf16_f32 v72, v72, v73
    v_cvt_pk_bf16_f32 v73, v74, v75
    v_cvt_pk_bf16_f32 v74, v76, v77
    v_cvt_pk_bf16_f32 v75, v78, v79
    buffer_store_dwordx4 v[72:75], v8, s[20:23], s38 offen offset:1536 sc0 sc1
    v_mul_f32 v80, v80, v6
    v_mul_f32 v81, v81, v6
    v_mul_f32 v82, v82, v6
    v_mul_f32 v83, v83, v6
    v_mul_f32 v84, v84, v6
    v_mul_f32 v85, v85, v6
    v_mul_f32 v86, v86, v6
    v_mul_f32 v87, v87, v6
    v_cvt_pk_bf16_f32 v80, v80, v81
    v_cvt_pk_bf16_f32 v81, v82, v83
    v_cvt_pk_bf16_f32 v82, v84, v85
    v_cvt_pk_bf16_f32 v83, v86, v87
    buffer_store_dwordx4 v[80:83], v8, s[20:23], s38 offen offset:2048 sc0 sc1
    v_mul_f32 v88, v88, v6
    v_mul_f32 v89, v89, v6
    v_mul_f32 v90, v90, v6
    v_mul_f32 v91, v91, v6
    v_mul_f32 v92, v92, v6
    v_mul_f32 v93, v93, v6
    v_mul_f32 v94, v94, v6
    v_mul_f32 v95, v95, v6
    v_cvt_pk_bf16_f32 v88, v88, v89
    v_cvt_pk_bf16_f32 v89, v90, v91
    v_cvt_pk_bf16_f32 v90, v92, v93
    v_cvt_pk_bf16_f32 v91, v94, v95
    buffer_store_dwordx4 v[88:91], v8, s[20:23], s38 offen offset:2560 sc0 sc1
    v_mul_f32 v96, v96, v6
    v_mul_f32 v97, v97, v6
    v_mul_f32 v98, v98, v6
    v_mul_f32 v99, v99, v6
    v_mul_f32 v100, v100, v6
    v_mul_f32 v101, v101, v6
    v_mul_f32 v102, v102, v6
    v_mul_f32 v103, v103, v6
    v_cvt_pk_bf16_f32 v96, v96, v97
    v_cvt_pk_bf16_f32 v97, v98, v99
    v_cvt_pk_bf16_f32 v98, v100, v101
    v_cvt_pk_bf16_f32 v99, v102, v103
    buffer_store_dwordx4 v[96:99], v8, s[20:23], s38 offen offset:3072 sc0 sc1
    v_mul_f32 v104, v104, v6
    v_mul_f32 v105, v105, v6
    v_mul_f32 v106, v106, v6
    v_mul_f32 v107, v107, v6
    v_mul_f32 v108, v108, v6
    v_mul_f32 v109, v109, v6
    v_mul_f32 v110, v110, v6
    v_mul_f32 v111, v111, v6
    v_cvt_pk_bf16_f32 v104, v104, v105
    v_cvt_pk_bf16_f32 v105, v106, v107
    v_cvt_pk_bf16_f32 v106, v108, v109
    v_cvt_pk_bf16_f32 v107, v110, v111
    buffer_store_dwordx4 v[104:107], v8, s[20:23], s38 offen offset:3584 sc0 sc1
    s_branch L_attn_doneB
L_attn_doneB:
    s_endpgm
L_mask_45:
    s_nop 15
    s_add_u32 s38, s31, 1
    s_lshl_b32 s38, s38, 6
    v_subrev_u32 v9, s38, v11
    v_mov_b32 v10, 0xff800000
    v_cmp_gt_i32 vcc, 0, v9
    v_cmp_gt_i32 s[40:41], 1, v9
    v_cmp_gt_i32 s[42:43], 2, v9
    v_cndmask_b32 v112, v112, v10, vcc
    v_cndmask_b32 v113, v113, v10, s[40:41]
    v_cndmask_b32 v114, v114, v10, s[42:43]
    v_cmp_gt_i32 vcc, 3, v9
    v_cmp_gt_i32 s[40:41], 8, v9
    v_cmp_gt_i32 s[42:43], 9, v9
    v_cndmask_b32 v115, v115, v10, vcc
    v_cndmask_b32 v116, v116, v10, s[40:41]
    v_cndmask_b32 v117, v117, v10, s[42:43]
    v_cmp_gt_i32 vcc, 10, v9
    v_cmp_gt_i32 s[40:41], 11, v9
    v_cmp_gt_i32 s[42:43], 16, v9
    v_cndmask_b32 v118, v118, v10, vcc
    v_cndmask_b32 v119, v119, v10, s[40:41]
    v_cndmask_b32 v120, v120, v10, s[42:43]
    v_cmp_gt_i32 vcc, 17, v9
    v_cmp_gt_i32 s[40:41], 18, v9
    v_cmp_gt_i32 s[42:43], 19, v9
    v_cndmask_b32 v121, v121, v10, vcc
    v_cndmask_b32 v122, v122, v10, s[40:41]
    v_cndmask_b32 v123, v123, v10, s[42:43]
    v_cmp_gt_i32 vcc, 24, v9
    v_cmp_gt_i32 s[40:41], 25, v9
    v_cmp_gt_i32 s[42:43], 26, v9
    v_cndmask_b32 v124, v124, v10, vcc
    v_cndmask_b32 v125, v125, v10, s[40:41]
    v_cndmask_b32 v126, v126, v10, s[42:43]
    v_cmp_gt_i32 vcc, 27, v9
    v_cmp_gt_i32 s[40:41], 32, v9
    v_cmp_gt_i32 s[42:43], 33, v9
    v_cndmask_b32 v127, v127, v10, vcc
    v_cndmask_b32 v128, v128, v10, s[40:41]
    v_cndmask_b32 v129, v129, v10, s[42:43]
    v_cmp_gt_i32 vcc, 34, v9
    v_cmp_gt_i32 s[40:41], 35, v9
    v_cmp_gt_i32 s[42:43], 40, v9
    v_cndmask_b32 v130, v130, v10, vcc
    v_cndmask_b32 v131, v131, v10, s[40:41]
    v_cndmask_b32 v132, v132, v10, s[42:43]
    v_cmp_gt_i32 vcc, 41, v9
    v_cmp_gt_i32 s[40:41], 42, v9
    v_cmp_gt_i32 s[42:43], 43, v9
    v_cndmask_b32 v133, v133, v10, vcc
    v_cndmask_b32 v134, v134, v10, s[40:41]
    v_cndmask_b32 v135, v135, v10, s[42:43]
    v_cmp_gt_i32 vcc, 48, v9
    v_cmp_gt_i32 s[40:41], 49, v9
    v_cmp_gt_i32 s[42:43], 50, v9
    v_cndmask_b32 v136, v136, v10, vcc
    v_cndmask_b32 v137, v137, v10, s[40:41]
    v_cndmask_b32 v138, v138, v10, s[42:43]
    v_cmp_gt_i32 vcc, 51, v9
    v_cmp_gt_i32 s[40:41], 56, v9
    v_cmp_gt_i32 s[42:43], 57, v9
    v_cndmask_b32 v139, v139, v10, vcc
    v_cndmask_b32 v140, v140, v10, s[40:41]
    v_cndmask_b32 v141, v141, v10, s[42:43]
    v_cmp_gt_i32 vcc, 58, v9
    v_cmp_gt_i32 s[40:41], 59, v9
    s_nop 1
    v_cndmask_b32 v142, v142, v10, vcc
    v_cndmask_b32 v143, v143, v10, s[40:41]
    s_branch L_maskb_46
L_mask_47:
    s_add_u32 s38, s31, 1
    s_lshl_b32 s38, s38, 6
    v_subrev_u32 v9, s38, v11
    v_mov_b32 v10, 0xff800000
    v_cmp_gt_i32 vcc, 0, v9
    v_cmp_gt_i32 s[40:41], 1, v9
    v_cmp_gt_i32 s[42:43], 2, v9
    v_cndmask_b32 v144, v144, v10, vcc
    v_cndmask_b32 v145, v145, v10, s[40:41]
    v_cndmask_b32 v146, v146, v10, s[42:43]
    v_cmp_gt_i32 vcc, 3, v9
    v_cmp_gt_i32 s[40:41], 8, v9
    v_cmp_gt_i32 s[42:43], 9, v9
    v_cndmask_b32 v147, v147, v10, vcc
    v_cndmask_b32 v148, v148, v10, s[40:41]
    v_cndmask_b32 v149, v149, v10, s[42:43]
    v_cmp_gt_i32 vcc, 10, v9
    v_cmp_gt_i32 s[40:41], 11, v9
    v_cmp_gt_i32 s[42:43], 16, v9
    v_cndmask_b32 v150, v150, v10, vcc
    v_cndmask_b32 v151, v151, v10, s[40:41]
    v_cndmask_b32 v152, v152, v10, s[42:43]
    v_cmp_gt_i32 vcc, 17, v9
    v_cmp_gt_i32 s[40:41], 18, v9
    v_cmp_gt_i32 s[42:43], 19, v9
    v_cndmask_b32 v153, v153, v10, vcc
    v_cndmask_b32 v154, v154, v10, s[40:41]
    v_cndmask_b32 v155, v155, v10, s[42:43]
    v_cmp_gt_i32 vcc, 24, v9
    v_cmp_gt_i32 s[40:41], 25, v9
    v_cmp_gt_i32 s[42:43], 26, v9
    v_cndmask_b32 v156, v156, v10, vcc
    v_cndmask_b32 v157, v157, v10, s[40:41]
    v_cndmask_b32 v158, v158, v10, s[42:43]
    v_cmp_gt_i32 vcc, 27, v9
    v_cmp_gt_i32 s[40:41], 32, v9
    v_cmp_gt_i32 s[42:43], 33, v9
    v_cndmask_b32 v159, v159, v10, vcc
    v_cndmask_b32 v160, v160, v10, s[40:41]
    v_cndmask_b32 v161, v161, v10, s[42:43]
    v_cmp_gt_i32 vcc, 34, v9
    v_cmp_gt_i32 s[40:41], 35, v9
    v_cmp_gt_i32 s[42:43], 40, v9
    v_cndmask_b32 v162, v162, v10, vcc
    v_cndmask_b32 v163, v163, v10, s[40:41]
    v_cndmask_b32 v164, v164, v10, s[42:43]
    v_cmp_gt_i32 vcc, 41, v9
    v_cmp_gt_i32 s[40:41], 42, v9
    v_cmp_gt_i32 s[42:43], 43, v9
    v_cndmask_b32 v165, v165, v10, vcc
    v_cndmask_b32 v166, v166, v10, s[40:41]
    v_cndmask_b32 v167, v167, v10, s[42:43]
    v_cmp_gt_i32 vcc, 48, v9
    v_cmp_gt_i32 s[40:41], 49, v9
    v_cmp_gt_i32 s[42:43], 50, v9
    v_cndmask_b32 v168, v168, v10, vcc
    v_cndmask_b32 v169, v169, v10, s[40:41]
    v_cndmask_b32 v170, v170, v10, s[42:43]
    v_cmp_gt_i32 vcc, 51, v9
    v_cmp_gt_i32 s[40:41], 56, v9
    v_cmp_gt_i32 s[42:43], 57, v9
    v_cndmask_b32 v171, v171, v10, vcc
    v_cndmask_b32 v172, v172, v10, s[40:41]
    v_cndmask_b32 v173, v173, v10, s[42:43]
    v_cmp_gt_i32 vcc, 58, v9
    v_cmp_gt_i32 s[40:41], 59, v9
    s_nop 1
    v_cndmask_b32 v174, v174, v10, vcc
    v_cndmask_b32 v175, v175, v10, s[40:41]
    s_branch L_maskb_48
L_rs_49:
    s_nop 15
    v_max_f32 v8, 0, v8
    v_sub_f32 v9, 0, v8
    v_exp_f32 v9, v9
    s_nop 0
    v_mul_f32 v6, v6, v9
    v_mul_f32 v7, v7, v9
    v_mul_f32 v48, v48, v9
    v_mul_f32 v49, v49, v9
    v_mul_f32 v50, v50, v9
    v_mul_f32 v51, v51, v9
    v_mul_f32 v52, v52, v9
    v_mul_f32 v53, v53, v9
    v_mul_f32 v54, v54, v9
    v_mul_f32 v55, v55, v9
    v_mul_f32 v56, v56, v9
    v_mul_f32 v57, v57, v9
    v_mul_f32 v58, v58, v9
    v_mul_f32 v59, v59, v9
    v_mul_f32 v60, v60, v9
    v_mul_f32 v61, v61, v9
    v_mul_f32 v62, v62, v9
    v_mul_f32 v63, v63, v9
    v_mul_f32 v64, v64, v9
    v_mul_f32 v65, v65, v9
    v_mul_f32 v66, v66, v9
    v_mul_f32 v67, v67, v9
    v_mul_f32 v68, v68, v9
    v_mul_f32 v69, v69, v9
    v_mul_f32 v70, v70, v9
    v_mul_f32 v71, v71, v9
    v_mul_f32 v72, v72, v9
    v_mul_f32 v73, v73, v9
    v_mul_f32 v74, v74, v9
    v_mul_f32 v75, v75, v9
    v_mul_f32 v76, v76, v9
    v_mul_f32 v77, v77, v9
    v_mul_f32 v78, v78, v9
    v_mul_f32 v79, v79, v9
    v_mul_f32 v80, v80, v9
    v_mul_f32 v81, v81, v9
    v_mul_f32 v82, v82, v9
    v_mul_f32 v83, v83, v9
    v_mul_f32 v84, v84, v9
    v_mul_f32 v85, v85, v9
    v_mul_f32 v86, v86, v9
    v_mul_f32 v87, v87, v9
    v_mul_f32 v88, v88, v9
    v_mul_f32 v89, v89, v9
    v_mul_f32 v90, v90, v9
    v_mul_f32 v91, v91, v9
    v_mul_f32 v92, v92, v9
    v_mul_f32 v93, v93, v9
    v_mul_f32 v94, v94, v9
    v_mul_f32 v95, v95, v9
    v_mul_f32 v96, v96, v9
    v_mul_f32 v97, v97, v9
    v_mul_f32 v98, v98, v9
    v_mul_f32 v99, v99, v9
    v_mul_f32 v100, v100, v9
    v_mul_f32 v101, v101, v9
    v_mul_f32 v102, v102, v9
    v_mul_f32 v103, v103, v9
    v_mul_f32 v104, v104, v9
    v_mul_f32 v105, v105, v9
    v_mul_f32 v106, v106, v9
    v_mul_f32 v107, v107, v9
    v_mul_f32 v108, v108, v9
    v_mul_f32 v109, v109, v9
    v_mul_f32 v110, v110, v9
    v_mul_f32 v111, v111, v9
    v_sub_f32 v144, v144, v8
    v_sub_f32 v145, v145, v8
    v_sub_f32 v146, v146, v8
    v_sub_f32 v147, v147, v8
    v_sub_f32 v148, v148, v8
    v_sub_f32 v149, v149, v8
    v_sub_f32 v150, v150, v8
    v_sub_f32 v151, v151, v8
    v_sub_f32 v152, v152, v8
    v_sub_f32 v153, v153, v8
    v_sub_f32 v154, v154, v8
    v_sub_f32 v155, v155, v8
    v_sub_f32 v156, v156, v8
    v_sub_f32 v157, v157, v8
    v_sub_f32 v158, v158, v8
    v_sub_f32 v159, v159, v8
    v_sub_f32 v160, v160, v8
    v_sub_f32 v161, v161, v8
    v_sub_f32 v162, v162, v8
    v_sub_f32 v163, v163, v8
    v_sub_f32 v164, v164, v8
    v_sub_f32 v165, v165, v8
    v_sub_f32 v166, v166, v8
    v_sub_f32 v167, v167, v8
    v_sub_f32 v168, v168, v8
    v_sub_f32 v169, v169, v8
    v_sub_f32 v170, v170, v8
    v_sub_f32 v171, v171, v8
    v_sub_f32 v172, v172, v8
    v_sub_f32 v173, v173, v8
    v_sub_f32 v174, v174, v8
    v_sub_f32 v175, v175, v8
    v_sub_f32 v176, v176, v8
    v_sub_f32 v177, v177, v8
    v_sub_f32 v178, v178, v8
    v_sub_f32 v179, v179, v8
    v_sub_f32 v180, v180, v8
    v_sub_f32 v181, v181, v8
    v_sub_f32 v182, v182, v8
    v_sub_f32 v183, v183, v8
    v_sub_f32 v184, v184, v8
    v_sub_f32 v185, v185, v8
    v_sub_f32 v186, v186, v8
    v_sub_f32 v187, v187, v8
    v_sub_f32 v188, v188, v8
    v_sub_f32 v189, v189, v8
    v_sub_f32 v190, v190, v8
    v_sub_f32 v191, v191, v8
    s_nop 1
    s_branch L_rsb_50
L_mask_51:
    s_add_u32 s38, s31, 1
    s_lshl_b32 s38, s38, 6
    v_subrev_u32 v9, s38, v11
    v_mov_b32 v10, 0xff800000
    v_cmp_gt_i32 vcc, 0, v9
    v_cmp_gt_i32 s[40:41], 1, v9
    v_cmp_gt_i32 s[42:43], 2, v9
    v_cndmask_b32 v112, v112, v10, vcc
    v_cndmask_b32 v113, v113, v10, s[40:41]
    v_cndmask_b32 v114, v114, v10, s[42:43]
    v_cmp_gt_i32 vcc, 3, v9
    v_cmp_gt_i32 s[40:41], 8, v9
    v_cmp_gt_i32 s[42:43], 9, v9
    v_cndmask_b32 v115, v115, v10, vcc
    v_cndmask_b32 v116, v116, v10, s[40:41]
    v_cndmask_b32 v117, v117, v10, s[42:43]
    v_cmp_gt_i32 vcc, 10, v9
    v_cmp_gt_i32 s[40:41], 11, v9
    v_cmp_gt_i32 s[42:43], 16, v9
    v_cndmask_b32 v118, v118, v10, vcc
    v_cndmask_b32 v119, v119, v10, s[40:41]
    v_cndmask_b32 v120, v120, v10, s[42:43]
    v_cmp_gt_i32 vcc, 17, v9
    v_cmp_gt_i32 s[40:41], 18, v9
    v_cmp_gt_i32 s[42:43], 19, v9
    v_cndmask_b32 v121, v121, v10, vcc
    v_cndmask_b32 v122, v122, v10, s[40:41]
    v_cndmask_b32 v123, v123, v10, s[42:43]
    v_cmp_gt_i32 vcc, 24, v9
    v_cmp_gt_i32 s[40:41], 25, v9
    v_cmp_gt_i32 s[42:43], 26, v9
    v_cndmask_b32 v124, v124, v10, vcc
    v_cndmask_b32 v125, v125, v10, s[40:41]
    v_cndmask_b32 v126, v126, v10, s[42:43]
    v_cmp_gt_i32 vcc, 27, v9
    v_cmp_gt_i32 s[40:41], 32, v9
    v_cmp_gt_i32 s[42:43], 33, v9
    v_cndmask_b32 v127, v127, v10, vcc
    v_cndmask_b32 v128, v128, v10, s[40:41]
    v_cndmask_b32 v129, v129, v10, s[42:43]
    v_cmp_gt_i32 vcc, 34, v9
    v_cmp_gt_i32 s[40:41], 35, v9
    v_cmp_gt_i32 s[42:43], 40, v9
    v_cndmask_b32 v130, v130, v10, vcc
    v_cndmask_b32 v131, v131, v10, s[40:41]
    v_cndmask_b32 v132, v132, v10, s[42:43]
    v_cmp_gt_i32 vcc, 41, v9
    v_cmp_gt_i32 s[40:41], 42, v9
    v_cmp_gt_i32 s[42:43], 43, v9
    v_cndmask_b32 v133, v133, v10, vcc
    v_cndmask_b32 v134, v134, v10, s[40:41]
    v_cndmask_b32 v135, v135, v10, s[42:43]
    v_cmp_gt_i32 vcc, 48, v9
    v_cmp_gt_i32 s[40:41], 49, v9
    v_cmp_gt_i32 s[42:43], 50, v9
    v_cndmask_b32 v136, v136, v10, vcc
    v_cndmask_b32 v137, v137, v10, s[40:41]
    v_cndmask_b32 v138, v138, v10, s[42:43]
    v_cmp_gt_i32 vcc, 51, v9
    v_cmp_gt_i32 s[40:41], 56, v9
    v_cmp_gt_i32 s[42:43], 57, v9
    v_cndmask_b32 v139, v139, v10, vcc
    v_cndmask_b32 v140, v140, v10, s[40:41]
    v_cndmask_b32 v141, v141, v10, s[42:43]
    v_cmp_gt_i32 vcc, 58, v9
    v_cmp_gt_i32 s[40:41], 59, v9
    s_nop 1
    v_cndmask_b32 v142, v142, v10, vcc
    v_cndmask_b32 v143, v143, v10, s[40:41]
    s_branch L_maskb_52
L_rs_53:
    s_nop 15
    v_max_f32 v8, 0, v8
    v_sub_f32 v9, 0, v8
    v_exp_f32 v9, v9
    s_nop 0
    v_mul_f32 v6, v6, v9
    v_mul_f32 v7, v7, v9
    v_mul_f32 v48, v48, v9
    v_mul_f32 v49, v49, v9
    v_mul_f32 v50, v50, v9
    v_mul_f32 v51, v51, v9
    v_mul_f32 v52, v52, v9
    v_mul_f32 v53, v53, v9
    v_mul_f32 v54, v54, v9
    v_mul_f32 v55, v55, v9
    v_mul_f32 v56, v56, v9
    v_mul_f32 v57, v57, v9
    v_mul_f32 v58, v58, v9
    v_mul_f32 v59, v59, v9
    v_mul_f32 v60, v60, v9
    v_mul_f32 v61, v61, v9
    v_mul_f32 v62, v62, v9
    v_mul_f32 v63, v63, v9
    v_mul_f32 v64, v64, v9
    v_mul_f32 v65, v65, v9
    v_mul_f32 v66, v66, v9
    v_mul_f32 v67, v67, v9
    v_mul_f32 v68, v68, v9
    v_mul_f32 v69, v69, v9
    v_mul_f32 v70, v70, v9
    v_mul_f32 v71, v71, v9
    v_mul_f32 v72, v72, v9
    v_mul_f32 v73, v73, v9
    v_mul_f32 v74, v74, v9
    v_mul_f32 v75, v75, v9
    v_mul_f32 v76, v76, v9
    v_mul_f32 v77, v77, v9
    v_mul_f32 v78, v78, v9
    v_mul_f32 v79, v79, v9
    v_mul_f32 v80, v80, v9
    v_mul_f32 v81, v81, v9
    v_mul_f32 v82, v82, v9
    v_mul_f32 v83, v83, v9
    v_mul_f32 v84, v84, v9
    v_mul_f32 v85, v85, v9
    v_mul_f32 v86, v86, v9
    v_mul_f32 v87, v87, v9
    v_mul_f32 v88, v88, v9
    v_mul_f32 v89, v89, v9
    v_mul_f32 v90, v90, v9
    v_mul_f32 v91, v91, v9
    v_mul_f32 v92, v92, v9
    v_mul_f32 v93, v93, v9
    v_mul_f32 v94, v94, v9
    v_mul_f32 v95, v95, v9
    v_mul_f32 v96, v96, v9
    v_mul_f32 v97, v97, v9
    v_mul_f32 v98, v98, v9
    v_mul_f32 v99, v99, v9
    v_mul_f32 v100, v100, v9
    v_mul_f32 v101, v101, v9
    v_mul_f32 v102, v102, v9
    v_mul_f32 v103, v103, v9
    v_mul_f32 v104, v104, v9
    v_mul_f32 v105, v105, v9
    v_mul_f32 v106, v106, v9
    v_mul_f32 v107, v107, v9
    v_mul_f32 v108, v108, v9
    v_mul_f32 v109, v109, v9
    v_mul_f32 v110, v110, v9
    v_mul_f32 v111, v111, v9
    v_sub_f32 v112, v112, v8
    v_sub_f32 v113, v113, v8
    v_sub_f32 v114, v114, v8
    v_sub_f32 v115, v115, v8
    v_sub_f32 v116, v116, v8
    v_sub_f32 v117, v117, v8
    v_sub_f32 v118, v118, v8
    v_sub_f32 v119, v119, v8
    v_sub_f32 v120, v120, v8
    v_sub_f32 v121, v121, v8
    v_sub_f32 v122, v122, v8
    v_sub_f32 v123, v123, v8
    v_sub_f32 v124, v124, v8
    v_sub_f32 v125, v125, v8
    v_sub_f32 v126, v126, v8
    v_sub_f32 v127, v127, v8
    v_sub_f32 v128, v128, v8
    v_sub_f32 v129, v129, v8
    v_sub_f32 v130, v130, v8
    v_sub_f32 v131, v131, v8
    v_sub_f32 v132, v132, v8
    v_sub_f32 v133, v133, v8
    v_sub_f32 v134, v134, v8
    v_sub_f32 v135, v135, v8
    v_sub_f32 v136, v136, v8
    v_sub_f32 v137, v137, v8
    v_sub_f32 v138, v138, v8
    v_sub_f32 v139, v139, v8
    v_sub_f32 v140, v140, v8
    v_sub_f32 v141, v141, v8
    v_sub_f32 v142, v142, v8
    v_sub_f32 v143, v143, v8
    v_sub_f32 v176, v176, v8
    v_sub_f32 v177, v177, v8
    v_sub_f32 v178, v178, v8
    v_sub_f32 v179, v179, v8
    v_sub_f32 v180, v180, v8
    v_sub_f32 v181, v181, v8
    v_sub_f32 v182, v182, v8
    v_sub_f32 v183, v183, v8
    v_sub_f32 v184, v184, v8
    v_sub_f32 v185, v185, v8
    v_sub_f32 v186, v186, v8
    v_sub_f32 v187, v187, v8
    v_sub_f32 v188, v188, v8
    v_sub_f32 v189, v189, v8
    v_sub_f32 v190, v190, v8
    v_sub_f32 v191, v191, v8
    s_nop 1
    s_branch L_rsb_54
L_attn_end:
    s_endpgm
.globl oproj_kernel
.p2align 8
.type oproj_kernel,@function
oproj_kernel:
    s_cmp_ge_u32 s2, 256
    s_cbranch_scc1 L_oproj_kernel_end
    s_load_dwordx2 s[44:45], s[0:1], 40
    s_load_dwordx2 s[46:47], s[0:1], 104
    v_lshrrev_b32 v2, 6, v0
    v_and_b32 v1, 63, v0
    s_nop 0
    v_readfirstlane_b32 s20, v2
    s_nop 3
    s_and_b32 s21, s20, 3
    s_lshr_b32 s23, s20, 2
    s_and_b32 s26, s2, 3
    s_bfe_u32 s32, s2, 0x10002
    s_lshr_b32 s33, s2, 3
    s_and_b32 s34, s33, 3
    s_mul_i32 s25, s34, 144
    s_lshr_b32 s33, s33, 2
    s_lshl_b32 s32, s32, 3
    s_add_u32 s33, s33, s32
    s_lshl_b32 s24, s33, 7
    s_mul_i32 s27, s26, 32768
    s_mul_i32 s28, s26, 1179648
    s_waitcnt lgkmcnt(0)
    s_add_u32 s4, s46, 0x3000000
    s_addc_u32 s5, s47, 0
    s_mov_b32 s6, 0x1000000
    s_mov_b32 s7, 0x00020000
    s_mov_b32 s8, s44
    s_mov_b32 s9, s45
    s_mov_b32 s10, 0x480000
    s_mov_b32 s11, 0x00020000
    s_add_u32 s12, s46, 0x4000000
    s_addc_u32 s13, s47, 0
    s_mov_b32 s14, 0x1200000
    s_mov_b32 s15, 0x00020000
    s_lshr_b32 s32, s24, 4
    s_lshl_b32 s33, s21, 1
    s_add_u32 s32, s32, s33
    s_mul_i32 s32, s32, 131072
    s_add_u32 s27, s27, s32
    s_lshl_b32 s32, s23, 10
    s_add_u32 s27, s27, s32
    v_lshlrev_b32 v12, 4, v1
    v_add_u32 v13, 0x20000, v12
    s_lshl_b32 s34, s25, 1
    s_mov_b32 s33, 1152
    s_lshl_b32 s32, s20, 3
    v_add_u32 v2, 0, v1
    v_mul_u32_u24 v3, 57, v2
    v_lshrrev_b32 v3, 10, v3
    v_mul_u32_u24 v4, 18, v3
    v_sub_u32 v4, v2, v4
    v_add_u32 v3, s32, v3
    v_mul_lo_u32 v3, v3, s33
    v_lshl_add_u32 v3, v4, 4, v3
    v_add_u32 v14, s34, v3
    v_add_u32 v2, 64, v1
    v_mul_u32_u24 v3, 57, v2
    v_lshrrev_b32 v3, 10, v3
    v_mul_u32_u24 v4, 18, v3
    v_sub_u32 v4, v2, v4
    v_add_u32 v3, s32, v3
    v_mul_lo_u32 v3, v3, s33
    v_lshl_add_u32 v3, v4, 4, v3
    v_add_u32 v15, s34, v3
    v_add_u32 v2, 128, v1
    v_mul_u32_u24 v3, 57, v2
    v_lshrrev_b32 v3, 10, v3
    v_mul_u32_u24 v4, 18, v3
    v_sub_u32 v4, v2, v4
    v_add_u32 v3, s32, v3
    v_mul_lo_u32 v3, v3, s33
    v_lshl_add_u32 v3, v4, 4, v3
    v_add_u32 v16, s34, v3
    s_mul_i32 s30, s20, 2304
    buffer_load_dwordx4 v[20:23], v12, s[4:7], s27 offen
    buffer_load_dwordx4 v[24:27], v13, s[4:7], s27 offen
    s_add_u32 s27, s27, 2048
    s_add_u32 m0, s30, 0x0
    s_nop 0
    buffer_load_dwordx4 v14, s[8:11], s28 offen lds
    s_add_u32 m0, s30, 0x400
    s_nop 0
    buffer_load_dwordx4 v15, s[8:11], s28 offen lds
    s_add_u32 m0, s30, 0x800
    s_mov_b64 exec, 0xffff
    buffer_load_dwordx4 v16, s[8:11], s28 offen lds
    s_mov_b64 exec, -1
    s_add_u32 s28, s28, 0x12000
    buffer_load_dwordx4 v[28:31], v12, s[4:7], s27 offen
    buffer_load_dwordx4 v[32:35], v13, s[4:7], s27 offen
    s_add_u32 s27, s27, 2048
    s_add_u32 m0, s30, 0x4800
    s_nop 0
    buffer_load_dwordx4 v14, s[8:11], s28 offen lds
    s_add_u32 m0, s30, 0x4c00
    s_nop 0
    buffer_load_dwordx4 v15, s[8:11], s28 offen lds
    s_add_u32 m0, s30, 0x5000
    s_mov_b64 exec, 0xffff
    buffer_load_dwordx4 v16, s[8:11], s28 offen lds
    s_mov_b64 exec, -1
    s_add_u32 s28, s28, 0x12000
    buffer_load_dwordx4 v[36:39], v12, s[4:7], s27 offen
    buffer_load_dwordx4 v[40:43], v13, s[4:7], s27 offen
    s_add_u32 s27, s27, 2048
    s_add_u32 m0, s30, 0x9000
    s_nop 0
    buffer_load_dwordx4 v14, s[8:11], s28 offen lds
    s_add_u32 m0, s30, 0x9400
    s_nop 0
    buffer_load_dwordx4 v15, s[8:11], s28 offen lds
    s_add_u32 m0, s30, 0x9800
    s_mov_b64 exec, 0xffff
    buffer_load_dwordx4 v16, s[8:11], s28 offen lds
    s_mov_b64 exec, -1
    s_add_u32 s28, s28, 0x12000
    buffer_load_dwordx4 v[44:47], v12, s[4:7], s27 offen
    buffer_load_dwordx4 v[48:51], v13, s[4:7], s27 offen
    s_add_u32 s27, s27, 2048
    s_add_u32 m0, s30, 0xd800
    s_nop 0
    buffer_load_dwordx4 v14, s[8:11], s28 offen lds
    s_add_u32 m0, s30, 0xdc00
    s_nop 0
    buffer_load_dwordx4 v15, s[8:11], s28 offen lds
    s_add_u32 m0, s30, 0xe000
    s_mov_b64 exec, 0xffff
    buffer_load_dwordx4 v16, s[8:11], s28 offen lds
    s_mov_b64 exec, -1
    s_add_u32 s28, s28, 0x12000
    v_lshrrev_b32 v2, 4, v1
    v_bfe_u32 v3, v1, 2, 2
    v_and_b32 v4, 3, v1
    v_lshrrev_b32 v5, 1, v2
    v_lshl_add_u32 v3, v5, 4, v3
    v_and_b32 v5, 1, v2
    v_lshl_add_u32 v3, v5, 2, v3
    v_mul_u32_u24 v3, 288, v3
    v_lshl_add_u32 v17, v4, 3, v3
    s_mul_i32 s33, s23, 9216
    v_add_u32 v17, s33, v17
    v_add_u32 v18, 0x10000, v17
    v_mov_b32 v132, 0
    v_mov_b32 v133, 0
    v_mov_b32 v134, 0
    v_mov_b32 v135, 0
    v_mov_b32 v136, 0
    v_mov_b32 v137, 0
    v_mov_b32 v138, 0
    v_mov_b32 v139, 0
    v_mov_b32 v140, 0
    v_mov_b32 v141, 0
    v_mov_b32 v142, 0
    v_mov_b32 v143, 0
    v_mov_b32 v144, 0
    v_mov_b32 v145, 0
    v_mov_b32 v146, 0
    v_mov_b32 v147, 0
    v_mov_b32 v148, 0
    v_mov_b32 v149, 0
    v_mov_b32 v150, 0
    v_mov_b32 v151, 0
    v_mov_b32 v152, 0
    v_mov_b32 v153, 0
    v_mov_b32 v154, 0
    v_mov_b32 v155, 0
    v_mov_b32 v156, 0
    v_mov_b32 v157, 0
    v_mov_b32 v158, 0
    v_mov_b32 v159, 0
    v_mov_b32 v160, 0
    v_mov_b32 v161, 0
    v_mov_b32 v162, 0
    v_mov_b32 v163, 0
    v_mov_b32 v164, 0
    v_mov_b32 v165, 0
    v_mov_b32 v166, 0
    v_mov_b32 v167, 0
    v_mov_b32 v168, 0
    v_mov_b32 v169, 0
    v_mov_b32 v170, 0
    v_mov_b32 v171, 0
    v_mov_b32 v172, 0
    v_mov_b32 v173, 0
    v_mov_b32 v174, 0
    v_mov_b32 v175, 0
    v_mov_b32 v176, 0
    v_mov_b32 v177, 0
    v_mov_b32 v178, 0
    v_mov_b32 v179, 0
    v_mov_b32 v180, 0
    v_mov_b32 v181, 0
    v_mov_b32 v182, 0
    v_mov_b32 v183, 0
    v_mov_b32 v184, 0
    v_mov_b32 v185, 0
    v_mov_b32 v186, 0
    v_mov_b32 v187, 0
    v_mov_b32 v188, 0
    v_mov_b32 v189, 0
    v_mov_b32 v190, 0
    v_mov_b32 v191, 0
    v_mov_b32 v192, 0
    v_mov_b32 v193, 0
    v_mov_b32 v194, 0
    v_mov_b32 v195, 0
    v_mov_b32 v196, 0
    v_mov_b32 v197, 0
    v_mov_b32 v198, 0
    v_mov_b32 v199, 0
    v_mov_b32 v200, 0
    v_mov_b32 v201, 0
    v_mov_b32 v202, 0
    v_mov_b32 v203, 0
    s_mul_i32 s56, s26, 4718592
    s_lshl_b32 s58, s20, 4
    s_add_u32 s57, s24, s58
    s_mul_i32 s57, s57, 2304
    s_add_u32 s56, s56, s57
    s_lshl_b32 s57, s25, 2
    s_add_u32 s56, s56, s57
    s_mul_i32 s58, s58, 592
    v_add_u32 v3, 0, v1
    v_mul_u32_u24 v4, 1821, v3
    v_lshrrev_b32 v4, 16, v4
    v_mul_u32_u24 v5, 36, v4
    v_sub_u32 v5, v3, v5
    v_lshlrev_b32 v5, 4, v5
    v_mul_u32_u24 v204, 592, v4
    v_add3_u32 v204, v204, v5, s58
    v_add_u32 v206, 0x12800, v204
    v_mul_u32_u24 v205, 2304, v4
    v_add_u32 v205, v205, v5
    v_add_u32 v3, 64, v1
    v_mul_u32_u24 v4, 1821, v3
    v_lshrrev_b32 v4, 16, v4
    v_mul_u32_u24 v5, 36, v4
    v_sub_u32 v5, v3, v5
    v_lshlrev_b32 v5, 4, v5
    v_mul_u32_u24 v207, 592, v4
    v_add3_u32 v207, v207, v5, s58
    v_add_u32 v209, 0x12800, v207
    v_mul_u32_u24 v208, 2304, v4
    v_add_u32 v208, v208, v5
    v_add_u32 v3, 128, v1
    v_mul_u32_u24 v4, 1821, v3
    v_lshrrev_b32 v4, 16, v4
    v_mul_u32_u24 v5, 36, v4
    v_sub_u32 v5, v3, v5
    v_lshlrev_b32 v5, 4, v5
    v_mul_u32_u24 v210, 592, v4
    v_add3_u32 v210, v210, v5, s58
    v_add_u32 v212, 0x12800, v210
    v_mul_u32_u24 v211, 2304, v4
    v_add_u32 v211, v211, v5
    v_add_u32 v3, 192, v1
    v_mul_u32_u24 v4, 1821, v3
    v_lshrrev_b32 v4, 16, v4
    v_mul_u32_u24 v5, 36, v4
    v_sub_u32 v5, v3, v5
    v_lshlrev_b32 v5, 4, v5
    v_mul_u32_u24 v213, 592, v4
    v_add3_u32 v213, v213, v5, s58
    v_add_u32 v215, 0x12800, v213
    v_mul_u32_u24 v214, 2304, v4
    v_add_u32 v214, v214, v5
    v_add_u32 v3, 256, v1
    v_mul_u32_u24 v4, 1821, v3
    v_lshrrev_b32 v4, 16, v4
    v_mul_u32_u24 v5, 36, v4
    v_sub_u32 v5, v3, v5
    v_lshlrev_b32 v5, 4, v5
    v_mul_u32_u24 v216, 592, v4
    v_add3_u32 v216, v216, v5, s58
    v_add_u32 v218, 0x12800, v216
    v_mul_u32_u24 v217, 2304, v4
    v_add_u32 v217, v217, v5
    v_add_u32 v3, 320, v1
    v_mul_u32_u24 v4, 1821, v3
    v_lshrrev_b32 v4, 16, v4
    v_mul_u32_u24 v5, 36, v4
    v_sub_u32 v5, v3, v5
    v_lshlrev_b32 v5, 4, v5
    v_mul_u32_u24 v219, 592, v4
    v_add3_u32 v219, v219, v5, s58
    v_add_u32 v221, 0x12800, v219
    v_mul_u32_u24 v220, 2304, v4
    v_add_u32 v220, v220, v5
    v_add_u32 v3, 384, v1
    v_mul_u32_u24 v4, 1821, v3
    v_lshrrev_b32 v4, 16, v4
    v_mul_u32_u24 v5, 36, v4
    v_sub_u32 v5, v3, v5
    v_lshlrev_b32 v5, 4, v5
    v_mul_u32_u24 v222, 592, v4
    v_add3_u32 v222, v222, v5, s58
    v_add_u32 v224, 0x12800, v222
    v_mul_u32_u24 v223, 2304, v4
    v_add_u32 v223, v223, v5
    v_add_u32 v3, 448, v1
    v_mul_u32_u24 v4, 1821, v3
    v_lshrrev_b32 v4, 16, v4
    v_mul_u32_u24 v5, 36, v4
    v_sub_u32 v5, v3, v5
    v_lshlrev_b32 v5, 4, v5
    v_mul_u32_u24 v225, 592, v4
    v_add3_u32 v225, v225, v5, s58
    v_add_u32 v227, 0x12800, v225
    v_mul_u32_u24 v226, 2304, v4
    v_add_u32 v226, v226, v5
    v_add_u32 v3, 512, v1
    v_mul_u32_u24 v4, 1821, v3
    v_lshrrev_b32 v4, 16, v4
    v_mul_u32_u24 v5, 36, v4
    v_sub_u32 v5, v3, v5
    v_lshlrev_b32 v5, 4, v5
    v_mul_u32_u24 v228, 592, v4
    v_add3_u32 v228, v228, v5, s58
    v_add_u32 v230, 0x12800, v228
    v_mul_u32_u24 v229, 2304, v4
    v_add_u32 v229, v229, v5
    s_waitcnt vmcnt(15)
    s_barrier
    ds_read_b64_tr_b16 v[60:61], v17 offset:0
    ds_read_b64_tr_b16 v[62:63], v17 offset:2304
    ds_read_b64_tr_b16 v[64:65], v17 offset:32
    ds_read_b64_tr_b16 v[66:67], v17 offset:2336
    ds_read_b64_tr_b16 v[68:69], v17 offset:64
    ds_read_b64_tr_b16 v[70:71], v17 offset:2368
    ds_read_b64_tr_b16 v[72:73], v17 offset:96
    ds_read_b64_tr_b16 v[74:75], v17 offset:2400
    ds_read_b64_tr_b16 v[76:77], v17 offset:128
    ds_read_b64_tr_b16 v[78:79], v17 offset:2432
    ds_read_b64_tr_b16 v[80:81], v17 offset:160
    ds_read_b64_tr_b16 v[82:83], v17 offset:2464
    ds_read_b64_tr_b16 v[84:85], v17 offset:192
    ds_read_b64_tr_b16 v[86:87], v17 offset:2496
    ds_read_b64_tr_b16 v[88:89], v17 offset:224
    ds_read_b64_tr_b16 v[90:91], v17 offset:2528
    ds_read_b64_tr_b16 v[92:93], v17 offset:256
    ds_read_b64_tr_b16 v[94:95], v17 offset:2560
    s_waitcnt vmcnt(10) lgkmcnt(0)
    s_barrier
    v_mfma_f32_16x16x32_bf16 v[132:135], v[60:63], v[20:23], v[132:135]
    ds_read_b64_tr_b16 v[96:97], v17 offset:18432
    ds_read_b64_tr_b16 v[98:99], v17 offset:20736
    v_mfma_f32_16x16x32_bf16 v[136:139], v[60:63], v[24:27], v[136:139]
    ds_read_b64_tr_b16 v[100:101], v17 offset:18464
    v_mfma_f32_16x16x32_bf16 v[140:143], v[64:67], v[20:23], v[140:143]
    buffer_load_dwordx4 v[52:55], v12, s[4:7], s27 offen
    v_mfma_f32_16x16x32_bf16 v[144:147], v[64:67], v[24:27], v[144:147]
    ds_read_b64_tr_b16 v[102:103], v17 offset:20768
    ds_read_b64_tr_b16 v[104:105], v17 offset:18496
    v_mfma_f32_16x16x32_bf16 v[148:151], v[68:71], v[20:23], v[148:151]
    ds_read_b64_tr_b16 v[106:107], v17 offset:20800
    v_mfma_f32_16x16x32_bf16 v[152:155], v[68:71], v[24:27], v[152:155]
    buffer_load_dwordx4 v[56:59], v13, s[4:7], s27 offen
    s_add_u32 s27, s27, 2048
    v_mfma_f32_16x16x32_bf16 v[156:159], v[72:75], v[20:23], v[156:159]
    ds_read_b64_tr_b16 v[108:109], v17 offset:18528
    v_mfma_f32_16x16x32_bf16 v[160:163], v[72:75], v[24:27], v[160:163]
    ds_read_b64_tr_b16 v[110:111], v17 offset:20832
    ds_read_b64_tr_b16 v[112:113], v17 offset:18560
    v_mfma_f32_16x16x32_bf16 v[164:167], v[76:79], v[20:23], v[164:167]
    s_add_u32 m0, s30, 0x0
    s_nop 0
    buffer_load_dwordx4 v14, s[8:11], s28 offen lds
    v_mfma_f32_16x16x32_bf16 v[168:171], v[76:79], v[24:27], v[168:171]
    ds_read_b64_tr_b16 v[114:115], v17 offset:20864
    v_mfma_f32_16x16x32_bf16 v[172:175], v[80:83], v[20:23], v[172:175]
    ds_read_b64_tr_b16 v[116:117], v17 offset:18592
    ds_read_b64_tr_b16 v[118:119], v17 offset:20896
    v_mfma_f32_16x16x32_bf16 v[176:179], v[80:83], v[24:27], v[176:179]
    s_add_u32 m0, s30, 0x400
    s_nop 0
    buffer_load_dwordx4 v15, s[8:11], s28 offen lds
    v_mfma_f32_16x16x32_bf16 v[180:183], v[84:87], v[20:23], v[180:183]
    ds_read_b64_tr_b16 v[120:121], v17 offset:18624
    v_mfma_f32_16x16x32_bf16 v[184:187], v[84:87], v[24:27], v[184:187]
    ds_read_b64_tr_b16 v[122:123], v17 offset:20928
    v_mfma_f32_16x16x32_bf16 v[188:191], v[88:91], v[20:23], v[188:191]
    ds_read_b64_tr_b16 v[124:125], v17 offset:18656
    s_add_u32 m0, s30, 0x800
    s_mov_b64 exec, 0xffff
    buffer_load_dwordx4 v16, s[8:11], s28 offen lds
    s_mov_b64 exec, -1
    s_add_u32 s28, s28, 0x12000
    v_mfma_f32_16x16x32_bf16 v[192:195], v[88:91], v[24:27], v[192:195]
    ds_read_b64_tr_b16 v[126:127], v17 offset:20960
    v_mfma_f32_16x16x32_bf16 v[196:199], v[92:95], v[20:23], v[196:199]
    ds_read_b64_tr_b16 v[128:129], v17 offset:18688
    v_mfma_f32_16x16x32_bf16 v[200:203], v[92:95], v[24:27], v[200:203]
    ds_read_b64_tr_b16 v[130:131], v17 offset:20992
    s_waitcnt vmcnt(10) lgkmcnt(0)
    s_barrier
    v_mfma_f32_16x16x32_bf16 v[132:135], v[96:99], v[28:31], v[132:135]
    ds_read_b64_tr_b16 v[60:61], v17 offset:36864
    ds_read_b64_tr_b16 v[62:63], v17 offset:39168
    v_mfma_f32_16x16x32_bf16 v[136:139], v[96:99], v[32:35], v[136:139]
    ds_read_b64_tr_b16 v[64:65], v17 offset:36896
    v_mfma_f32_16x16x32_bf16 v[140:143], v[100:103], v[28:31], v[140:143]
    buffer_load_dwordx4 v[20:23], v12, s[4:7], s27 offen
    v_mfma_f32_16x16x32_bf16 v[144:147], v[100:103], v[32:35], v[144:147]
    ds_read_b64_tr_b16 v[66:67], v17 offset:39200
    ds_read_b64_tr_b16 v[68:69], v17 offset:36928
    v_mfma_f32_16x16x32_bf16 v[148:151], v[104:107], v[28:31], v[148:151]
    ds_read_b64_tr_b16 v[70:71], v17 offset:39232
    v_mfma_f32_16x16x32_bf16 v[152:155], v[104:107], v[32:35], v[152:155]
    buffer_load_dwordx4 v[24:27], v13, s[4:7], s27 offen
    s_add_u32 s27, s27, 2048
    v_mfma_f32_16x16x32_bf16 v[156:159], v[108:111], v[28:31], v[156:159]
    ds_read_b64_tr_b16 v[72:73], v17 offset:36960
    v_mfma_f32_16x16x32_bf16 v[160:163], v[108:111], v[32:35], v[160:163]
    ds_read_b64_tr_b16 v[74:75], v17 offset:39264
    ds_read_b64_tr_b16 v[76:77], v17 offset:36992
    v_mfma_f32_16x16x32_bf16 v[164:167], v[112:115], v[28:31], v[164:167]
    s_add_u32 m0, s30, 0x4800
    s_nop 0
    buffer_load_dwordx4 v14, s[8:11], s28 offen lds
    v_mfma_f32_16x16x32_bf16 v[168:171], v[112:115], v[32:35], v[168:171]
    ds_read_b64_tr_b16 v[78:79], v17 offset:39296
    v_mfma_f32_16x16x32_bf16 v[172:175], v[116:119], v[28:31], v[172:175]
    ds_read_b64_tr_b16 v[80:81], v17 offset:37024
    ds_read_b64_tr_b16 v[82:83], v17 offset:39328
    v_mfma_f32_16x16x32_bf16 v[176:179], v[116:119], v[32:35], v[176:179]
    s_add_u32 m0, s30, 0x4c00
    s_nop 0
    buffer_load_dwordx4 v15, s[8:11], s28 offen lds
    v_mfma_f32_16x16x32_bf16 v[180:183], v[120:123], v[28:31], v[180:183]
    ds_read_b64_tr_b16 v[84:85], v17 offset:37056
    v_mfma_f32_16x16x32_bf16 v[184:187], v[120:123], v[32:35], v[184:187]
    ds_read_b64_tr_b16 v[86:87], v17 offset:39360
    v_mfma_f32_16x16x32_bf16 v[188:191], v[124:127], v[28:31], v[188:191]
    ds_read_b64_tr_b16 v[88:89], v17 offset:37088
    s_add_u32 m0, s30, 0x5000
    s_mov_b64 exec, 0xffff
    buffer_load_dwordx4 v16, s[8:11], s28 offen lds
    s_mov_b64 exec, -1
    s_add_u32 s28, s28, 0x12000
    v_mfma_f32_16x16x32_bf16 v[192:195], v[124:127], v[32:35], v[192:195]
    ds_read_b64_tr_b16 v[90:91], v17 offset:39392
    v_mfma_f32_16x16x32_bf16 v[196:199], v[128:131], v[28:31], v[196:199]
    ds_read_b64_tr_b16 v[92:93], v17 offset:37120
    v_mfma_f32_16x16x32_bf16 v[200:203], v[128:131], v[32:35], v[200:203]
    ds_read_b64_tr_b16 v[94:95], v17 offset:39424
    s_waitcnt vmcnt(10) lgkmcnt(0)
    s_barrier
    v_mfma_f32_16x16x32_bf16 v[132:135], v[60:63], v[36:39], v[132:135]
    ds_read_b64_tr_b16 v[96:97], v17 offset:55296
    ds_read_b64_tr_b16 v[98:99], v17 offset:57600
    v_mfma_f32_16x16x32_bf16 v[136:139], v[60:63], v[40:43], v[136:139]
    ds_read_b64_tr_b16 v[100:101], v17 offset:55328
    v_mfma_f32_16x16x32_bf16 v[140:143], v[64:67], v[36:39], v[140:143]
    buffer_load_dwordx4 v[28:31], v12, s[4:7], s27 offen
    v_mfma_f32_16x16x32_bf16 v[144:147], v[64:67], v[40:43], v[144:147]
    ds_read_b64_tr_b16 v[102:103], v17 offset:57632
    ds_read_b64_tr_b16 v[104:105], v17 offset:55360
    v_mfma_f32_16x16x32_bf16 v[148:151], v[68:71], v[36:39], v[148:151]
    ds_read_b64_tr_b16 v[106:107], v17 offset:57664
    v_mfma_f32_16x16x32_bf16 v[152:155], v[68:71], v[40:43], v[152:155]
    buffer_load_dwordx4 v[32:35], v13, s[4:7], s27 offen
    s_add_u32 s27, s27, 2048
    v_mfma_f32_16x16x32_bf16 v[156:159], v[72:75], v[36:39], v[156:159]
    ds_read_b64_tr_b16 v[108:109], v17 offset:55392
    v_mfma_f32_16x16x32_bf16 v[160:163], v[72:75], v[40:43], v[160:163]
    ds_read_b64_tr_b16 v[110:111], v17 offset:57696
    ds_read_b64_tr_b16 v[112:113], v17 offset:55424
    v_mfma_f32_16x16x32_bf16 v[164:167], v[76:79], v[36:39], v[164:167]
    s_add_u32 m0, s30, 0x9000
    s_nop 0
    buffer_load_dwordx4 v14, s[8:11], s28 offen lds
    v_mfma_f32_16x16x32_bf16 v[168:171], v[76:79], v[40:43], v[168:171]
    ds_read_b64_tr_b16 v[114:115], v17 offset:57728
    v_mfma_f32_16x16x32_bf16 v[172:175], v[80:83], v[36:39], v[172:175]
    ds_read_b64_tr_b16 v[116:117], v17 offset:55456
    ds_read_b64_tr_b16 v[118:119], v17 offset:57760
    v_mfma_f32_16x16x32_bf16 v[176:179], v[80:83], v[40:43], v[176:179]
    s_add_u32 m0, s30, 0x9400
    s_nop 0
    buffer_load_dwordx4 v15, s[8:11], s28 offen lds
    v_mfma_f32_16x16x32_bf16 v[180:183], v[84:87], v[36:39], v[180:183]
    ds_read_b64_tr_b16 v[120:121], v17 offset:55488
    v_mfma_f32_16x16x32_bf16 v[184:187], v[84:87], v[40:43], v[184:187]
    ds_read_b64_tr_b16 v[122:123], v17 offset:57792
    v_mfma_f32_16x16x32_bf16 v[188:191], v[88:91], v[36:39], v[188:191]
    ds_read_b64_tr_b16 v[124:125], v17 offset:55520
    s_add_u32 m0, s30, 0x9800
    s_mov_b64 exec, 0xffff
    buffer_load_dwordx4 v16, s[8:11], s28 offen lds
    s_mov_b64 exec, -1
    s_add_u32 s28, s28, 0x12000
    v_mfma_f32_16x16x32_bf16 v[192:195], v[88:91], v[40:43], v[192:195]
    ds_read_b64_tr_b16 v[126:127], v17 offset:57824
    v_mfma_f32_16x16x32_bf16 v[196:199], v[92:95], v[36:39], v[196:199]
    ds_read_b64_tr_b16 v[128:129], v17 offset:55552
    v_mfma_f32_16x16x32_bf16 v[200:203], v[92:95], v[40:43], v[200:203]
    ds_read_b64_tr_b16 v[130:131], v17 offset:57856
    s_waitcnt vmcnt(10) lgkmcnt(0)
    s_barrier
    v_mfma_f32_16x16x32_bf16 v[132:135], v[96:99], v[44:47], v[132:135]
    ds_read_b64_tr_b16 v[60:61], v17 offset:0
    ds_read_b64_tr_b16 v[62:63], v17 offset:2304
    v_mfma_f32_16x16x32_bf16 v[136:139], v[96:99], v[48:51], v[136:139]
    ds_read_b64_tr_b16 v[64:65], v17 offset:32
    v_mfma_f32_16x16x32_bf16 v[140:143], v[100:103], v[44:47], v[140:143]
    buffer_load_dwordx4 v[36:39], v12, s[4:7], s27 offen
    v_mfma_f32_16x16x32_bf16 v[144:147], v[100:103], v[48:51], v[144:147]
    ds_read_b64_tr_b16 v[66:67], v17 offset:2336
    ds_read_b64_tr_b16 v[68:69], v17 offset:64
    v_mfma_f32_16x16x32_bf16 v[148:151], v[104:107], v[44:47], v[148:151]
    ds_read_b64_tr_b16 v[70:71], v17 offset:2368
    v_mfma_f32_16x16x32_bf16 v[152:155], v[104:107], v[48:51], v[152:155]
    buffer_load_dwordx4 v[40:43], v13, s[4:7], s27 offen
    s_add_u32 s27, s27, 2048
    v_mfma_f32_16x16x32_bf16 v[156:159], v[108:111], v[44:47], v[156:159]
    ds_read_b64_tr_b16 v[72:73], v17 offset:96
    v_mfma_f32_16x16x32_bf16 v[160:163], v[108:111], v[48:51], v[160:163]
    ds_read_b64_tr_b16 v[74:75], v17 offset:2400
    ds_read_b64_tr_b16 v[76:77], v17 offset:128
    v_mfma_f32_16x16x32_bf16 v[164:167], v[112:115], v[44:47], v[164:167]
    s_add_u32 m0, s30, 0xd800
    s_nop 0
    buffer_load_dwordx4 v14, s[8:11], s28 offen lds
    v_mfma_f32_16x16x32_bf16 v[168:171], v[112:115], v[48:51], v[168:171]
    ds_read_b64_tr_b16 v[78:79], v17 offset:2432
    v_mfma_f32_16x16x32_bf16 v[172:175], v[116:119], v[44:47], v[172:175]
    ds_read_b64_tr_b16 v[80:81], v17 offset:160
    ds_read_b64_tr_b16 v[82:83], v17 offset:2464
    v_mfma_f32_16x16x32_bf16 v[176:179], v[116:119], v[48:51], v[176:179]
    s_add_u32 m0, s30, 0xdc00
    s_nop 0
    buffer_load_dwordx4 v15, s[8:11], s28 offen lds
    v_mfma_f32_16x16x32_bf16 v[180:183], v[120:123], v[44:47], v[180:183]
    ds_read_b64_tr_b16 v[84:85], v17 offset:192
    v_mfma_f32_16x16x32_bf16 v[184:187], v[120:123], v[48:51], v[184:187]
    ds_read_b64_tr_b16 v[86:87], v17 offset:2496
    v_mfma_f32_16x16x32_bf16 v[188:191], v[124:127], v[44:47], v[188:191]
    ds_read_b64_tr_b16 v[88:89], v17 offset:224
    s_add_u32 m0, s30, 0xe000
    s_mov_b64 exec, 0xffff
    buffer_load_dwordx4 v16, s[8:11], s28 offen lds
    s_mov_b64 exec, -1
    s_add_u32 s28, s28, 0x12000
    v_mfma_f32_16x16x32_bf16 v[192:195], v[124:127], v[48:51], v[192:195]
    ds_read_b64_tr_b16 v[90:91], v17 offset:2528
    v_mfma_f32_16x16x32_bf16 v[196:199], v[128:131], v[44:47], v[196:199]
    ds_read_b64_tr_b16 v[92:93], v17 offset:256
    v_mfma_f32_16x16x32_bf16 v[200:203], v[128:131], v[48:51], v[200:203]
    ds_read_b64_tr_b16 v[94:95], v17 offset:2560
    s_waitcnt vmcnt(10) lgkmcnt(0)
    s_barrier
    v_mfma_f32_16x16x32_bf16 v[132:135], v[60:63], v[52:55], v[132:135]
    ds_read_b64_tr_b16 v[96:97], v17 offset:18432
    ds_read_b64_tr_b16 v[98:99], v17 offset:20736
    v_mfma_f32_16x16x32_bf16 v[136:139], v[60:63], v[56:59], v[136:139]
    ds_read_b64_tr_b16 v[100:101], v17 offset:18464
    v_mfma_f32_16x16x32_bf16 v[140:143], v[64:67], v[52:55], v[140:143]
    buffer_load_dwordx4 v[44:47], v12, s[4:7], s27 offen
    v_mfma_f32_16x16x32_bf16 v[144:147], v[64:67], v[56:59], v[144:147]
    ds_read_b64_tr_b16 v[102:103], v17 offset:20768
    ds_read_b64_tr_b16 v[104:105], v17 offset:18496
    v_mfma_f32_16x16x32_bf16 v[148:151], v[68:71], v[52:55], v[148:151]
    ds_read_b64_tr_b16 v[106:107], v17 offset:20800
    v_mfma_f32_16x16x32_bf16 v[152:155], v[68:71], v[56:59], v[152:155]
    buffer_load_dwordx4 v[48:51], v13, s[4:7], s27 offen
    s_add_u32 s27, s27, 2048
    v_mfma_f32_16x16x32_bf16 v[156:159], v[72:75], v[52:55], v[156:159]
    ds_read_b64_tr_b16 v[108:109], v17 offset:18528
    v_mfma_f32_16x16x32_bf16 v[160:163], v[72:75], v[56:59], v[160:163]
    ds_read_b64_tr_b16 v[110:111], v17 offset:20832
    ds_read_b64_tr_b16 v[112:113], v17 offset:18560
    v_mfma_f32_16x16x32_bf16 v[164:167], v[76:79], v[52:55], v[164:167]
    s_add_u32 m0, s30, 0x0
    s_nop 0
    buffer_load_dwordx4 v14, s[8:11], s28 offen lds
    v_mfma_f32_16x16x32_bf16 v[168:171], v[76:79], v[56:59], v[168:171]
    ds_read_b64_tr_b16 v[114:115], v17 offset:20864
    v_mfma_f32_16x16x32_bf16 v[172:175], v[80:83], v[52:55], v[172:175]
    ds_read_b64_tr_b16 v[116:117], v17 offset:18592
    ds_read_b64_tr_b16 v[118:119], v17 offset:20896
    v_mfma_f32_16x16x32_bf16 v[176:179], v[80:83], v[56:59], v[176:179]
    s_add_u32 m0, s30, 0x400
    s_nop 0
    buffer_load_dwordx4 v15, s[8:11], s28 offen lds
    v_mfma_f32_16x16x32_bf16 v[180:183], v[84:87], v[52:55], v[180:183]
    ds_read_b64_tr_b16 v[120:121], v17 offset:18624
    v_mfma_f32_16x16x32_bf16 v[184:187], v[84:87], v[56:59], v[184:187]
    ds_read_b64_tr_b16 v[122:123], v17 offset:20928
    v_mfma_f32_16x16x32_bf16 v[188:191], v[88:91], v[52:55], v[188:191]
    ds_read_b64_tr_b16 v[124:125], v17 offset:18656
    s_add_u32 m0, s30, 0x800
    s_mov_b64 exec, 0xffff
    buffer_load_dwordx4 v16, s[8:11], s28 offen lds
    s_mov_b64 exec, -1
    s_add_u32 s28, s28, 0x12000
    v_mfma_f32_16x16x32_bf16 v[192:195], v[88:91], v[56:59], v[192:195]
    ds_read_b64_tr_b16 v[126:127], v17 offset:20960
    v_mfma_f32_16x16x32_bf16 v[196:199], v[92:95], v[52:55], v[196:199]
    ds_read_b64_tr_b16 v[128:129], v17 offset:18688
    v_mfma_f32_16x16x32_bf16 v[200:203], v[92:95], v[56:59], v[200:203]
    ds_read_b64_tr_b16 v[130:131], v17 offset:20992
    s_waitcnt vmcnt(10) lgkmcnt(0)
    s_barrier
    v_mfma_f32_16x16x32_bf16 v[132:135], v[96:99], v[20:23], v[132:135]
    ds_read_b64_tr_b16 v[60:61], v17 offset:36864
    ds_read_b64_tr_b16 v[62:63], v17 offset:39168
    v_mfma_f32_16x16x32_bf16 v[136:139], v[96:99], v[24:27], v[136:139]
    ds_read_b64_tr_b16 v[64:65], v17 offset:36896
    v_mfma_f32_16x16x32_bf16 v[140:143], v[100:103], v[20:23], v[140:143]
    buffer_load_dwordx4 v[52:55], v12, s[4:7], s27 offen
    v_mfma_f32_16x16x32_bf16 v[144:147], v[100:103], v[24:27], v[144:147]
    ds_read_b64_tr_b16 v[66:67], v17 offset:39200
    ds_read_b64_tr_b16 v[68:69], v17 offset:36928
    v_mfma_f32_16x16x32_bf16 v[148:151], v[104:107], v[20:23], v[148:151]
    ds_read_b64_tr_b16 v[70:71], v17 offset:39232
    v_mfma_f32_16x16x32_bf16 v[152:155], v[104:107], v[24:27], v[152:155]
    buffer_load_dwordx4 v[56:59], v13, s[4:7], s27 offen
    s_add_u32 s27, s27, 2048
    v_mfma_f32_16x16x32_bf16 v[156:159], v[108:111], v[20:23], v[156:159]
    ds_read_b64_tr_b16 v[72:73], v17 offset:36960
    v_mfma_f32_16x16x32_bf16 v[160:163], v[108:111], v[24:27], v[160:163]
    ds_read_b64_tr_b16 v[74:75], v17 offset:39264
    ds_read_b64_tr_b16 v[76:77], v17 offset:36992
    v_mfma_f32_16x16x32_bf16 v[164:167], v[112:115], v[20:23], v[164:167]
    s_add_u32 m0, s30, 0x4800
    s_nop 0
    buffer_load_dwordx4 v14, s[8:11], s28 offen lds
    v_mfma_f32_16x16x32_bf16 v[168:171], v[112:115], v[24:27], v[168:171]
    ds_read_b64_tr_b16 v[78:79], v17 offset:39296
    v_mfma_f32_16x16x32_bf16 v[172:175], v[116:119], v[20:23], v[172:175]
    ds_read_b64_tr_b16 v[80:81], v17 offset:37024
    ds_read_b64_tr_b16 v[82:83], v17 offset:39328
    v_mfma_f32_16x16x32_bf16 v[176:179], v[116:119], v[24:27], v[176:179]
    s_add_u32 m0, s30, 0x4c00
    s_nop 0
    buffer_load_dwordx4 v15, s[8:11], s28 offen lds
    v_mfma_f32_16x16x32_bf16 v[180:183], v[120:123], v[20:23], v[180:183]
    ds_read_b64_tr_b16 v[84:85], v17 offset:37056
    v_mfma_f32_16x16x32_bf16 v[184:187], v[120:123], v[24:27], v[184:187]
    ds_read_b64_tr_b16 v[86:87], v17 offset:39360
    v_mfma_f32_16x16x32_bf16 v[188:191], v[124:127], v[20:23], v[188:191]
    ds_read_b64_tr_b16 v[88:89], v17 offset:37088
    s_add_u32 m0, s30, 0x5000
    s_mov_b64 exec, 0xffff
    buffer_load_dwordx4 v16, s[8:11], s28 offen lds
    s_mov_b64 exec, -1
    s_add_u32 s28, s28, 0x12000
    v_mfma_f32_16x16x32_bf16 v[192:195], v[124:127], v[24:27], v[192:195]
    ds_read_b64_tr_b16 v[90:91], v17 offset:39392
    v_mfma_f32_16x16x32_bf16 v[196:199], v[128:131], v[20:23], v[196:199]
    ds_read_b64_tr_b16 v[92:93], v17 offset:37120
    v_mfma_f32_16x16x32_bf16 v[200:203], v[128:131], v[24:27], v[200:203]
    ds_read_b64_tr_b16 v[94:95], v17 offset:39424
    s_waitcnt vmcnt(10) lgkmcnt(0)
    s_barrier
    v_mfma_f32_16x16x32_bf16 v[132:135], v[60:63], v[28:31], v[132:135]
    ds_read_b64_tr_b16 v[96:97], v17 offset:55296
    ds_read_b64_tr_b16 v[98:99], v17 offset:57600
    v_mfma_f32_16x16x32_bf16 v[136:139], v[60:63], v[32:35], v[136:139]
    ds_read_b64_tr_b16 v[100:101], v17 offset:55328
    v_mfma_f32_16x16x32_bf16 v[140:143], v[64:67], v[28:31], v[140:143]
    buffer_load_dwordx4 v[20:23], v12, s[4:7], s27 offen
    v_mfma_f32_16x16x32_bf16 v[144:147], v[64:67], v[32:35], v[144:147]
    ds_read_b64_tr_b16 v[102:103], v17 offset:57632
    ds_read_b64_tr_b16 v[104:105], v17 offset:55360
    v_mfma_f32_16x16x32_bf16 v[148:151], v[68:71], v[28:31], v[148:151]
    ds_read_b64_tr_b16 v[106:107], v17 offset:57664
    v_mfma_f32_16x16x32_bf16 v[152:155], v[68:71], v[32:35], v[152:155]
    buffer_load_dwordx4 v[24:27], v13, s[4:7], s27 offen
    s_add_u32 s27, s27, 2048
    v_mfma_f32_16x16x32_bf16 v[156:159], v[72:75], v[28:31], v[156:159]
    ds_read_b64_tr_b16 v[108:109], v17 offset:55392
    v_mfma_f32_16x16x32_bf16 v[160:163], v[72:75], v[32:35], v[160:163]
    ds_read_b64_tr_b16 v[110:111], v17 offset:57696
    ds_read_b64_tr_b16 v[112:113], v17 offset:55424
    v_mfma_f32_16x16x32_bf16 v[164:167], v[76:79], v[28:31], v[164:167]
    s_add_u32 m0, s30, 0x9000
    s_nop 0
    buffer_load_dwordx4 v14, s[8:11], s28 offen lds
    v_mfma_f32_16x16x32_bf16 v[168:171], v[76:79], v[32:35], v[168:171]
    ds_read_b64_tr_b16 v[114:115], v17 offset:57728
    v_mfma_f32_16x16x32_bf16 v[172:175], v[80:83], v[28:31], v[172:175]
    ds_read_b64_tr_b16 v[116:117], v17 offset:55456
    ds_read_b64_tr_b16 v[118:119], v17 offset:57760
    v_mfma_f32_16x16x32_bf16 v[176:179], v[80:83], v[32:35], v[176:179]
    s_add_u32 m0, s30, 0x9400
    s_nop 0
    buffer_load_dwordx4 v15, s[8:11], s28 offen lds
    v_mfma_f32_16x16x32_bf16 v[180:183], v[84:87], v[28:31], v[180:183]
    ds_read_b64_tr_b16 v[120:121], v17 offset:55488
    v_mfma_f32_16x16x32_bf16 v[184:187], v[84:87], v[32:35], v[184:187]
    ds_read_b64_tr_b16 v[122:123], v17 offset:57792
    v_mfma_f32_16x16x32_bf16 v[188:191], v[88:91], v[28:31], v[188:191]
    ds_read_b64_tr_b16 v[124:125], v17 offset:55520
    s_add_u32 m0, s30, 0x9800
    s_mov_b64 exec, 0xffff
    buffer_load_dwordx4 v16, s[8:11], s28 offen lds
    s_mov_b64 exec, -1
    s_add_u32 s28, s28, 0x12000
    v_mfma_f32_16x16x32_bf16 v[192:195], v[88:91], v[32:35], v[192:195]
    ds_read_b64_tr_b16 v[126:127], v17 offset:57824
    v_mfma_f32_16x16x32_bf16 v[196:199], v[92:95], v[28:31], v[196:199]
    ds_read_b64_tr_b16 v[128:129], v17 offset:55552
    v_mfma_f32_16x16x32_bf16 v[200:203], v[92:95], v[32:35], v[200:203]
    ds_read_b64_tr_b16 v[130:131], v17 offset:57856
    s_waitcnt vmcnt(10) lgkmcnt(0)
    s_barrier
    v_mfma_f32_16x16x32_bf16 v[132:135], v[96:99], v[36:39], v[132:135]
    ds_read_b64_tr_b16 v[60:61], v17 offset:0
    ds_read_b64_tr_b16 v[62:63], v17 offset:2304
    v_mfma_f32_16x16x32_bf16 v[136:139], v[96:99], v[40:43], v[136:139]
    ds_read_b64_tr_b16 v[64:65], v17 offset:32
    v_mfma_f32_16x16x32_bf16 v[140:143], v[100:103], v[36:39], v[140:143]
    buffer_load_dwordx4 v[28:31], v12, s[4:7], s27 offen
    v_mfma_f32_16x16x32_bf16 v[144:147], v[100:103], v[40:43], v[144:147]
    ds_read_b64_tr_b16 v[66:67], v17 offset:2336
    ds_read_b64_tr_b16 v[68:69], v17 offset:64
    v_mfma_f32_16x16x32_bf16 v[148:151], v[104:107], v[36:39], v[148:151]
    ds_read_b64_tr_b16 v[70:71], v17 offset:2368
    v_mfma_f32_16x16x32_bf16 v[152:155], v[104:107], v[40:43], v[152:155]
    buffer_load_dwordx4 v[32:35], v13, s[4:7], s27 offen
    s_add_u32 s27, s27, 2048
    v_mfma_f32_16x16x32_bf16 v[156:159], v[108:111], v[36:39], v[156:159]
    ds_read_b64_tr_b16 v[72:73], v17 offset:96
    v_mfma_f32_16x16x32_bf16 v[160:163], v[108:111], v[40:43], v[160:163]
    ds_read_b64_tr_b16 v[74:75], v17 offset:2400
    ds_read_b64_tr_b16 v[76:77], v17 offset:128
    v_mfma_f32_16x16x32_bf16 v[164:167], v[112:115], v[36:39], v[164:167]
    s_add_u32 m0, s30, 0xd800
    s_nop 0
    buffer_load_dwordx4 v14, s[8:11], s28 offen lds
    v_mfma_f32_16x16x32_bf16 v[168:171], v[112:115], v[40:43], v[168:171]
    ds_read_b64_tr_b16 v[78:79], v17 offset:2432
    v_mfma_f32_16x16x32_bf16 v[172:175], v[116:119], v[36:39], v[172:175]
    ds_read_b64_tr_b16 v[80:81], v17 offset:160
    ds_read_b64_tr_b16 v[82:83], v17 offset:2464
    v_mfma_f32_16x16x32_bf16 v[176:179], v[116:119], v[40:43], v[176:179]
    s_add_u32 m0, s30, 0xdc00
    s_nop 0
    buffer_load_dwordx4 v15, s[8:11], s28 offen lds
    v_mfma_f32_16x16x32_bf16 v[180:183], v[120:123], v[36:39], v[180:183]
    ds_read_b64_tr_b16 v[84:85], v17 offset:192
    v_mfma_f32_16x16x32_bf16 v[184:187], v[120:123], v[40:43], v[184:187]
    ds_read_b64_tr_b16 v[86:87], v17 offset:2496
    v_mfma_f32_16x16x32_bf16 v[188:191], v[124:127], v[36:39], v[188:191]
    ds_read_b64_tr_b16 v[88:89], v17 offset:224
    s_add_u32 m0, s30, 0xe000
    s_mov_b64 exec, 0xffff
    buffer_load_dwordx4 v16, s[8:11], s28 offen lds
    s_mov_b64 exec, -1
    s_add_u32 s28, s28, 0x12000
    v_mfma_f32_16x16x32_bf16 v[192:195], v[124:127], v[40:43], v[192:195]
    ds_read_b64_tr_b16 v[90:91], v17 offset:2528
    v_mfma_f32_16x16x32_bf16 v[196:199], v[128:131], v[36:39], v[196:199]
    ds_read_b64_tr_b16 v[92:93], v17 offset:256
    v_mfma_f32_16x16x32_bf16 v[200:203], v[128:131], v[40:43], v[200:203]
    ds_read_b64_tr_b16 v[94:95], v17 offset:2560
    s_waitcnt vmcnt(10) lgkmcnt(0)
    s_barrier
    v_mfma_f32_16x16x32_bf16 v[132:135], v[60:63], v[44:47], v[132:135]
    ds_read_b64_tr_b16 v[96:97], v17 offset:18432
    ds_read_b64_tr_b16 v[98:99], v17 offset:20736
    v_mfma_f32_16x16x32_bf16 v[136:139], v[60:63], v[48:51], v[136:139]
    ds_read_b64_tr_b16 v[100:101], v17 offset:18464
    v_mfma_f32_16x16x32_bf16 v[140:143], v[64:67], v[44:47], v[140:143]
    buffer_load_dwordx4 v[36:39], v12, s[4:7], s27 offen
    v_mfma_f32_16x16x32_bf16 v[144:147], v[64:67], v[48:51], v[144:147]
    ds_read_b64_tr_b16 v[102:103], v17 offset:20768
    ds_read_b64_tr_b16 v[104:105], v17 offset:18496
    v_mfma_f32_16x16x32_bf16 v[148:151], v[68:71], v[44:47], v[148:151]
    ds_read_b64_tr_b16 v[106:107], v17 offset:20800
    v_mfma_f32_16x16x32_bf16 v[152:155], v[68:71], v[48:51], v[152:155]
    buffer_load_dwordx4 v[40:43], v13, s[4:7], s27 offen
    s_add_u32 s27, s27, 2048
    v_mfma_f32_16x16x32_bf16 v[156:159], v[72:75], v[44:47], v[156:159]
    ds_read_b64_tr_b16 v[108:109], v17 offset:18528
    v_mfma_f32_16x16x32_bf16 v[160:163], v[72:75], v[48:51], v[160:163]
    ds_read_b64_tr_b16 v[110:111], v17 offset:20832
    ds_read_b64_tr_b16 v[112:113], v17 offset:18560
    v_mfma_f32_16x16x32_bf16 v[164:167], v[76:79], v[44:47], v[164:167]
    s_add_u32 m0, s30, 0x0
    s_nop 0
    buffer_load_dwordx4 v14, s[8:11], s28 offen lds
    v_mfma_f32_16x16x32_bf16 v[168:171], v[76:79], v[48:51], v[168:171]
    ds_read_b64_tr_b16 v[114:115], v17 offset:20864
    v_mfma_f32_16x16x32_bf16 v[172:175], v[80:83], v[44:47], v[172:175]
    ds_read_b64_tr_b16 v[116:117], v17 offset:18592
    ds_read_b64_tr_b16 v[118:119], v17 offset:20896
    v_mfma_f32_16x16x32_bf16 v[176:179], v[80:83], v[48:51], v[176:179]
    s_add_u32 m0, s30, 0x400
    s_nop 0
    buffer_load_dwordx4 v15, s[8:11], s28 offen lds
    v_mfma_f32_16x16x32_bf16 v[180:183], v[84:87], v[44:47], v[180:183]
    ds_read_b64_tr_b16 v[120:121], v17 offset:18624
    v_mfma_f32_16x16x32_bf16 v[184:187], v[84:87], v[48:51], v[184:187]
    ds_read_b64_tr_b16 v[122:123], v17 offset:20928
    v_mfma_f32_16x16x32_bf16 v[188:191], v[88:91], v[44:47], v[188:191]
    ds_read_b64_tr_b16 v[124:125], v17 offset:18656
    s_add_u32 m0, s30, 0x800
    s_mov_b64 exec, 0xffff
    buffer_load_dwordx4 v16, s[8:11], s28 offen lds
    s_mov_b64 exec, -1
    s_add_u32 s28, s28, 0x12000
    v_mfma_f32_16x16x32_bf16 v[192:195], v[88:91], v[48:51], v[192:195]
    ds_read_b64_tr_b16 v[126:127], v17 offset:20960
    v_mfma_f32_16x16x32_bf16 v[196:199], v[92:95], v[44:47], v[196:199]
    ds_read_b64_tr_b16 v[128:129], v17 offset:18688
    v_mfma_f32_16x16x32_bf16 v[200:203], v[92:95], v[48:51], v[200:203]
    ds_read_b64_tr_b16 v[130:131], v17 offset:20992
    s_waitcnt vmcnt(10) lgkmcnt(0)
    s_barrier
    v_mfma_f32_16x16x32_bf16 v[132:135], v[96:99], v[52:55], v[132:135]
    ds_read_b64_tr_b16 v[60:61], v17 offset:36864
    ds_read_b64_tr_b16 v[62:63], v17 offset:39168
    v_mfma_f32_16x16x32_bf16 v[136:139], v[96:99], v[56:59], v[136:139]
    ds_read_b64_tr_b16 v[64:65], v17 offset:36896
    v_mfma_f32_16x16x32_bf16 v[140:143], v[100:103], v[52:55], v[140:143]
    buffer_load_dwordx4 v[44:47], v12, s[4:7], s27 offen
    v_mfma_f32_16x16x32_bf16 v[144:147], v[100:103], v[56:59], v[144:147]
    ds_read_b64_tr_b16 v[66:67], v17 offset:39200
    ds_read_b64_tr_b16 v[68:69], v17 offset:36928
    v_mfma_f32_16x16x32_bf16 v[148:151], v[104:107], v[52:55], v[148:151]
    ds_read_b64_tr_b16 v[70:71], v17 offset:39232
    v_mfma_f32_16x16x32_bf16 v[152:155], v[104:107], v[56:59], v[152:155]
    buffer_load_dwordx4 v[48:51], v13, s[4:7], s27 offen
    s_add_u32 s27, s27, 2048
    v_mfma_f32_16x16x32_bf16 v[156:159], v[108:111], v[52:55], v[156:159]
    ds_read_b64_tr_b16 v[72:73], v17 offset:36960
    v_mfma_f32_16x16x32_bf16 v[160:163], v[108:111], v[56:59], v[160:163]
    ds_read_b64_tr_b16 v[74:75], v17 offset:39264
    ds_read_b64_tr_b16 v[76:77], v17 offset:36992
    v_mfma_f32_16x16x32_bf16 v[164:167], v[112:115], v[52:55], v[164:167]
    s_add_u32 m0, s30, 0x4800
    s_nop 0
    buffer_load_dwordx4 v14, s[8:11], s28 offen lds
    v_mfma_f32_16x16x32_bf16 v[168:171], v[112:115], v[56:59], v[168:171]
    ds_read_b64_tr_b16 v[78:79], v17 offset:39296
    v_mfma_f32_16x16x32_bf16 v[172:175], v[116:119], v[52:55], v[172:175]
    ds_read_b64_tr_b16 v[80:81], v17 offset:37024
    ds_read_b64_tr_b16 v[82:83], v17 offset:39328
    v_mfma_f32_16x16x32_bf16 v[176:179], v[116:119], v[56:59], v[176:179]
    s_add_u32 m0, s30, 0x4c00
    s_nop 0
    buffer_load_dwordx4 v15, s[8:11], s28 offen lds
    v_mfma_f32_16x16x32_bf16 v[180:183], v[120:123], v[52:55], v[180:183]
    ds_read_b64_tr_b16 v[84:85], v17 offset:37056
    v_mfma_f32_16x16x32_bf16 v[184:187], v[120:123], v[56:59], v[184:187]
    ds_read_b64_tr_b16 v[86:87], v17 offset:39360
    v_mfma_f32_16x16x32_bf16 v[188:191], v[124:127], v[52:55], v[188:191]
    ds_read_b64_tr_b16 v[88:89], v17 offset:37088
    s_add_u32 m0, s30, 0x5000
    s_mov_b64 exec, 0xffff
    buffer_load_dwordx4 v16, s[8:11], s28 offen lds
    s_mov_b64 exec, -1
    s_add_u32 s28, s28, 0x12000
    v_mfma_f32_16x16x32_bf16 v[192:195], v[124:127], v[56:59], v[192:195]
    ds_read_b64_tr_b16 v[90:91], v17 offset:39392
    v_mfma_f32_16x16x32_bf16 v[196:199], v[128:131], v[52:55], v[196:199]
    ds_read_b64_tr_b16 v[92:93], v17 offset:37120
    v_mfma_f32_16x16x32_bf16 v[200:203], v[128:131], v[56:59], v[200:203]
    ds_read_b64_tr_b16 v[94:95], v17 offset:39424
    s_waitcnt vmcnt(10) lgkmcnt(0)
    s_barrier
    v_mfma_f32_16x16x32_bf16 v[132:135], v[60:63], v[20:23], v[132:135]
    ds_read_b64_tr_b16 v[96:97], v17 offset:55296
    ds_read_b64_tr_b16 v[98:99], v17 offset:57600
    v_mfma_f32_16x16x32_bf16 v[136:139], v[60:63], v[24:27], v[136:139]
    ds_read_b64_tr_b16 v[100:101], v17 offset:55328
    v_mfma_f32_16x16x32_bf16 v[140:143], v[64:67], v[20:23], v[140:143]
    buffer_load_dwordx4 v[52:55], v12, s[4:7], s27 offen
    v_mfma_f32_16x16x32_bf16 v[144:147], v[64:67], v[24:27], v[144:147]
    ds_read_b64_tr_b16 v[102:103], v17 offset:57632
    ds_read_b64_tr_b16 v[104:105], v17 offset:55360
    v_mfma_f32_16x16x32_bf16 v[148:151], v[68:71], v[20:23], v[148:151]
    ds_read_b64_tr_b16 v[106:107], v17 offset:57664
    v_mfma_f32_16x16x32_bf16 v[152:155], v[68:71], v[24:27], v[152:155]
    buffer_load_dwordx4 v[56:59], v13, s[4:7], s27 offen
    s_add_u32 s27, s27, 2048
    v_mfma_f32_16x16x32_bf16 v[156:159], v[72:75], v[20:23], v[156:159]
    ds_read_b64_tr_b16 v[108:109], v17 offset:55392
    v_mfma_f32_16x16x32_bf16 v[160:163], v[72:75], v[24:27], v[160:163]
    ds_read_b64_tr_b16 v[110:111], v17 offset:57696
    ds_read_b64_tr_b16 v[112:113], v17 offset:55424
    v_mfma_f32_16x16x32_bf16 v[164:167], v[76:79], v[20:23], v[164:167]
    s_add_u32 m0, s30, 0x9000
    s_nop 0
    buffer_load_dwordx4 v14, s[8:11], s28 offen lds
    v_mfma_f32_16x16x32_bf16 v[168:171], v[76:79], v[24:27], v[168:171]
    ds_read_b64_tr_b16 v[114:115], v17 offset:57728
    v_mfma_f32_16x16x32_bf16 v[172:175], v[80:83], v[20:23], v[172:175]
    ds_read_b64_tr_b16 v[116:117], v17 offset:55456
    ds_read_b64_tr_b16 v[118:119], v17 offset:57760
    v_mfma_f32_16x16x32_bf16 v[176:179], v[80:83], v[24:27], v[176:179]
    s_add_u32 m0, s30, 0x9400
    s_nop 0
    buffer_load_dwordx4 v15, s[8:11], s28 offen lds
    v_mfma_f32_16x16x32_bf16 v[180:183], v[84:87], v[20:23], v[180:183]
    ds_read_b64_tr_b16 v[120:121], v17 offset:55488
    v_mfma_f32_16x16x32_bf16 v[184:187], v[84:87], v[24:27], v[184:187]
    ds_read_b64_tr_b16 v[122:123], v17 offset:57792
    v_mfma_f32_16x16x32_bf16 v[188:191], v[88:91], v[20:23], v[188:191]
    ds_read_b64_tr_b16 v[124:125], v17 offset:55520
    s_add_u32 m0, s30, 0x9800
    s_mov_b64 exec, 0xffff
    buffer_load_dwordx4 v16, s[8:11], s28 offen lds
    s_mov_b64 exec, -1
    s_add_u32 s28, s28, 0x12000
    v_mfma_f32_16x16x32_bf16 v[192:195], v[88:91], v[24:27], v[192:195]
    ds_read_b64_tr_b16 v[126:127], v17 offset:57824
    v_mfma_f32_16x16x32_bf16 v[196:199], v[92:95], v[20:23], v[196:199]
    ds_read_b64_tr_b16 v[128:129], v17 offset:55552
    v_mfma_f32_16x16x32_bf16 v[200:203], v[92:95], v[24:27], v[200:203]
    ds_read_b64_tr_b16 v[130:131], v17 offset:57856
    s_waitcnt vmcnt(10) lgkmcnt(0)
    s_barrier
    v_mfma_f32_16x16x32_bf16 v[132:135], v[96:99], v[28:31], v[132:135]
    ds_read_b64_tr_b16 v[60:61], v17 offset:0
    ds_read_b64_tr_b16 v[62:63], v17 offset:2304
    v_mfma_f32_16x16x32_bf16 v[136:139], v[96:99], v[32:35], v[136:139]
    ds_read_b64_tr_b16 v[64:65], v17 offset:32
    v_mfma_f32_16x16x32_bf16 v[140:143], v[100:103], v[28:31], v[140:143]
    buffer_load_dwordx4 v[20:23], v12, s[4:7], s27 offen
    v_mfma_f32_16x16x32_bf16 v[144:147], v[100:103], v[32:35], v[144:147]
    ds_read_b64_tr_b16 v[66:67], v17 offset:2336
    ds_read_b64_tr_b16 v[68:69], v17 offset:64
    v_mfma_f32_16x16x32_bf16 v[148:151], v[104:107], v[28:31], v[148:151]
    ds_read_b64_tr_b16 v[70:71], v17 offset:2368
    v_mfma_f32_16x16x32_bf16 v[152:155], v[104:107], v[32:35], v[152:155]
    buffer_load_dwordx4 v[24:27], v13, s[4:7], s27 offen
    s_add_u32 s27, s27, 2048
    v_mfma_f32_16x16x32_bf16 v[156:159], v[108:111], v[28:31], v[156:159]
    ds_read_b64_tr_b16 v[72:73], v17 offset:96
    v_mfma_f32_16x16x32_bf16 v[160:163], v[108:111], v[32:35], v[160:163]
    ds_read_b64_tr_b16 v[74:75], v17 offset:2400
    ds_read_b64_tr_b16 v[76:77], v17 offset:128
    v_mfma_f32_16x16x32_bf16 v[164:167], v[112:115], v[28:31], v[164:167]
    s_add_u32 m0, s30, 0xd800
    s_nop 0
    buffer_load_dwordx4 v14, s[8:11], s28 offen lds
    v_mfma_f32_16x16x32_bf16 v[168:171], v[112:115], v[32:35], v[168:171]
    ds_read_b64_tr_b16 v[78:79], v17 offset:2432
    v_mfma_f32_16x16x32_bf16 v[172:175], v[116:119], v[28:31], v[172:175]
    ds_read_b64_tr_b16 v[80:81], v17 offset:160
    ds_read_b64_tr_b16 v[82:83], v17 offset:2464
    v_mfma_f32_16x16x32_bf16 v[176:179], v[116:119], v[32:35], v[176:179]
    s_add_u32 m0, s30, 0xdc00
    s_nop 0
    buffer_load_dwordx4 v15, s[8:11], s28 offen lds
    v_mfma_f32_16x16x32_bf16 v[180:183], v[120:123], v[28:31], v[180:183]
    ds_read_b64_tr_b16 v[84:85], v17 offset:192
    v_mfma_f32_16x16x32_bf16 v[184:187], v[120:123], v[32:35], v[184:187]
    ds_read_b64_tr_b16 v[86:87], v17 offset:2496
    v_mfma_f32_16x16x32_bf16 v[188:191], v[124:127], v[28:31], v[188:191]
    ds_read_b64_tr_b16 v[88:89], v17 offset:224
    s_add_u32 m0, s30, 0xe000
    s_mov_b64 exec, 0xffff
    buffer_load_dwordx4 v16, s[8:11], s28 offen lds
    s_mov_b64 exec, -1
    s_add_u32 s28, s28, 0x12000
    v_mfma_f32_16x16x32_bf16 v[192:195], v[124:127], v[32:35], v[192:195]
    ds_read_b64_tr_b16 v[90:91], v17 offset:2528
    v_mfma_f32_16x16x32_bf16 v[196:199], v[128:131], v[28:31], v[196:199]
    ds_read_b64_tr_b16 v[92:93], v17 offset:256
    v_mfma_f32_16x16x32_bf16 v[200:203], v[128:131], v[32:35], v[200:203]
    ds_read_b64_tr_b16 v[94:95], v17 offset:2560
    s_waitcnt vmcnt(10) lgkmcnt(0)
    s_barrier
    v_mfma_f32_16x16x32_bf16 v[132:135], v[60:63], v[36:39], v[132:135]
    ds_read_b64_tr_b16 v[96:97], v17 offset:18432
    v_mfma_f32_16x16x32_bf16 v[136:139], v[60:63], v[40:43], v[136:139]
    ds_read_b64_tr_b16 v[98:99], v17 offset:20736
    v_mfma_f32_16x16x32_bf16 v[140:143], v[64:67], v[36:39], v[140:143]
    ds_read_b64_tr_b16 v[100:101], v17 offset:18464
    v_mfma_f32_16x16x32_bf16 v[144:147], v[64:67], v[40:43], v[144:147]
    ds_read_b64_tr_b16 v[102:103], v17 offset:20768
    v_mfma_f32_16x16x32_bf16 v[148:151], v[68:71], v[36:39], v[148:151]
    ds_read_b64_tr_b16 v[104:105], v17 offset:18496
    v_mfma_f32_16x16x32_bf16 v[152:155], v[68:71], v[40:43], v[152:155]
    ds_read_b64_tr_b16 v[106:107], v17 offset:20800
    v_mfma_f32_16x16x32_bf16 v[156:159], v[72:75], v[36:39], v[156:159]
    ds_read_b64_tr_b16 v[108:109], v17 offset:18528
    v_mfma_f32_16x16x32_bf16 v[160:163], v[72:75], v[40:43], v[160:163]
    ds_read_b64_tr_b16 v[110:111], v17 offset:20832
    v_mfma_f32_16x16x32_bf16 v[164:167], v[76:79], v[36:39], v[164:167]
    ds_read_b64_tr_b16 v[112:113], v17 offset:18560
    v_mfma_f32_16x16x32_bf16 v[168:171], v[76:79], v[40:43], v[168:171]
    ds_read_b64_tr_b16 v[114:115], v17 offset:20864
    v_mfma_f32_16x16x32_bf16 v[172:175], v[80:83], v[36:39], v[172:175]
    ds_read_b64_tr_b16 v[116:117], v17 offset:18592
    v_mfma_f32_16x16x32_bf16 v[176:179], v[80:83], v[40:43], v[176:179]
    ds_read_b64_tr_b16 v[118:119], v17 offset:20896
    v_mfma_f32_16x16x32_bf16 v[180:183], v[84:87], v[36:39], v[180:183]
    ds_read_b64_tr_b16 v[120:121], v17 offset:18624
    v_mfma_f32_16x16x32_bf16 v[184:187], v[84:87], v[40:43], v[184:187]
    ds_read_b64_tr_b16 v[122:123], v17 offset:20928
    v_mfma_f32_16x16x32_bf16 v[188:191], v[88:91], v[36:39], v[188:191]
    ds_read_b64_tr_b16 v[124:125], v17 offset:18656
    v_mfma_f32_16x16x32_bf16 v[192:195], v[88:91], v[40:43], v[192:195]
    ds_read_b64_tr_b16 v[126:127], v17 offset:20960
    v_mfma_f32_16x16x32_bf16 v[196:199], v[92:95], v[36:39], v[196:199]
    ds_read_b64_tr_b16 v[128:129], v17 offset:18688
    v_mfma_f32_16x16x32_bf16 v[200:203], v[92:95], v[40:43], v[200:203]
    ds_read_b64_tr_b16 v[130:131], v17 offset:20992
    s_waitcnt vmcnt(5) lgkmcnt(0)
    s_barrier
    v_mfma_f32_16x16x32_bf16 v[132:135], v[96:99], v[44:47], v[132:135]
    ds_read_b64_tr_b16 v[60:61], v17 offset:36864
    v_mfma_f32_16x16x32_bf16 v[136:139], v[96:99], v[48:51], v[136:139]
    ds_read_b64_tr_b16 v[62:63], v17 offset:39168
    v_mfma_f32_16x16x32_bf16 v[140:143], v[100:103], v[44:47], v[140:143]
    ds_read_b64_tr_b16 v[64:65], v17 offset:36896
    v_mfma_f32_16x16x32_bf16 v[144:147], v[100:103], v[48:51], v[144:147]
    ds_read_b64_tr_b16 v[66:67], v17 offset:39200
    v_mfma_f32_16x16x32_bf16 v[148:151], v[104:107], v[44:47], v[148:151]
    ds_read_b64_tr_b16 v[68:69], v17 offset:36928
    v_mfma_f32_16x16x32_bf16 v[152:155], v[104:107], v[48:51], v[152:155]
    ds_read_b64_tr_b16 v[70:71], v17 offset:39232
    v_mfma_f32_16x16x32_bf16 v[156:159], v[108:111], v[44:47], v[156:159]
    ds_read_b64_tr_b16 v[72:73], v17 offset:36960
    v_mfma_f32_16x16x32_bf16 v[160:163], v[108:111], v[48:51], v[160:163]
    ds_read_b64_tr_b16 v[74:75], v17 offset:39264
    v_mfma_f32_16x16x32_bf16 v[164:167], v[112:115], v[44:47], v[164:167]
    ds_read_b64_tr_b16 v[76:77], v17 offset:36992
    v_mfma_f32_16x16x32_bf16 v[168:171], v[112:115], v[48:51], v[168:171]
    ds_read_b64_tr_b16 v[78:79], v17 offset:39296
    v_mfma_f32_16x16x32_bf16 v[172:175], v[116:119], v[44:47], v[172:175]
    ds_read_b64_tr_b16 v[80:81], v17 offset:37024
    v_mfma_f32_16x16x32_bf16 v[176:179], v[116:119], v[48:51], v[176:179]
    ds_read_b64_tr_b16 v[82:83], v17 offset:39328
    v_mfma_f32_16x16x32_bf16 v[180:183], v[120:123], v[44:47], v[180:183]
    ds_read_b64_tr_b16 v[84:85], v17 offset:37056
    v_mfma_f32_16x16x32_bf16 v[184:187], v[120:123], v[48:51], v[184:187]
    ds_read_b64_tr_b16 v[86:87], v17 offset:39360
    v_mfma_f32_16x16x32_bf16 v[188:191], v[124:127], v[44:47], v[188:191]
    ds_read_b64_tr_b16 v[88:89], v17 offset:37088
    v_mfma_f32_16x16x32_bf16 v[192:195], v[124:127], v[48:51], v[192:195]
    ds_read_b64_tr_b16 v[90:91], v17 offset:39392
    v_mfma_f32_16x16x32_bf16 v[196:199], v[128:131], v[44:47], v[196:199]
    ds_read_b64_tr_b16 v[92:93], v17 offset:37120
    v_mfma_f32_16x16x32_bf16 v[200:203], v[128:131], v[48:51], v[200:203]
    ds_read_b64_tr_b16 v[94:95], v17 offset:39424
    s_waitcnt vmcnt(0) lgkmcnt(0)
    s_barrier
    v_mfma_f32_16x16x32_bf16 v[132:135], v[60:63], v[52:55], v[132:135]
    ds_read_b64_tr_b16 v[96:97], v17 offset:55296
    v_mfma_f32_16x16x32_bf16 v[136:139], v[60:63], v[56:59], v[136:139]
    ds_read_b64_tr_b16 v[98:99], v17 offset:57600
    v_mfma_f32_16x16x32_bf16 v[140:143], v[64:67], v[52:55], v[140:143]
    ds_read_b64_tr_b16 v[100:101], v17 offset:55328
    v_mfma_f32_16x16x32_bf16 v[144:147], v[64:67], v[56:59], v[144:147]
    ds_read_b64_tr_b16 v[102:103], v17 offset:57632
    v_mfma_f32_16x16x32_bf16 v[148:151], v[68:71], v[52:55], v[148:151]
    ds_read_b64_tr_b16 v[104:105], v17 offset:55360
    v_mfma_f32_16x16x32_bf16 v[152:155], v[68:71], v[56:59], v[152:155]
    ds_read_b64_tr_b16 v[106:107], v17 offset:57664
    v_mfma_f32_16x16x32_bf16 v[156:159], v[72:75], v[52:55], v[156:159]
    ds_read_b64_tr_b16 v[108:109], v17 offset:55392
    v_mfma_f32_16x16x32_bf16 v[160:163], v[72:75], v[56:59], v[160:163]
    ds_read_b64_tr_b16 v[110:111], v17 offset:57696
    v_mfma_f32_16x16x32_bf16 v[164:167], v[76:79], v[52:55], v[164:167]
    ds_read_b64_tr_b16 v[112:113], v17 offset:55424
    v_mfma_f32_16x16x32_bf16 v[168:171], v[76:79], v[56:59], v[168:171]
    ds_read_b64_tr_b16 v[114:115], v17 offset:57728
    v_mfma_f32_16x16x32_bf16 v[172:175], v[80:83], v[52:55], v[172:175]
    ds_read_b64_tr_b16 v[116:117], v17 offset:55456
    v_mfma_f32_16x16x32_bf16 v[176:179], v[80:83], v[56:59], v[176:179]
    ds_read_b64_tr_b16 v[118:119], v17 offset:57760
    v_mfma_f32_16x16x32_bf16 v[180:183], v[84:87], v[52:55], v[180:183]
    ds_read_b64_tr_b16 v[120:121], v17 offset:55488
    v_mfma_f32_16x16x32_bf16 v[184:187], v[84:87], v[56:59], v[184:187]
    ds_read_b64_tr_b16 v[122:123], v17 offset:57792
    v_mfma_f32_16x16x32_bf16 v[188:191], v[88:91], v[52:55], v[188:191]
    ds_read_b64_tr_b16 v[124:125], v17 offset:55520
    v_mfma_f32_16x16x32_bf16 v[192:195], v[88:91], v[56:59], v[192:195]
    ds_read_b64_tr_b16 v[126:127], v17 offset:57824
    v_mfma_f32_16x16x32_bf16 v[196:199], v[92:95], v[52:55], v[196:199]
    ds_read_b64_tr_b16 v[128:129], v17 offset:55552
    v_mfma_f32_16x16x32_bf16 v[200:203], v[92:95], v[56:59], v[200:203]
    ds_read_b64_tr_b16 v[130:131], v17 offset:57856
    s_waitcnt vmcnt(3) lgkmcnt(0)
    v_mfma_f32_16x16x32_bf16 v[132:135], v[96:99], v[20:23], v[132:135]
    v_mfma_f32_16x16x32_bf16 v[136:139], v[96:99], v[24:27], v[136:139]
    v_mfma_f32_16x16x32_bf16 v[140:143], v[100:103], v[20:23], v[140:143]
    v_mfma_f32_16x16x32_bf16 v[144:147], v[100:103], v[24:27], v[144:147]
    v_mfma_f32_16x16x32_bf16 v[148:151], v[104:107], v[20:23], v[148:151]
    v_mfma_f32_16x16x32_bf16 v[152:155], v[104:107], v[24:27], v[152:155]
    v_mfma_f32_16x16x32_bf16 v[156:159], v[108:111], v[20:23], v[156:159]
    v_mfma_f32_16x16x32_bf16 v[160:163], v[108:111], v[24:27], v[160:163]
    v_mfma_f32_16x16x32_bf16 v[164:167], v[112:115], v[20:23], v[164:167]
    v_mfma_f32_16x16x32_bf16 v[168:171], v[112:115], v[24:27], v[168:171]
    v_mfma_f32_16x16x32_bf16 v[172:175], v[116:119], v[20:23], v[172:175]
    v_mfma_f32_16x16x32_bf16 v[176:179], v[116:119], v[24:27], v[176:179]
    v_mfma_f32_16x16x32_bf16 v[180:183], v[120:123], v[20:23], v[180:183]
    v_mfma_f32_16x16x32_bf16 v[184:187], v[120:123], v[24:27], v[184:187]
    v_mfma_f32_16x16x32_bf16 v[188:191], v[124:127], v[20:23], v[188:191]
    v_mfma_f32_16x16x32_bf16 v[192:195], v[124:127], v[24:27], v[192:195]
    v_mfma_f32_16x16x32_bf16 v[196:199], v[128:131], v[20:23], v[196:199]
    v_mfma_f32_16x16x32_bf16 v[200:203], v[128:131], v[24:27], v[200:203]
    s_nop 15
    s_barrier
    s_lshl_b32 s32, s21, 5
    v_and_b32 v2, 15, v1
    v_add_u32 v2, s32, v2
    v_mul_u32_u24 v2, 592, v2
    v_lshrrev_b32 v3, 4, v1
    v_lshl_add_u32 v2, v3, 4, v2
    s_mul_i32 s32, s23, 75776
    v_add_u32 v2, s32, v2
    ds_write_b128 v2, v[132:135] offset:0
    ds_write_b128 v2, v[136:139] offset:9472
    ds_write_b128 v2, v[140:143] offset:64
    ds_write_b128 v2, v[144:147] offset:9536
    ds_write_b128 v2, v[148:151] offset:128
    ds_write_b128 v2, v[152:155] offset:9600
    ds_write_b128 v2, v[156:159] offset:192
    ds_write_b128 v2, v[160:163] offset:9664
    ds_write_b128 v2, v[164:167] offset:256
    ds_write_b128 v2, v[168:171] offset:9728
    ds_write_b128 v2, v[172:175] offset:320
    ds_write_b128 v2, v[176:179] offset:9792
    ds_write_b128 v2, v[180:183] offset:384
    ds_write_b128 v2, v[184:187] offset:9856
    ds_write_b128 v2, v[188:191] offset:448
    ds_write_b128 v2, v[192:195] offset:9920
    ds_write_b128 v2, v[196:199] offset:512
    ds_write_b128 v2, v[200:203] offset:9984
    s_waitcnt lgkmcnt(0)
    s_barrier
    ds_read_b128 v[132:135], v204
    ds_read_b128 v[136:139], v206
    ds_read_b128 v[140:143], v207
    ds_read_b128 v[144:147], v209
    ds_read_b128 v[148:151], v210
    ds_read_b128 v[152:155], v212
    ds_read_b128 v[156:159], v213
    ds_read_b128 v[160:163], v215
    ds_read_b128 v[164:167], v216
    ds_read_b128 v[168:171], v218
    ds_read_b128 v[172:175], v219
    ds_read_b128 v[176:179], v221
    ds_read_b128 v[180:183], v222
    ds_read_b128 v[184:187], v224
    ds_read_b128 v[188:191], v225
    ds_read_b128 v[192:195], v227
    ds_read_b128 v[196:199], v228
    ds_read_b128 v[200:203], v230
    s_waitcnt lgkmcnt(14)
    v_add_f32 v132, v132, v136
    v_add_f32 v133, v133, v137
    v_add_f32 v134, v134, v138
    v_add_f32 v135, v135, v139
    buffer_store_dwordx4 v[132:135], v205, s[12:15], s56 offen sc0 sc1
    s_waitcnt lgkmcnt(14)
    v_add_f32 v140, v140, v144
    v_add_f32 v141, v141, v145
    v_add_f32 v142, v142, v146
    v_add_f32 v143, v143, v147
    buffer_store_dwordx4 v[140:143], v208, s[12:15], s56 offen sc0 sc1
    s_waitcnt lgkmcnt(12)
    v_add_f32 v148, v148, v152
    v_add_f32 v149, v149, v153
    v_add_f32 v150, v150, v154
    v_add_f32 v151, v151, v155
    buffer_store_dwordx4 v[148:151], v211, s[12:15], s56 offen sc0 sc1
    s_waitcnt lgkmcnt(10)
    v_add_f32 v156, v156, v160
    v_add_f32 v157, v157, v161
    v_add_f32 v158, v158, v162
    v_add_f32 v159, v159, v163
    buffer_store_dwordx4 v[156:159], v214, s[12:15], s56 offen sc0 sc1
    s_waitcnt lgkmcnt(8)
    v_add_f32 v164, v164, v168
    v_add_f32 v165, v165, v169
    v_add_f32 v166, v166, v170
    v_add_f32 v167, v167, v171
    buffer_store_dwordx4 v[164:167], v217, s[12:15], s56 offen sc0 sc1
    s_waitcnt lgkmcnt(6)
    v_add_f32 v172, v172, v176
    v_add_f32 v173, v173, v177
    v_add_f32 v174, v174, v178
    v_add_f32 v175, v175, v179
    buffer_store_dwordx4 v[172:175], v220, s[12:15], s56 offen sc0 sc1
    s_waitcnt lgkmcnt(4)
    v_add_f32 v180, v180, v184
    v_add_f32 v181, v181, v185
    v_add_f32 v182, v182, v186
    v_add_f32 v183, v183, v187
    buffer_store_dwordx4 v[180:183], v223, s[12:15], s56 offen sc0 sc1
    s_waitcnt lgkmcnt(2)
    v_add_f32 v188, v188, v192
    v_add_f32 v189, v189, v193
    v_add_f32 v190, v190, v194
    v_add_f32 v191, v191, v195
    buffer_store_dwordx4 v[188:191], v226, s[12:15], s56 offen sc0 sc1
    s_waitcnt lgkmcnt(0)
    v_add_f32 v196, v196, v200
    v_add_f32 v197, v197, v201
    v_add_f32 v198, v198, v202
    v_add_f32 v199, v199, v203
    buffer_store_dwordx4 v[196:199], v229, s[12:15], s56 offen sc0 sc1
L_oproj_kernel_end:
    s_endpgm
.globl red1_kernel
.p2align 8
.type red1_kernel,@function
red1_kernel:
    s_cmp_ge_u32 s2, 512
    s_cbranch_scc1 L_red1_kernel_end
    v_lshrrev_b32 v2, 6, v0
    v_and_b32 v1, 63, v0
    s_nop 0
    v_readfirstlane_b32 s20, v2
    s_nop 3
    s_mul_i32 s32, s2, 4
    s_add_u32 s32, s32, s20
    s_load_dwordx2 s[46:47], s[0:1], 104
    s_load_dwordx2 s[44:45], s[0:1], 0
    s_mul_i32 s33, s32, 2304
    s_mul_i32 s34, s32, 1152
    s_lshr_b32 s38, s32, 4
    s_mul_i32 s38, s38, 18432
    s_and_b32 s39, s32, 15
    s_lshl_b32 s39, s39, 4
    s_add_u32 s38, s38, s39
    s_waitcnt lgkmcnt(0)
    s_add_u32 s4, s46, 0x4000000
    s_addc_u32 s5, s47, 0
    s_mov_b32 s6, 0x1200000
    s_mov_b32 s7, 0x00020000
    s_mov_b32 s16, s44
    s_mov_b32 s17, s45
    s_mov_b32 s18, 0x240000
    s_mov_b32 s19, 0x00020000
    s_add_u32 s12, s46, 0x400000
    s_addc_u32 s13, s47, 0
    s_mov_b32 s14, 0x240000
    s_mov_b32 s15, 0x00020000
    s_add_u32 s40, s46, 0x800000
    s_addc_u32 s41, s47, 0
    s_mov_b32 s42, 0x240000
    s_mov_b32 s43, 0x00020000
    v_lshlrev_b32 v4, 6, v1
    v_lshlrev_b32 v5, 5, v1
    s_mov_b32 exec_lo, 0xffffffff
    s_mov_b32 exec_hi, 0xf
    buffer_load_dwordx4 v[8:11], v4, s[4:7], s33 offen offset:0
    buffer_load_dwordx4 v[12:15], v4, s[4:7], s33 offen offset:16
    buffer_load_dwordx4 v[16:19], v4, s[4:7], s33 offen offset:32
    buffer_load_dwordx4 v[20:23], v4, s[4:7], s33 offen offset:48
    s_add_u32 s33, s33, 4718592
    buffer_load_dwordx4 v[24:27], v4, s[4:7], s33 offen offset:0
    buffer_load_dwordx4 v[28:31], v4, s[4:7], s33 offen offset:16
    buffer_load_dwordx4 v[32:35], v4, s[4:7], s33 offen offset:32
    buffer_load_dwordx4 v[36:39], v4, s[4:7], s33 offen offset:48
    s_add_u32 s33, s33, 4718592
    buffer_load_dwordx4 v[40:43], v4, s[4:7], s33 offen offset:0
    buffer_load_dwordx4 v[44:47], v4, s[4:7], s33 offen offset:16
    buffer_load_dwordx4 v[48:51], v4, s[4:7], s33 offen offset:32
    buffer_load_dwordx4 v[52:55], v4, s[4:7], s33 offen offset:48
    s_add_u32 s33, s33, 4718592
    buffer_load_dwordx4 v[56:59], v4, s[4:7], s33 offen offset:0
    buffer_load_dwordx4 v[60:63], v4, s[4:7], s33 offen offset:16
    buffer_load_dwordx4 v[64:67], v4, s[4:7], s33 offen offset:32
    buffer_load_dwordx4 v[68:71], v4, s[4:7], s33 offen offset:48
    buffer_load_dwordx4 v[72:75], v5, s[16:19], s34 offen offset:0
    buffer_load_dwordx4 v[76:79], v5, s[16:19], s34 offen offset:16
    v_lshrrev_b32 v6, 1, v1
    v_lshlrev_b32 v6, 10, v6
    v_and_b32 v104, 1, v1
    v_lshl_add_u32 v6, v104, 9, v6
    s_waitcnt vmcnt(0)
    v_add_f32 v8, v8, v24
    v_add_f32 v40, v40, v56
    v_add_f32 v9, v9, v25
    v_add_f32 v41, v41, v57
    v_add_f32 v10, v10, v26
    v_add_f32 v42, v42, v58
    v_add_f32 v11, v11, v27
    v_add_f32 v43, v43, v59
    v_add_f32 v12, v12, v28
    v_add_f32 v44, v44, v60
    v_add_f32 v13, v13, v29
    v_add_f32 v45, v45, v61
    v_add_f32 v14, v14, v30
    v_add_f32 v46, v46, v62
    v_add_f32 v15, v15, v31
    v_add_f32 v47, v47, v63
    v_add_f32 v16, v16, v32
    v_add_f32 v48, v48, v64
    v_add_f32 v17, v17, v33
    v_add_f32 v49, v49, v65
    v_add_f32 v18, v18, v34
    v_add_f32 v50, v50, v66
    v_add_f32 v19, v19, v35
    v_add_f32 v51, v51, v67
    v_add_f32 v20, v20, v36
    v_add_f32 v52, v52, v68
    v_add_f32 v21, v21, v37
    v_add_f32 v53, v53, v69
    v_add_f32 v22, v22, v38
    v_add_f32 v54, v54, v70
    v_add_f32 v23, v23, v39
    v_add_f32 v55, v55, v71
    v_add_f32 v8, v8, v40
    v_add_f32 v9, v9, v41
    v_add_f32 v10, v10, v42
    v_add_f32 v11, v11, v43
    v_add_f32 v12, v12, v44
    v_add_f32 v13, v13, v45
    v_add_f32 v14, v14, v46
    v_add_f32 v15, v15, v47
    v_add_f32 v16, v16, v48
    v_add_f32 v17, v17, v49
    v_add_f32 v18, v18, v50
    v_add_f32 v19, v19, v51
    v_add_f32 v20, v20, v52
    v_add_f32 v21, v21, v53
    v_add_f32 v22, v22, v54
    v_add_f32 v23, v23, v55
    v_cvt_pk_bf16_f32 v104, v8, v9
    v_lshlrev_b32 v8, 16, v104
    v_and_b32 v9, 0xffff0000, v104
    v_lshlrev_b32 v104, 16, v72
    v_and_b32 v105, 0xffff0000, v72
    v_add_f32 v8, v8, v104
    v_add_f32 v9, v9, v105
    v_cvt_pk_bf16_f32 v72, v8, v9
    v_lshlrev_b32 v88, 16, v72
    v_and_b32 v89, 0xffff0000, v72
    v_cvt_pk_bf16_f32 v104, v10, v11
    v_lshlrev_b32 v10, 16, v104
    v_and_b32 v11, 0xffff0000, v104
    v_lshlrev_b32 v104, 16, v73
    v_and_b32 v105, 0xffff0000, v73
    v_add_f32 v10, v10, v104
    v_add_f32 v11, v11, v105
    v_cvt_pk_bf16_f32 v73, v10, v11
    v_lshlrev_b32 v90, 16, v73
    v_and_b32 v91, 0xffff0000, v73
    v_cvt_pk_bf16_f32 v104, v12, v13
    v_lshlrev_b32 v12, 16, v104
    v_and_b32 v13, 0xffff0000, v104
    v_lshlrev_b32 v104, 16, v74
    v_and_b32 v105, 0xffff0000, v74
    v_add_f32 v12, v12, v104
    v_add_f32 v13, v13, v105
    v_cvt_pk_bf16_f32 v74, v12, v13
    v_lshlrev_b32 v92, 16, v74
    v_and_b32 v93, 0xffff0000, v74
    v_cvt_pk_bf16_f32 v104, v14, v15
    v_lshlrev_b32 v14, 16, v104
    v_and_b32 v15, 0xffff0000, v104
    v_lshlrev_b32 v104, 16, v75
    v_and_b32 v105, 0xffff0000, v75
    v_add_f32 v14, v14, v104
    v_add_f32 v15, v15, v105
    v_cvt_pk_bf16_f32 v75, v14, v15
    v_lshlrev_b32 v94, 16, v75
    v_and_b32 v95, 0xffff0000, v75
    v_cvt_pk_bf16_f32 v104, v16, v17
    v_lshlrev_b32 v16, 16, v104
    v_and_b32 v17, 0xffff0000, v104
    v_lshlrev_b32 v104, 16, v76
    v_and_b32 v105, 0xffff0000, v76
    v_add_f32 v16, v16, v104
    v_add_f32 v17, v17, v105
    v_cvt_pk_bf16_f32 v76, v16, v17
    v_lshlrev_b32 v96, 16, v76
    v_and_b32 v97, 0xffff0000, v76
    v_cvt_pk_bf16_f32 v104, v18, v19
    v_lshlrev_b32 v18, 16, v104
    v_and_b32 v19, 0xffff0000, v104
    v_lshlrev_b32 v104, 16, v77
    v_and_b32 v105, 0xffff0000, v77
    v_add_f32 v18, v18, v104
    v_add_f32 v19, v19, v105
    v_cvt_pk_bf16_f32 v77, v18, v19
    v_lshlrev_b32 v98, 16, v77
    v_and_b32 v99, 0xffff0000, v77
    v_cvt_pk_bf16_f32 v104, v20, v21
    v_lshlrev_b32 v20, 16, v104
    v_and_b32 v21, 0xffff0000, v104
    v_lshlrev_b32 v104, 16, v78
    v_and_b32 v105, 0xffff0000, v78
    v_add_f32 v20, v20, v104
    v_add_f32 v21, v21, v105
    v_cvt_pk_bf16_f32 v78, v20, v21
    v_lshlrev_b32 v100, 16, v78
    v_and_b32 v101, 0xffff0000, v78
    v_cvt_pk_bf16_f32 v104, v22, v23
    v_lshlrev_b32 v22, 16, v104
    v_and_b32 v23, 0xffff0000, v104
    v_lshlrev_b32 v104, 16, v79
    v_and_b32 v105, 0xffff0000, v79
    v_add_f32 v22, v22, v104
    v_add_f32 v23, v23, v105
    v_cvt_pk_bf16_f32 v79, v22, v23
    v_lshlrev_b32 v102, 16, v79
    v_and_b32 v103, 0xffff0000, v79
    buffer_store_dwordx4 v[72:75], v5, s[12:15], s34 offen offset:0
    buffer_store_dwordx4 v[76:79], v5, s[12:15], s34 offen offset:16
    s_mov_b64 exec, -1
    v_mov_b32 v104, 0
    s_mov_b32 exec_lo, 0xffffffff
    s_mov_b32 exec_hi, 0xf
    v_add_f32 v104, v104, v88
    v_add_f32 v104, v104, v89
    v_add_f32 v104, v104, v90
    v_add_f32 v104, v104, v91
    v_add_f32 v104, v104, v92
    v_add_f32 v104, v104, v93
    v_add_f32 v104, v104, v94
    v_add_f32 v104, v104, v95
    v_add_f32 v104, v104, v96
    v_add_f32 v104, v104, v97
    v_add_f32 v104, v104, v98
    v_add_f32 v104, v104, v99
    v_add_f32 v104, v104, v100
    v_add_f32 v104, v104, v101
    v_add_f32 v104, v104, v102
    v_add_f32 v104, v104, v103
    s_mov_b64 exec, -1
    s_nop 1
    v_add_f32_dpp v104, v104, v104 row_shr:1 row_mask:0xf bank_mask:0xf
    s_nop 1
    v_add_f32_dpp v104, v104, v104 row_shr:2 row_mask:0xf bank_mask:0xf
    s_nop 1
    v_add_f32_dpp v104, v104, v104 row_shr:4 row_mask:0xf bank_mask:0xf
    s_nop 1
    v_add_f32_dpp v104, v104, v104 row_shr:8 row_mask:0xf bank_mask:0xf
    s_nop 1
    v_add_f32_dpp v104, v104, v104 row_bcast:15 row_mask:0xa bank_mask:0xf
    s_nop 1
    v_add_f32_dpp v104, v104, v104 row_bcast:31 row_mask:0xc bank_mask:0xf
    s_nop 1
    v_readlane_b32 s36, v104, 63
    s_nop 3
    s_mov_b32 s37, 0x3ae38e39
    v_mov_b32 v105, s36
    v_mul_f32 v105, s37, v105
    v_mov_b32 v104, 0
    s_mov_b32 exec_lo, 0xffffffff
    s_mov_b32 exec_hi, 0xf
    v_sub_f32 v109, v88, v105
    v_fmac_f32 v104, v109, v109
    v_sub_f32 v109, v89, v105
    v_fmac_f32 v104, v109, v109
    v_sub_f32 v109, v90, v105
    v_fmac_f32 v104, v109, v109
    v_sub_f32 v109, v91, v105
    v_fmac_f32 v104, v109, v109
    v_sub_f32 v109, v92, v105
    v_fmac_f32 v104, v109, v109
    v_sub_f32 v109, v93, v105
    v_fmac_f32 v104, v109, v109
    v_sub_f32 v109, v94, v105
    v_fmac_f32 v104, v109, v109
    v_sub_f32 v109, v95, v105
    v_fmac_f32 v104, v109, v109
    v_sub_f32 v109, v96, v105
    v_fmac_f32 v104, v109, v109
    v_sub_f32 v109, v97, v105
    v_fmac_f32 v104, v109, v109
    v_sub_f32 v109, v98, v105
    v_fmac_f32 v104, v109, v109
    v_sub_f32 v109, v99, v105
    v_fmac_f32 v104, v109, v109
    v_sub_f32 v109, v100, v105
    v_fmac_f32 v104, v109, v109
    v_sub_f32 v109, v101, v105
    v_fmac_f32 v104, v109, v109
    v_sub_f32 v109, v102, v105
    v_fmac_f32 v104, v109, v109
    v_sub_f32 v109, v103, v105
    v_fmac_f32 v104, v109, v109
    s_mov_b64 exec, -1
    s_nop 1
    v_add_f32_dpp v104, v104, v104 row_shr:1 row_mask:0xf bank_mask:0xf
    s_nop 1
    v_add_f32_dpp v104, v104, v104 row_shr:2 row_mask:0xf bank_mask:0xf
    s_nop 1
    v_add_f32_dpp v104, v104, v104 row_shr:4 row_mask:0xf bank_mask:0xf
    s_nop 1
    v_add_f32_dpp v104, v104, v104 row_shr:8 row_mask:0xf bank_mask:0xf
    s_nop 1
    v_add_f32_dpp v104, v104, v104 row_bcast:15 row_mask:0xa bank_mask:0xf
    s_nop 1
    v_add_f32_dpp v104, v104, v104 row_bcast:31 row_mask:0xc bank_mask:0xf
    s_nop 1
    v_readlane_b32 s36, v104, 63
    s_nop 3
    v_mov_b32 v106, s36
    v_mul_f32 v106, s37, v106
    v_cvt_pk_bf16_f32 v106, v106, v105
    v_and_b32 v105, 0xffff0000, v106
    v_lshlrev_b32 v106, 16, v106
    v_add_f32 v106, 0x3727c5ac, v106
    v_cvt_pk_bf16_f32 v106, v106, v106
    v_lshlrev_b32 v106, 16, v106
    v_sqrt_f32 v106, v106
    s_nop 0
    v_cvt_pk_bf16_f32 v106, v106, v106
    v_lshlrev_b32 v106, 16, v106
    v_rcp_f32 v108, v106
    v_sub_f32 v109, v88, v105
    v_sub_f32 v107, v89, v105
    v_cvt_pk_bf16_f32 v109, v109, v107
    v_and_b32 v107, 0xffff0000, v109
    v_lshlrev_b32 v109, 16, v109
    v_mul_f32 v109, v109, v108
    v_mul_f32 v107, v107, v108
    v_cvt_pk_bf16_f32 v80, v109, v107
    v_sub_f32 v109, v90, v105
    v_sub_f32 v107, v91, v105
    v_cvt_pk_bf16_f32 v109, v109, v107
    v_and_b32 v107, 0xffff0000, v109
    v_lshlrev_b32 v109, 16, v109
    v_mul_f32 v109, v109, v108
    v_mul_f32 v107, v107, v108
    v_cvt_pk_bf16_f32 v81, v109, v107
    v_sub_f32 v109, v92, v105
    v_sub_f32 v107, v93, v105
    v_cvt_pk_bf16_f32 v109, v109, v107
    v_and_b32 v107, 0xffff0000, v109
    v_lshlrev_b32 v109, 16, v109
    v_mul_f32 v109, v109, v108
    v_mul_f32 v107, v107, v108
    v_cvt_pk_bf16_f32 v82, v109, v107
    v_sub_f32 v109, v94, v105
    v_sub_f32 v107, v95, v105
    v_cvt_pk_bf16_f32 v109, v109, v107
    v_and_b32 v107, 0xffff0000, v109
    v_lshlrev_b32 v109, 16, v109
    v_mul_f32 v109, v109, v108
    v_mul_f32 v107, v107, v108
    v_cvt_pk_bf16_f32 v83, v109, v107
    v_sub_f32 v109, v96, v105
    v_sub_f32 v107, v97, v105
    v_cvt_pk_bf16_f32 v109, v109, v107
    v_and_b32 v107, 0xffff0000, v109
    v_lshlrev_b32 v109, 16, v109
    v_mul_f32 v109, v109, v108
    v_mul_f32 v107, v107, v108
    v_cvt_pk_bf16_f32 v84, v109, v107
    v_sub_f32 v109, v98, v105
    v_sub_f32 v107, v99, v105
    v_cvt_pk_bf16_f32 v109, v109, v107
    v_and_b32 v107, 0xffff0000, v109
    v_lshlrev_b32 v109, 16, v109
    v_mul_f32 v109, v109, v108
    v_mul_f32 v107, v107, v108
    v_cvt_pk_bf16_f32 v85, v109, v107
    v_sub_f32 v109, v100, v105
    v_sub_f32 v107, v101, v105
    v_cvt_pk_bf16_f32 v109, v109, v107
    v_and_b32 v107, 0xffff0000, v109
    v_lshlrev_b32 v109, 16, v109
    v_mul_f32 v109, v109, v108
    v_mul_f32 v107, v107, v108
    v_cvt_pk_bf16_f32 v86, v109, v107
    v_sub_f32 v109, v102, v105
    v_sub_f32 v107, v103, v105
    v_cvt_pk_bf16_f32 v109, v109, v107
    v_and_b32 v107, 0xffff0000, v109
    v_lshlrev_b32 v109, 16, v109
    v_mul_f32 v109, v109, v108
    v_mul_f32 v107, v107, v108
    v_cvt_pk_bf16_f32 v87, v109, v107
    s_mov_b32 exec_lo, 0xffffffff
    s_mov_b32 exec_hi, 0xf
    buffer_store_dwordx4 v[80:83], v6, s[40:43], s38 offen
    buffer_store_dwordx4 v[84:87], v6, s[40:43], s38 offen offset:256
L_red1_kernel_end:
    s_endpgm
.globl mlp_up_kernel
.p2align 8
.type mlp_up_kernel,@function
mlp_up_kernel:
    s_cmp_ge_u32 s2, 256
    s_cbranch_scc1 L_mlp_up_kernel_end
    s_load_dwordx4 s[48:51], s[0:1], 56
    s_load_dwordx2 s[46:47], s[0:1], 104
    v_lshrrev_b32 v2, 6, v0
    v_and_b32 v1, 63, v0
    s_nop 0
    v_readfirstlane_b32 s20, v2
    s_nop 3
    s_and_b32 s21, s20, 7
    s_lshr_b32 s23, s20, 3
    s_and_b32 s32, s2, 7
    s_lshr_b32 s33, s2, 3
    s_and_b32 s34, s33, 3
    s_lshl_b32 s32, s32, 2
    s_add_u32 s26, s32, s34
    s_lshr_b32 s33, s33, 2
    s_lshl_b32 s24, s33, 8
    s_mul_i32 s25, s26, 144
    s_mov_b32 s27, 0
    s_mov_b32 s28, 0
    s_waitcnt lgkmcnt(0)
    s_add_u32 s4, s46, 0x800000
    s_addc_u32 s5, s47, 0
    s_mov_b32 s6, 0x240000
    s_mov_b32 s7, 0x00020000
    s_mov_b32 s8, s48
    s_mov_b32 s9, s49
    s_mov_b32 s10, 0x510000
    s_mov_b32 s11, 0x00020000
    s_add_u32 s12, s46, 0x6000000
    s_addc_u32 s13, s47, 0
    s_mov_b32 s14, 0x1200000
    s_mov_b32 s15, 0x00020000
    s_mov_b32 s16, s50
    s_mov_b32 s17, s51
    s_mov_b32 s18, 0x2400
    s_mov_b32 s19, 0x00020000
    s_lshr_b32 s32, s24, 4
    s_lshl_b32 s33, s21, 1
    s_add_u32 s32, s32, s33
    s_mul_i32 s32, s32, 18432
    s_add_u32 s27, s27, s32
    v_lshlrev_b32 v12, 4, v1
    v_add_u32 v13, 0x4800, v12
    s_lshl_b32 s34, s25, 1
    s_mov_b32 s33, 9216
    s_lshl_b32 s32, s20, 3
    v_add_u32 v2, 0, v1
    v_mul_u32_u24 v3, 57, v2
    v_lshrrev_b32 v3, 10, v3
    v_mul_u32_u24 v4, 18, v3
    v_sub_u32 v4, v2, v4
    v_add_u32 v3, s32, v3
    v_bfe_u32 v5, v3, 2, 1
    v_bfe_u32 v6, v3, 3, 1
    v_and_b32 v3, 0xfffffff3, v3
    v_lshl_or_b32 v3, v5, 3, v3
    v_lshl_or_b32 v3, v6, 2, v3
    v_mul_lo_u32 v3, v3, s33
    v_lshl_add_u32 v3, v4, 4, v3
    v_add_u32 v14, s34, v3
    v_add_u32 v2, 64, v1
    v_mul_u32_u24 v3, 57, v2
    v_lshrrev_b32 v3, 10, v3
    v_mul_u32_u24 v4, 18, v3
    v_sub_u32 v4, v2, v4
    v_add_u32 v3, s32, v3
    v_bfe_u32 v5, v3, 2, 1
    v_bfe_u32 v6, v3, 3, 1
    v_and_b32 v3, 0xfffffff3, v3
    v_lshl_or_b32 v3, v5, 3, v3
    v_lshl_or_b32 v3, v6, 2, v3
    v_mul_lo_u32 v3, v3, s33
    v_lshl_add_u32 v3, v4, 4, v3
    v_add_u32 v15, s34, v3
    v_add_u32 v2, 128, v1
    v_mul_u32_u24 v3, 57, v2
    v_lshrrev_b32 v3, 10, v3
    v_mul_u32_u24 v4, 18, v3
    v_sub_u32 v4, v2, v4
    v_add_u32 v3, s32, v3
    v_bfe_u32 v5, v3, 2, 1
    v_bfe_u32 v6, v3, 3, 1
    v_and_b32 v3, 0xfffffff3, v3
    v_lshl_or_b32 v3, v5, 3, v3
    v_lshl_or_b32 v3, v6, 2, v3
    v_mul_lo_u32 v3, v3, s33
    v_lshl_add_u32 v3, v4, 4, v3
    v_add_u32 v16, s34, v3
    s_mul_i32 s30, s20, 2304
    buffer_load_dwordx4 v[20:23], v12, s[4:7], s27 offen
    buffer_load_dwordx4 v[24:27], v13, s[4:7], s27 offen
    s_add_u32 s27, s27, 1024
    buffer_load_dwordx4 v[28:31], v12, s[4:7], s27 offen
    buffer_load_dwordx4 v[32:35], v13, s[4:7], s27 offen
    s_add_u32 s27, s27, 1024
    s_add_u32 m0, s30, 0x0
    s_nop 0
    buffer_load_dwordx4 v14, s[8:11], s28 offen lds
    s_add_u32 m0, s30, 0x400
    s_nop 0
    buffer_load_dwordx4 v15, s[8:11], s28 offen lds
    s_add_u32 m0, s30, 0x800
    s_mov_b64 exec, 0xffff
    buffer_load_dwordx4 v16, s[8:11], s28 offen lds
    s_mov_b64 exec, -1
    s_add_u32 s28, s28, 0x90000
    buffer_load_dwordx4 v[36:39], v12, s[4:7], s27 offen
    buffer_load_dwordx4 v[40:43], v13, s[4:7], s27 offen
    s_add_u32 s27, s27, 1024
    buffer_load_dwordx4 v[44:47], v12, s[4:7], s27 offen
    buffer_load_dwordx4 v[48:51], v13, s[4:7], s27 offen
    s_add_u32 s27, s27, 1024
    s_add_u32 m0, s30, 0x4800
    s_nop 0
    buffer_load_dwordx4 v14, s[8:11], s28 offen lds
    s_add_u32 m0, s30, 0x4c00
    s_nop 0
    buffer_load_dwordx4 v15, s[8:11], s28 offen lds
    s_add_u32 m0, s30, 0x5000
    s_mov_b64 exec, 0xffff
    buffer_load_dwordx4 v16, s[8:11], s28 offen lds
    s_mov_b64 exec, -1
    s_add_u32 s28, s28, 0x90000
    s_add_u32 m0, s30, 0x9000
    s_nop 0
    buffer_load_dwordx4 v14, s[8:11], s28 offen lds
    s_add_u32 m0, s30, 0x9400
    s_nop 0
    buffer_load_dwordx4 v15, s[8:11], s28 offen lds
    s_add_u32 m0, s30, 0x9800
    s_mov_b64 exec, 0xffff
    buffer_load_dwordx4 v16, s[8:11], s28 offen lds
    s_mov_b64 exec, -1
    s_add_u32 s28, s28, 0x90000
    v_lshrrev_b32 v2, 4, v1
    v_lshlrev_b32 v2, 3, v2
    s_lshl_b32 s32, s25, 1
    buffer_load_dwordx2 v[204:205], v2, s[16:19], s32 offen offset:0
    buffer_load_dwordx2 v[206:207], v2, s[16:19], s32 offen offset:32
    buffer_load_dwordx2 v[208:209], v2, s[16:19], s32 offen offset:64
    buffer_load_dwordx2 v[210:211], v2, s[16:19], s32 offen offset:96
    buffer_load_dwordx2 v[212:213], v2, s[16:19], s32 offen offset:128
    buffer_load_dwordx2 v[214:215], v2, s[16:19], s32 offen offset:160
    buffer_load_dwordx2 v[216:217], v2, s[16:19], s32 offen offset:192
    buffer_load_dwordx2 v[218:219], v2, s[16:19], s32 offen offset:224
    buffer_load_dwordx2 v[220:221], v2, s[16:19], s32 offen offset:256
    v_lshrrev_b32 v2, 4, v1
    v_bfe_u32 v3, v1, 2, 2
    v_and_b32 v4, 3, v1
    v_lshrrev_b32 v5, 1, v2
    v_lshl_add_u32 v3, v5, 4, v3
    v_and_b32 v5, 1, v2
    v_lshl_add_u32 v3, v5, 2, v3
    v_mul_u32_u24 v3, 288, v3
    v_lshl_add_u32 v17, v4, 3, v3
    v_mov_b32 v132, 0
    v_mov_b32 v133, 0
    v_mov_b32 v134, 0
    v_mov_b32 v135, 0
    v_mov_b32 v136, 0
    v_mov_b32 v137, 0
    v_mov_b32 v138, 0
    v_mov_b32 v139, 0
    v_mov_b32 v140, 0
    v_mov_b32 v141, 0
    v_mov_b32 v142, 0
    v_mov_b32 v143, 0
    v_mov_b32 v144, 0
    v_mov_b32 v145, 0
    v_mov_b32 v146, 0
    v_mov_b32 v147, 0
    v_mov_b32 v148, 0
    v_mov_b32 v149, 0
    v_mov_b32 v150, 0
    v_mov_b32 v151, 0
    v_mov_b32 v152, 0
    v_mov_b32 v153, 0
    v_mov_b32 v154, 0
    v_mov_b32 v155, 0
    v_mov_b32 v156, 0
    v_mov_b32 v157, 0
    v_mov_b32 v158, 0
    v_mov_b32 v159, 0
    v_mov_b32 v160, 0
    v_mov_b32 v161, 0
    v_mov_b32 v162, 0
    v_mov_b32 v163, 0
    v_mov_b32 v164, 0
    v_mov_b32 v165, 0
    v_mov_b32 v166, 0
    v_mov_b32 v167, 0
    v_mov_b32 v168, 0
    v_mov_b32 v169, 0
    v_mov_b32 v170, 0
    v_mov_b32 v171, 0
    v_mov_b32 v172, 0
    v_mov_b32 v173, 0
    v_mov_b32 v174, 0
    v_mov_b32 v175, 0
    v_mov_b32 v176, 0
    v_mov_b32 v177, 0
    v_mov_b32 v178, 0
    v_mov_b32 v179, 0
    v_mov_b32 v180, 0
    v_mov_b32 v181, 0
    v_mov_b32 v182, 0
    v_mov_b32 v183, 0
    v_mov_b32 v184, 0
    v_mov_b32 v185, 0
    v_mov_b32 v186, 0
    v_mov_b32 v187, 0
    v_mov_b32 v188, 0
    v_mov_b32 v189, 0
    v_mov_b32 v190, 0
    v_mov_b32 v191, 0
    v_mov_b32 v192, 0
    v_mov_b32 v193, 0
    v_mov_b32 v194, 0
    v_mov_b32 v195, 0
    v_mov_b32 v196, 0
    v_mov_b32 v197, 0
    v_mov_b32 v198, 0
    v_mov_b32 v199, 0
    v_mov_b32 v200, 0
    v_mov_b32 v201, 0
    v_mov_b32 v202, 0
    v_mov_b32 v203, 0
    s_mul_i32 s58, s20, 9728
    v_and_b32 v2, 15, v1
    v_mul_u32_u24 v2, 304, v2
    v_lshrrev_b32 v3, 4, v1
    s_lshr_b32 s56, s24, 4
    s_lshl_b32 s57, s21, 1
    s_add_u32 s56, s56, s57
    s_mul_i32 s56, s56, 147456
    s_mul_i32 s57, s26, 18
    v_and_b32 v5, 15, v1
    v_lshlrev_b32 v5, 4, v5
    v_add_u32 v2, s58, v2
    s_mov_b32 s59, 147456
    v_add_u32 v6, 0, v3
    v_mul_u32_u24 v7, 57, v6
    v_lshrrev_b32 v7, 10, v7
    v_mul_u32_u24 v8, 18, v7
    v_sub_u32 v8, v6, v8
    v_mul_u32_u24 v222, 4864, v7
    v_lshl_add_u32 v222, v8, 4, v222
    v_add_u32 v222, v222, v2
    v_add_u32 v8, s57, v8
    v_lshrrev_b32 v9, 2, v8
    v_lshl_add_u32 v9, v9, 10, v5
    v_and_b32 v8, 3, v8
    v_lshl_add_u32 v9, v8, 8, v9
    v_mul_lo_u32 v7, v7, s59
    v_add_u32 v223, v9, v7
    v_add_u32 v6, 4, v3
    v_mul_u32_u24 v7, 57, v6
    v_lshrrev_b32 v7, 10, v7
    v_mul_u32_u24 v8, 18, v7
    v_sub_u32 v8, v6, v8
    v_mul_u32_u24 v224, 4864, v7
    v_lshl_add_u32 v224, v8, 4, v224
    v_add_u32 v224, v224, v2
    v_add_u32 v8, s57, v8
    v_lshrrev_b32 v9, 2, v8
    v_lshl_add_u32 v9, v9, 10, v5
    v_and_b32 v8, 3, v8
    v_lshl_add_u32 v9, v8, 8, v9
    v_mul_lo_u32 v7, v7, s59
    v_add_u32 v225, v9, v7
    v_add_u32 v6, 8, v3
    v_mul_u32_u24 v7, 57, v6
    v_lshrrev_b32 v7, 10, v7
    v_mul_u32_u24 v8, 18, v7
    v_sub_u32 v8, v6, v8
    v_mul_u32_u24 v226, 4864, v7
    v_lshl_add_u32 v226, v8, 4, v226
    v_add_u32 v226, v226, v2
    v_add_u32 v8, s57, v8
    v_lshrrev_b32 v9, 2, v8
    v_lshl_add_u32 v9, v9, 10, v5
    v_and_b32 v8, 3, v8
    v_lshl_add_u32 v9, v8, 8, v9
    v_mul_lo_u32 v7, v7, s59
    v_add_u32 v227, v9, v7
    v_add_u32 v6, 12, v3
    v_mul_u32_u24 v7, 57, v6
    v_lshrrev_b32 v7, 10, v7
    v_mul_u32_u24 v8, 18, v7
    v_sub_u32 v8, v6, v8
    v_mul_u32_u24 v228, 4864, v7
    v_lshl_add_u32 v228, v8, 4, v228
    v_add_u32 v228, v228, v2
    v_add_u32 v8, s57, v8
    v_lshrrev_b32 v9, 2, v8
    v_lshl_add_u32 v9, v9, 10, v5
    v_and_b32 v8, 3, v8
    v_lshl_add_u32 v9, v8, 8, v9
    v_mul_lo_u32 v7, v7, s59
    v_add_u32 v229, v9, v7
    v_add_u32 v6, 16, v3
    v_mul_u32_u24 v7, 57, v6
    v_lshrrev_b32 v7, 10, v7
    v_mul_u32_u24 v8, 18, v7
    v_sub_u32 v8, v6, v8
    v_mul_u32_u24 v230, 4864, v7
    v_lshl_add_u32 v230, v8, 4, v230
    v_add_u32 v230, v230, v2
    v_add_u32 v8, s57, v8
    v_lshrrev_b32 v9, 2, v8
    v_lshl_add_u32 v9, v9, 10, v5
    v_and_b32 v8, 3, v8
    v_lshl_add_u32 v9, v8, 8, v9
    v_mul_lo_u32 v7, v7, s59
    v_add_u32 v231, v9, v7
    v_add_u32 v6, 20, v3
    v_mul_u32_u24 v7, 57, v6
    v_lshrrev_b32 v7, 10, v7
    v_mul_u32_u24 v8, 18, v7
    v_sub_u32 v8, v6, v8
    v_mul_u32_u24 v232, 4864, v7
    v_lshl_add_u32 v232, v8, 4, v232
    v_add_u32 v232, v232, v2
    v_add_u32 v8, s57, v8
    v_lshrrev_b32 v9, 2, v8
    v_lshl_add_u32 v9, v9, 10, v5
    v_and_b32 v8, 3, v8
    v_lshl_add_u32 v9, v8, 8, v9
    v_mul_lo_u32 v7, v7, s59
    v_add_u32 v233, v9, v7
    v_add_u32 v6, 24, v3
    v_mul_u32_u24 v7, 57, v6
    v_lshrrev_b32 v7, 10, v7
    v_mul_u32_u24 v8, 18, v7
    v_sub_u32 v8, v6, v8
    v_mul_u32_u24 v234, 4864, v7
    v_lshl_add_u32 v234, v8, 4, v234
    v_add_u32 v234, v234, v2
    v_add_u32 v8, s57, v8
    v_lshrrev_b32 v9, 2, v8
    v_lshl_add_u32 v9, v9, 10, v5
    v_and_b32 v8, 3, v8
    v_lshl_add_u32 v9, v8, 8, v9
    v_mul_lo_u32 v7, v7, s59
    v_add_u32 v235, v9, v7
    v_add_u32 v6, 28, v3
    v_mul_u32_u24 v7, 57, v6
    v_lshrrev_b32 v7, 10, v7
    v_mul_u32_u24 v8, 18, v7
    v_sub_u32 v8, v6, v8
    v_mul_u32_u24 v236, 4864, v7
    v_lshl_add_u32 v236, v8, 4, v236
    v_add_u32 v236, v236, v2
    v_add_u32 v8, s57, v8
    v_lshrrev_b32 v9, 2, v8
    v_lshl_add_u32 v9, v9, 10, v5
    v_and_b32 v8, 3, v8
    v_lshl_add_u32 v9, v8, 8, v9
    v_mul_lo_u32 v7, v7, s59
    v_add_u32 v237, v9, v7
    v_add_u32 v6, 32, v3
    v_mul_u32_u24 v7, 57, v6
    v_lshrrev_b32 v7, 10, v7
    v_mul_u32_u24 v8, 18, v7
    v_sub_u32 v8, v6, v8
    v_mul_u32_u24 v238, 4864, v7
    v_lshl_add_u32 v238, v8, 4, v238
    v_add_u32 v238, v238, v2
    v_add_u32 v8, s57, v8
    v_lshrrev_b32 v9, 2, v8
    v_lshl_add_u32 v9, v9, 10, v5
    v_and_b32 v8, 3, v8
    v_lshl_add_u32 v9, v8, 8, v9
    v_mul_lo_u32 v7, v7, s59
    v_add_u32 v239, v9, v7
    s_waitcnt vmcnt(19)
    s_barrier
    ds_read_b64_tr_b16 v[60:61], v17 offset:0
    ds_read_b64_tr_b16 v[62:63], v17 offset:2304
    ds_read_b64_tr_b16 v[64:65], v17 offset:32
    ds_read_b64_tr_b16 v[66:67], v17 offset:2336
    ds_read_b64_tr_b16 v[68:69], v17 offset:64
    ds_read_b64_tr_b16 v[70:71], v17 offset:2368
    ds_read_b64_tr_b16 v[72:73], v17 offset:96
    ds_read_b64_tr_b16 v[74:75], v17 offset:2400
    ds_read_b64_tr_b16 v[76:77], v17 offset:128
    ds_read_b64_tr_b16 v[78:79], v17 offset:2432
    ds_read_b64_tr_b16 v[80:81], v17 offset:160
    ds_read_b64_tr_b16 v[82:83], v17 offset:2464
    ds_read_b64_tr_b16 v[84:85], v17 offset:192
    ds_read_b64_tr_b16 v[86:87], v17 offset:2496
    ds_read_b64_tr_b16 v[88:89], v17 offset:224
    ds_read_b64_tr_b16 v[90:91], v17 offset:2528
    ds_read_b64_tr_b16 v[92:93], v17 offset:256
    ds_read_b64_tr_b16 v[94:95], v17 offset:2560
    s_waitcnt vmcnt(24) lgkmcnt(0)
    v_mfma_f32_16x16x32_bf16 v[132:135], v[60:63], v[20:23], v[132:135]
    ds_read_b64_tr_b16 v[96:97], v17 offset:9216
    ds_read_b64_tr_b16 v[98:99], v17 offset:11520
    v_mfma_f32_16x16x32_bf16 v[136:139], v[60:63], v[24:27], v[136:139]
    ds_read_b64_tr_b16 v[100:101], v17 offset:9248
    v_mfma_f32_16x16x32_bf16 v[140:143], v[64:67], v[20:23], v[140:143]
    ds_read_b64_tr_b16 v[102:103], v17 offset:11552
    v_mfma_f32_16x16x32_bf16 v[144:147], v[64:67], v[24:27], v[144:147]
    ds_read_b64_tr_b16 v[104:105], v17 offset:9280
    v_mfma_f32_16x16x32_bf16 v[148:151], v[68:71], v[20:23], v[148:151]
    ds_read_b64_tr_b16 v[106:107], v17 offset:11584
    v_mfma_f32_16x16x32_bf16 v[152:155], v[68:71], v[24:27], v[152:155]
    ds_read_b64_tr_b16 v[108:109], v17 offset:9312
    v_mfma_f32_16x16x32_bf16 v[156:159], v[72:75], v[20:23], v[156:159]
    ds_read_b64_tr_b16 v[110:111], v17 offset:11616
    v_mfma_f32_16x16x32_bf16 v[160:163], v[72:75], v[24:27], v[160:163]
    ds_read_b64_tr_b16 v[112:113], v17 offset:9344
    v_mfma_f32_16x16x32_bf16 v[164:167], v[76:79], v[20:23], v[164:167]
    buffer_load_dwordx4 v[52:55], v12, s[4:7], s27 offen
    v_mfma_f32_16x16x32_bf16 v[168:171], v[76:79], v[24:27], v[168:171]
    ds_read_b64_tr_b16 v[114:115], v17 offset:11648
    ds_read_b64_tr_b16 v[116:117], v17 offset:9376
    v_mfma_f32_16x16x32_bf16 v[172:175], v[80:83], v[20:23], v[172:175]
    ds_read_b64_tr_b16 v[118:119], v17 offset:11680
    v_mfma_f32_16x16x32_bf16 v[176:179], v[80:83], v[24:27], v[176:179]
    ds_read_b64_tr_b16 v[120:121], v17 offset:9408
    v_mfma_f32_16x16x32_bf16 v[180:183], v[84:87], v[20:23], v[180:183]
    ds_read_b64_tr_b16 v[122:123], v17 offset:11712
    v_mfma_f32_16x16x32_bf16 v[184:187], v[84:87], v[24:27], v[184:187]
    ds_read_b64_tr_b16 v[124:125], v17 offset:9440
    v_mfma_f32_16x16x32_bf16 v[188:191], v[88:91], v[20:23], v[188:191]
    ds_read_b64_tr_b16 v[126:127], v17 offset:11744
    v_mfma_f32_16x16x32_bf16 v[192:195], v[88:91], v[24:27], v[192:195]
    ds_read_b64_tr_b16 v[128:129], v17 offset:9472
    v_mfma_f32_16x16x32_bf16 v[196:199], v[92:95], v[20:23], v[196:199]
    ds_read_b64_tr_b16 v[130:131], v17 offset:11776
    v_mfma_f32_16x16x32_bf16 v[200:203], v[92:95], v[24:27], v[200:203]
    buffer_load_dwordx4 v[56:59], v13, s[4:7], s27 offen
    s_add_u32 s27, s27, 1024
    s_waitcnt vmcnt(14) lgkmcnt(0)
    s_barrier
    v_mfma_f32_16x16x32_bf16 v[132:135], v[96:99], v[28:31], v[132:135]
    ds_read_b64_tr_b16 v[60:61], v17 offset:18432
    ds_read_b64_tr_b16 v[62:63], v17 offset:20736
    v_mfma_f32_16x16x32_bf16 v[136:139], v[96:99], v[32:35], v[136:139]
    ds_read_b64_tr_b16 v[64:65], v17 offset:18464
    v_mfma_f32_16x16x32_bf16 v[140:143], v[100:103], v[28:31], v[140:143]
    buffer_load_dwordx4 v[20:23], v12, s[4:7], s27 offen
    v_mfma_f32_16x16x32_bf16 v[144:147], v[100:103], v[32:35], v[144:147]
    ds_read_b64_tr_b16 v[66:67], v17 offset:20768
    ds_read_b64_tr_b16 v[68:69], v17 offset:18496
    v_mfma_f32_16x16x32_bf16 v[148:151], v[104:107], v[28:31], v[148:151]
    ds_read_b64_tr_b16 v[70:71], v17 offset:20800
    v_mfma_f32_16x16x32_bf16 v[152:155], v[104:107], v[32:35], v[152:155]
    buffer_load_dwordx4 v[24:27], v13, s[4:7], s27 offen
    s_add_u32 s27, s27, 1024
    v_mfma_f32_16x16x32_bf16 v[156:159], v[108:111], v[28:31], v[156:159]
    ds_read_b64_tr_b16 v[72:73], v17 offset:18528
    v_mfma_f32_16x16x32_bf16 v[160:163], v[108:111], v[32:35], v[160:163]
    ds_read_b64_tr_b16 v[74:75], v17 offset:20832
    ds_read_b64_tr_b16 v[76:77], v17 offset:18560
    v_mfma_f32_16x16x32_bf16 v[164:167], v[112:115], v[28:31], v[164:167]
    s_add_u32 m0, s30, 0x0
    s_nop 0
    buffer_load_dwordx4 v14, s[8:11], s28 offen lds
    v_mfma_f32_16x16x32_bf16 v[168:171], v[112:115], v[32:35], v[168:171]
    ds_read_b64_tr_b16 v[78:79], v17 offset:20864
    v_mfma_f32_16x16x32_bf16 v[172:175], v[116:119], v[28:31], v[172:175]
    ds_read_b64_tr_b16 v[80:81], v17 offset:18592
    ds_read_b64_tr_b16 v[82:83], v17 offset:20896
    v_mfma_f32_16x16x32_bf16 v[176:179], v[116:119], v[32:35], v[176:179]
    s_add_u32 m0, s30, 0x400
    s_nop 0
    buffer_load_dwordx4 v15, s[8:11], s28 offen lds
    v_mfma_f32_16x16x32_bf16 v[180:183], v[120:123], v[28:31], v[180:183]
    ds_read_b64_tr_b16 v[84:85], v17 offset:18624
    v_mfma_f32_16x16x32_bf16 v[184:187], v[120:123], v[32:35], v[184:187]
    ds_read_b64_tr_b16 v[86:87], v17 offset:20928
    v_mfma_f32_16x16x32_bf16 v[188:191], v[124:127], v[28:31], v[188:191]
    ds_read_b64_tr_b16 v[88:89], v17 offset:18656
    s_add_u32 m0, s30, 0x800
    s_mov_b64 exec, 0xffff
    buffer_load_dwordx4 v16, s[8:11], s28 offen lds
    s_mov_b64 exec, -1
    s_add_u32 s28, s28, 0x90000
    v_mfma_f32_16x16x32_bf16 v[192:195], v[124:127], v[32:35], v[192:195]
    ds_read_b64_tr_b16 v[90:91], v17 offset:20960
    v_mfma_f32_16x16x32_bf16 v[196:199], v[128:131], v[28:31], v[196:199]
    ds_read_b64_tr_b16 v[92:93], v17 offset:18688
    v_mfma_f32_16x16x32_bf16 v[200:203], v[128:131], v[32:35], v[200:203]
    ds_read_b64_tr_b16 v[94:95], v17 offset:20992
    s_waitcnt vmcnt(24) lgkmcnt(0)
    v_mfma_f32_16x16x32_bf16 v[132:135], v[60:63], v[36:39], v[132:135]
    ds_read_b64_tr_b16 v[96:97], v17 offset:27648
    ds_read_b64_tr_b16 v[98:99], v17 offset:29952
    v_mfma_f32_16x16x32_bf16 v[136:139], v[60:63], v[40:43], v[136:139]
    ds_read_b64_tr_b16 v[100:101], v17 offset:27680
    v_mfma_f32_16x16x32_bf16 v[140:143], v[64:67], v[36:39], v[140:143]
    ds_read_b64_tr_b16 v[102:103], v17 offset:29984
    v_mfma_f32_16x16x32_bf16 v[144:147], v[64:67], v[40:43], v[144:147]
    ds_read_b64_tr_b16 v[104:105], v17 offset:27712
    v_mfma_f32_16x16x32_bf16 v[148:151], v[68:71], v[36:39], v[148:151]
    ds_read_b64_tr_b16 v[106:107], v17 offset:30016
    v_mfma_f32_16x16x32_bf16 v[152:155], v[68:71], v[40:43], v[152:155]
    ds_read_b64_tr_b16 v[108:109], v17 offset:27744
    v_mfma_f32_16x16x32_bf16 v[156:159], v[72:75], v[36:39], v[156:159]
    ds_read_b64_tr_b16 v[110:111], v17 offset:30048
    v_mfma_f32_16x16x32_bf16 v[160:163], v[72:75], v[40:43], v[160:163]
    ds_read_b64_tr_b16 v[112:113], v17 offset:27776
    v_mfma_f32_16x16x32_bf16 v[164:167], v[76:79], v[36:39], v[164:167]
    buffer_load_dwordx4 v[28:31], v12, s[4:7], s27 offen
    v_mfma_f32_16x16x32_bf16 v[168:171], v[76:79], v[40:43], v[168:171]
    ds_read_b64_tr_b16 v[114:115], v17 offset:30080
    ds_read_b64_tr_b16 v[116:117], v17 offset:27808
    v_mfma_f32_16x16x32_bf16 v[172:175], v[80:83], v[36:39], v[172:175]
    ds_read_b64_tr_b16 v[118:119], v17 offset:30112
    v_mfma_f32_16x16x32_bf16 v[176:179], v[80:83], v[40:43], v[176:179]
    ds_read_b64_tr_b16 v[120:121], v17 offset:27840
    v_mfma_f32_16x16x32_bf16 v[180:183], v[84:87], v[36:39], v[180:183]
    ds_read_b64_tr_b16 v[122:123], v17 offset:30144
    v_mfma_f32_16x16x32_bf16 v[184:187], v[84:87], v[40:43], v[184:187]
    ds_read_b64_tr_b16 v[124:125], v17 offset:27872
    v_mfma_f32_16x16x32_bf16 v[188:191], v[88:91], v[36:39], v[188:191]
    ds_read_b64_tr_b16 v[126:127], v17 offset:30176
    v_mfma_f32_16x16x32_bf16 v[192:195], v[88:91], v[40:43], v[192:195]
    ds_read_b64_tr_b16 v[128:129], v17 offset:27904
    v_mfma_f32_16x16x32_bf16 v[196:199], v[92:95], v[36:39], v[196:199]
    ds_read_b64_tr_b16 v[130:131], v17 offset:30208
    v_mfma_f32_16x16x32_bf16 v[200:203], v[92:95], v[40:43], v[200:203]
    buffer_load_dwordx4 v[32:35], v13, s[4:7], s27 offen
    s_add_u32 s27, s27, 1024
    s_waitcnt vmcnt(18) lgkmcnt(0)
    s_barrier
    v_mfma_f32_16x16x32_bf16 v[132:135], v[96:99], v[44:47], v[132:135]
    ds_read_b64_tr_b16 v[60:61], v17 offset:36864
    ds_read_b64_tr_b16 v[62:63], v17 offset:39168
    v_mfma_f32_16x16x32_bf16 v[136:139], v[96:99], v[48:51], v[136:139]
    ds_read_b64_tr_b16 v[64:65], v17 offset:36896
    v_mfma_f32_16x16x32_bf16 v[140:143], v[100:103], v[44:47], v[140:143]
    buffer_load_dwordx4 v[36:39], v12, s[4:7], s27 offen
    v_mfma_f32_16x16x32_bf16 v[144:147], v[100:103], v[48:51], v[144:147]
    ds_read_b64_tr_b16 v[66:67], v17 offset:39200
    ds_read_b64_tr_b16 v[68:69], v17 offset:36928
    v_mfma_f32_16x16x32_bf16 v[148:151], v[104:107], v[44:47], v[148:151]
    ds_read_b64_tr_b16 v[70:71], v17 offset:39232
    v_mfma_f32_16x16x32_bf16 v[152:155], v[104:107], v[48:51], v[152:155]
    buffer_load_dwordx4 v[40:43], v13, s[4:7], s27 offen
    s_add_u32 s27, s27, 1024
    v_mfma_f32_16x16x32_bf16 v[156:159], v[108:111], v[44:47], v[156:159]
    ds_read_b64_tr_b16 v[72:73], v17 offset:36960
    v_mfma_f32_16x16x32_bf16 v[160:163], v[108:111], v[48:51], v[160:163]
    ds_read_b64_tr_b16 v[74:75], v17 offset:39264
    ds_read_b64_tr_b16 v[76:77], v17 offset:36992
    v_mfma_f32_16x16x32_bf16 v[164:167], v[112:115], v[44:47], v[164:167]
    s_add_u32 m0, s30, 0x4800
    s_nop 0
    buffer_load_dwordx4 v14, s[8:11], s28 offen lds
    v_mfma_f32_16x16x32_bf16 v[168:171], v[112:115], v[48:51], v[168:171]
    ds_read_b64_tr_b16 v[78:79], v17 offset:39296
    v_mfma_f32_16x16x32_bf16 v[172:175], v[116:119], v[44:47], v[172:175]
    ds_read_b64_tr_b16 v[80:81], v17 offset:37024
    ds_read_b64_tr_b16 v[82:83], v17 offset:39328
    v_mfma_f32_16x16x32_bf16 v[176:179], v[116:119], v[48:51], v[176:179]
    s_add_u32 m0, s30, 0x4c00
    s_nop 0
    buffer_load_dwordx4 v15, s[8:11], s28 offen lds
    v_mfma_f32_16x16x32_bf16 v[180:183], v[120:123], v[44:47], v[180:183]
    ds_read_b64_tr_b16 v[84:85], v17 offset:37056
    v_mfma_f32_16x16x32_bf16 v[184:187], v[120:123], v[48:51], v[184:187]
    ds_read_b64_tr_b16 v[86:87], v17 offset:39360
    v_mfma_f32_16x16x32_bf16 v[188:191], v[124:127], v[44:47], v[188:191]
    ds_read_b64_tr_b16 v[88:89], v17 offset:37088
    s_add_u32 m0, s30, 0x5000
    s_mov_b64 exec, 0xffff
    buffer_load_dwordx4 v16, s[8:11], s28 offen lds
    s_mov_b64 exec, -1
    s_add_u32 s28, s28, 0x90000
    v_mfma_f32_16x16x32_bf16 v[192:195], v[124:127], v[48:51], v[192:195]
    ds_read_b64_tr_b16 v[90:91], v17 offset:39392
    v_mfma_f32_16x16x32_bf16 v[196:199], v[128:131], v[44:47], v[196:199]
    ds_read_b64_tr_b16 v[92:93], v17 offset:37120
    v_mfma_f32_16x16x32_bf16 v[200:203], v[128:131], v[48:51], v[200:203]
    ds_read_b64_tr_b16 v[94:95], v17 offset:39424
    s_waitcnt vmcnt(12) lgkmcnt(0)
    v_mfma_f32_16x16x32_bf16 v[132:135], v[60:63], v[52:55], v[132:135]
    ds_read_b64_tr_b16 v[96:97], v17 offset:46080
    ds_read_b64_tr_b16 v[98:99], v17 offset:48384
    v_mfma_f32_16x16x32_bf16 v[136:139], v[60:63], v[56:59], v[136:139]
    ds_read_b64_tr_b16 v[100:101], v17 offset:46112
    v_mfma_f32_16x16x32_bf16 v[140:143], v[64:67], v[52:55], v[140:143]
    ds_read_b64_tr_b16 v[102:103], v17 offset:48416
    v_mfma_f32_16x16x32_bf16 v[144:147], v[64:67], v[56:59], v[144:147]
    ds_read_b64_tr_b16 v[104:105], v17 offset:46144
    v_mfma_f32_16x16x32_bf16 v[148:151], v[68:71], v[52:55], v[148:151]
    ds_read_b64_tr_b16 v[106:107], v17 offset:48448
    v_mfma_f32_16x16x32_bf16 v[152:155], v[68:71], v[56:59], v[152:155]
    ds_read_b64_tr_b16 v[108:109], v17 offset:46176
    v_mfma_f32_16x16x32_bf16 v[156:159], v[72:75], v[52:55], v[156:159]
    ds_read_b64_tr_b16 v[110:111], v17 offset:48480
    v_mfma_f32_16x16x32_bf16 v[160:163], v[72:75], v[56:59], v[160:163]
    ds_read_b64_tr_b16 v[112:113], v17 offset:46208
    v_mfma_f32_16x16x32_bf16 v[164:167], v[76:79], v[52:55], v[164:167]
    buffer_load_dwordx4 v[44:47], v12, s[4:7], s27 offen
    v_mfma_f32_16x16x32_bf16 v[168:171], v[76:79], v[56:59], v[168:171]
    ds_read_b64_tr_b16 v[114:115], v17 offset:48512
    ds_read_b64_tr_b16 v[116:117], v17 offset:46240
    v_mfma_f32_16x16x32_bf16 v[172:175], v[80:83], v[52:55], v[172:175]
    ds_read_b64_tr_b16 v[118:119], v17 offset:48544
    v_mfma_f32_16x16x32_bf16 v[176:179], v[80:83], v[56:59], v[176:179]
    ds_read_b64_tr_b16 v[120:121], v17 offset:46272
    v_mfma_f32_16x16x32_bf16 v[180:183], v[84:87], v[52:55], v[180:183]
    ds_read_b64_tr_b16 v[122:123], v17 offset:48576
    v_mfma_f32_16x16x32_bf16 v[184:187], v[84:87], v[56:59], v[184:187]
    ds_read_b64_tr_b16 v[124:125], v17 offset:46304
    v_mfma_f32_16x16x32_bf16 v[188:191], v[88:91], v[52:55], v[188:191]
    ds_read_b64_tr_b16 v[126:127], v17 offset:48608
    v_mfma_f32_16x16x32_bf16 v[192:195], v[88:91], v[56:59], v[192:195]
    ds_read_b64_tr_b16 v[128:129], v17 offset:46336
    v_mfma_f32_16x16x32_bf16 v[196:199], v[92:95], v[52:55], v[196:199]
    ds_read_b64_tr_b16 v[130:131], v17 offset:48640
    v_mfma_f32_16x16x32_bf16 v[200:203], v[92:95], v[56:59], v[200:203]
    buffer_load_dwordx4 v[48:51], v13, s[4:7], s27 offen
    s_add_u32 s27, s27, 1024
    s_waitcnt vmcnt(9) lgkmcnt(0)
    s_barrier
    v_mfma_f32_16x16x32_bf16 v[132:135], v[96:99], v[20:23], v[132:135]
    ds_read_b64_tr_b16 v[60:61], v17 offset:0
    ds_read_b64_tr_b16 v[62:63], v17 offset:2304
    v_mfma_f32_16x16x32_bf16 v[136:139], v[96:99], v[24:27], v[136:139]
    ds_read_b64_tr_b16 v[64:65], v17 offset:32
    v_mfma_f32_16x16x32_bf16 v[140:143], v[100:103], v[20:23], v[140:143]
    buffer_load_dwordx4 v[52:55], v12, s[4:7], s27 offen
    v_mfma_f32_16x16x32_bf16 v[144:147], v[100:103], v[24:27], v[144:147]
    ds_read_b64_tr_b16 v[66:67], v17 offset:2336
    ds_read_b64_tr_b16 v[68:69], v17 offset:64
    v_mfma_f32_16x16x32_bf16 v[148:151], v[104:107], v[20:23], v[148:151]
    ds_read_b64_tr_b16 v[70:71], v17 offset:2368
    v_mfma_f32_16x16x32_bf16 v[152:155], v[104:107], v[24:27], v[152:155]
    buffer_load_dwordx4 v[56:59], v13, s[4:7], s27 offen
    s_add_u32 s27, s27, 1024
    v_mfma_f32_16x16x32_bf16 v[156:159], v[108:111], v[20:23], v[156:159]
    ds_read_b64_tr_b16 v[72:73], v17 offset:96
    v_mfma_f32_16x16x32_bf16 v[160:163], v[108:111], v[24:27], v[160:163]
    ds_read_b64_tr_b16 v[74:75], v17 offset:2400
    ds_read_b64_tr_b16 v[76:77], v17 offset:128
    v_mfma_f32_16x16x32_bf16 v[164:167], v[112:115], v[20:23], v[164:167]
    s_add_u32 m0, s30, 0x9000
    s_nop 0
    buffer_load_dwordx4 v14, s[8:11], s28 offen lds
    v_mfma_f32_16x16x32_bf16 v[168:171], v[112:115], v[24:27], v[168:171]
    ds_read_b64_tr_b16 v[78:79], v17 offset:2432
    v_mfma_f32_16x16x32_bf16 v[172:175], v[116:119], v[20:23], v[172:175]
    ds_read_b64_tr_b16 v[80:81], v17 offset:160
    ds_read_b64_tr_b16 v[82:83], v17 offset:2464
    v_mfma_f32_16x16x32_bf16 v[176:179], v[116:119], v[24:27], v[176:179]
    s_add_u32 m0, s30, 0x9400
    s_nop 0
    buffer_load_dwordx4 v15, s[8:11], s28 offen lds
    v_mfma_f32_16x16x32_bf16 v[180:183], v[120:123], v[20:23], v[180:183]
    ds_read_b64_tr_b16 v[84:85], v17 offset:192
    v_mfma_f32_16x16x32_bf16 v[184:187], v[120:123], v[24:27], v[184:187]
    ds_read_b64_tr_b16 v[86:87], v17 offset:2496
    v_mfma_f32_16x16x32_bf16 v[188:191], v[124:127], v[20:23], v[188:191]
    ds_read_b64_tr_b16 v[88:89], v17 offset:224
    s_add_u32 m0, s30, 0x9800
    s_mov_b64 exec, 0xffff
    buffer_load_dwordx4 v16, s[8:11], s28 offen lds
    s_mov_b64 exec, -1
    s_add_u32 s28, s28, 0x90000
    v_mfma_f32_16x16x32_bf16 v[192:195], v[124:127], v[24:27], v[192:195]
    ds_read_b64_tr_b16 v[90:91], v17 offset:2528
    v_mfma_f32_16x16x32_bf16 v[196:199], v[128:131], v[20:23], v[196:199]
    ds_read_b64_tr_b16 v[92:93], v17 offset:256
    v_mfma_f32_16x16x32_bf16 v[200:203], v[128:131], v[24:27], v[200:203]
    ds_read_b64_tr_b16 v[94:95], v17 offset:2560
    s_waitcnt vmcnt(12) lgkmcnt(0)
    v_mfma_f32_16x16x32_bf16 v[132:135], v[60:63], v[28:31], v[132:135]
    ds_read_b64_tr_b16 v[96:97], v17 offset:9216
    ds_read_b64_tr_b16 v[98:99], v17 offset:11520
    v_mfma_f32_16x16x32_bf16 v[136:139], v[60:63], v[32:35], v[136:139]
    ds_read_b64_tr_b16 v[100:101], v17 offset:9248
    v_mfma_f32_16x16x32_bf16 v[140:143], v[64:67], v[28:31], v[140:143]
    ds_read_b64_tr_b16 v[102:103], v17 offset:11552
    v_mfma_f32_16x16x32_bf16 v[144:147], v[64:67], v[32:35], v[144:147]
    ds_read_b64_tr_b16 v[104:105], v17 offset:9280
    v_mfma_f32_16x16x32_bf16 v[148:151], v[68:71], v[28:31], v[148:151]
    ds_read_b64_tr_b16 v[106:107], v17 offset:11584
    v_mfma_f32_16x16x32_bf16 v[152:155], v[68:71], v[32:35], v[152:155]
    ds_read_b64_tr_b16 v[108:109], v17 offset:9312
    v_mfma_f32_16x16x32_bf16 v[156:159], v[72:75], v[28:31], v[156:159]
    ds_read_b64_tr_b16 v[110:111], v17 offset:11616
    v_mfma_f32_16x16x32_bf16 v[160:163], v[72:75], v[32:35], v[160:163]
    ds_read_b64_tr_b16 v[112:113], v17 offset:9344
    v_mfma_f32_16x16x32_bf16 v[164:167], v[76:79], v[28:31], v[164:167]
    buffer_load_dwordx4 v[20:23], v12, s[4:7], s27 offen
    v_mfma_f32_16x16x32_bf16 v[168:171], v[76:79], v[32:35], v[168:171]
    ds_read_b64_tr_b16 v[114:115], v17 offset:11648
    ds_read_b64_tr_b16 v[116:117], v17 offset:9376
    v_mfma_f32_16x16x32_bf16 v[172:175], v[80:83], v[28:31], v[172:175]
    ds_read_b64_tr_b16 v[118:119], v17 offset:11680
    v_mfma_f32_16x16x32_bf16 v[176:179], v[80:83], v[32:35], v[176:179]
    ds_read_b64_tr_b16 v[120:121], v17 offset:9408
    v_mfma_f32_16x16x32_bf16 v[180:183], v[84:87], v[28:31], v[180:183]
    ds_read_b64_tr_b16 v[122:123], v17 offset:11712
    v_mfma_f32_16x16x32_bf16 v[184:187], v[84:87], v[32:35], v[184:187]
    ds_read_b64_tr_b16 v[124:125], v17 offset:9440
    v_mfma_f32_16x16x32_bf16 v[188:191], v[88:91], v[28:31], v[188:191]
    ds_read_b64_tr_b16 v[126:127], v17 offset:11744
    v_mfma_f32_16x16x32_bf16 v[192:195], v[88:91], v[32:35], v[192:195]
    ds_read_b64_tr_b16 v[128:129], v17 offset:9472
    v_mfma_f32_16x16x32_bf16 v[196:199], v[92:95], v[28:31], v[196:199]
    ds_read_b64_tr_b16 v[130:131], v17 offset:11776
    v_mfma_f32_16x16x32_bf16 v[200:203], v[92:95], v[32:35], v[200:203]
    buffer_load_dwordx4 v[24:27], v13, s[4:7], s27 offen
    s_add_u32 s27, s27, 1024
    s_waitcnt vmcnt(9) lgkmcnt(0)
    s_barrier
    v_mfma_f32_16x16x32_bf16 v[132:135], v[96:99], v[36:39], v[132:135]
    ds_read_b64_tr_b16 v[60:61], v17 offset:18432
    ds_read_b64_tr_b16 v[62:63], v17 offset:20736
    v_mfma_f32_16x16x32_bf16 v[136:139], v[96:99], v[40:43], v[136:139]
    ds_read_b64_tr_b16 v[64:65], v17 offset:18464
    v_mfma_f32_16x16x32_bf16 v[140:143], v[100:103], v[36:39], v[140:143]
    buffer_load_dwordx4 v[28:31], v12, s[4:7], s27 offen
    v_mfma_f32_16x16x32_bf16 v[144:147], v[100:103], v[40:43], v[144:147]
    ds_read_b64_tr_b16 v[66:67], v17 offset:20768
    ds_read_b64_tr_b16 v[68:69], v17 offset:18496
    v_mfma_f32_16x16x32_bf16 v[148:151], v[104:107], v[36:39], v[148:151]
    ds_read_b64_tr_b16 v[70:71], v17 offset:20800
    v_mfma_f32_16x16x32_bf16 v[152:155], v[104:107], v[40:43], v[152:155]
    buffer_load_dwordx4 v[32:35], v13, s[4:7], s27 offen
    s_add_u32 s27, s27, 1024
    v_mfma_f32_16x16x32_bf16 v[156:159], v[108:111], v[36:39], v[156:159]
    ds_read_b64_tr_b16 v[72:73], v17 offset:18528
    v_mfma_f32_16x16x32_bf16 v[160:163], v[108:111], v[40:43], v[160:163]
    ds_read_b64_tr_b16 v[74:75], v17 offset:20832
    ds_read_b64_tr_b16 v[76:77], v17 offset:18560
    v_mfma_f32_16x16x32_bf16 v[164:167], v[112:115], v[36:39], v[164:167]
    s_add_u32 m0, s30, 0x0
    s_nop 0
    buffer_load_dwordx4 v14, s[8:11], s28 offen lds
    v_mfma_f32_16x16x32_bf16 v[168:171], v[112:115], v[40:43], v[168:171]
    ds_read_b64_tr_b16 v[78:79], v17 offset:20864
    v_mfma_f32_16x16x32_bf16 v[172:175], v[116:119], v[36:39], v[172:175]
    ds_read_b64_tr_b16 v[80:81], v17 offset:18592
    ds_read_b64_tr_b16 v[82:83], v17 offset:20896
    v_mfma_f32_16x16x32_bf16 v[176:179], v[116:119], v[40:43], v[176:179]
    s_add_u32 m0, s30, 0x400
    s_nop 0
    buffer_load_dwordx4 v15, s[8:11], s28 offen lds
    v_mfma_f32_16x16x32_bf16 v[180:183], v[120:123], v[36:39], v[180:183]
    ds_read_b64_tr_b16 v[84:85], v17 offset:18624
    v_mfma_f32_16x16x32_bf16 v[184:187], v[120:123], v[40:43], v[184:187]
    ds_read_b64_tr_b16 v[86:87], v17 offset:20928
    v_mfma_f32_16x16x32_bf16 v[188:191], v[124:127], v[36:39], v[188:191]
    ds_read_b64_tr_b16 v[88:89], v17 offset:18656
    s_add_u32 m0, s30, 0x800
    s_mov_b64 exec, 0xffff
    buffer_load_dwordx4 v16, s[8:11], s28 offen lds
    s_mov_b64 exec, -1
    s_add_u32 s28, s28, 0x90000
    v_mfma_f32_16x16x32_bf16 v[192:195], v[124:127], v[40:43], v[192:195]
    ds_read_b64_tr_b16 v[90:91], v17 offset:20960
    v_mfma_f32_16x16x32_bf16 v[196:199], v[128:131], v[36:39], v[196:199]
    ds_read_b64_tr_b16 v[92:93], v17 offset:18688
    v_mfma_f32_16x16x32_bf16 v[200:203], v[128:131], v[40:43], v[200:203]
    ds_read_b64_tr_b16 v[94:95], v17 offset:20992
    s_waitcnt vmcnt(12) lgkmcnt(0)
    v_mfma_f32_16x16x32_bf16 v[132:135], v[60:63], v[44:47], v[132:135]
    ds_read_b64_tr_b16 v[96:97], v17 offset:27648
    ds_read_b64_tr_b16 v[98:99], v17 offset:29952
    v_mfma_f32_16x16x32_bf16 v[136:139], v[60:63], v[48:51], v[136:139]
    ds_read_b64_tr_b16 v[100:101], v17 offset:27680
    v_mfma_f32_16x16x32_bf16 v[140:143], v[64:67], v[44:47], v[140:143]
    ds_read_b64_tr_b16 v[102:103], v17 offset:29984
    v_mfma_f32_16x16x32_bf16 v[144:147], v[64:67], v[48:51], v[144:147]
    ds_read_b64_tr_b16 v[104:105], v17 offset:27712
    v_mfma_f32_16x16x32_bf16 v[148:151], v[68:71], v[44:47], v[148:151]
    ds_read_b64_tr_b16 v[106:107], v17 offset:30016
    v_mfma_f32_16x16x32_bf16 v[152:155], v[68:71], v[48:51], v[152:155]
    ds_read_b64_tr_b16 v[108:109], v17 offset:27744
    v_mfma_f32_16x16x32_bf16 v[156:159], v[72:75], v[44:47], v[156:159]
    ds_read_b64_tr_b16 v[110:111], v17 offset:30048
    v_mfma_f32_16x16x32_bf16 v[160:163], v[72:75], v[48:51], v[160:163]
    ds_read_b64_tr_b16 v[112:113], v17 offset:27776
    v_mfma_f32_16x16x32_bf16 v[164:167], v[76:79], v[44:47], v[164:167]
    buffer_load_dwordx4 v[36:39], v12, s[4:7], s27 offen
    v_mfma_f32_16x16x32_bf16 v[168:171], v[76:79], v[48:51], v[168:171]
    ds_read_b64_tr_b16 v[114:115], v17 offset:30080
    ds_read_b64_tr_b16 v[116:117], v17 offset:27808
    v_mfma_f32_16x16x32_bf16 v[172:175], v[80:83], v[44:47], v[172:175]
    ds_read_b64_tr_b16 v[118:119], v17 offset:30112
    v_mfma_f32_16x16x32_bf16 v[176:179], v[80:83], v[48:51], v[176:179]
    ds_read_b64_tr_b16 v[120:121], v17 offset:27840
    v_mfma_f32_16x16x32_bf16 v[180:183], v[84:87], v[44:47], v[180:183]
    ds_read_b64_tr_b16 v[122:123], v17 offset:30144
    v_mfma_f32_16x16x32_bf16 v[184:187], v[84:87], v[48:51], v[184:187]
    ds_read_b64_tr_b16 v[124:125], v17 offset:27872
    v_mfma_f32_16x16x32_bf16 v[188:191], v[88:91], v[44:47], v[188:191]
    ds_read_b64_tr_b16 v[126:127], v17 offset:30176
    v_mfma_f32_16x16x32_bf16 v[192:195], v[88:91], v[48:51], v[192:195]
    ds_read_b64_tr_b16 v[128:129], v17 offset:27904
    v_mfma_f32_16x16x32_bf16 v[196:199], v[92:95], v[44:47], v[196:199]
    ds_read_b64_tr_b16 v[130:131], v17 offset:30208
    v_mfma_f32_16x16x32_bf16 v[200:203], v[92:95], v[48:51], v[200:203]
    buffer_load_dwordx4 v[40:43], v13, s[4:7], s27 offen
    s_add_u32 s27, s27, 1024
    s_waitcnt vmcnt(9) lgkmcnt(0)
    s_barrier
    v_mfma_f32_16x16x32_bf16 v[132:135], v[96:99], v[52:55], v[132:135]
    ds_read_b64_tr_b16 v[60:61], v17 offset:36864
    ds_read_b64_tr_b16 v[62:63], v17 offset:39168
    v_mfma_f32_16x16x32_bf16 v[136:139], v[96:99], v[56:59], v[136:139]
    ds_read_b64_tr_b16 v[64:65], v17 offset:36896
    v_mfma_f32_16x16x32_bf16 v[140:143], v[100:103], v[52:55], v[140:143]
    buffer_load_dwordx4 v[44:47], v12, s[4:7], s27 offen
    v_mfma_f32_16x16x32_bf16 v[144:147], v[100:103], v[56:59], v[144:147]
    ds_read_b64_tr_b16 v[66:67], v17 offset:39200
    ds_read_b64_tr_b16 v[68:69], v17 offset:36928
    v_mfma_f32_16x16x32_bf16 v[148:151], v[104:107], v[52:55], v[148:151]
    ds_read_b64_tr_b16 v[70:71], v17 offset:39232
    v_mfma_f32_16x16x32_bf16 v[152:155], v[104:107], v[56:59], v[152:155]
    buffer_load_dwordx4 v[48:51], v13, s[4:7], s27 offen
    s_add_u32 s27, s27, 1024
    v_mfma_f32_16x16x32_bf16 v[156:159], v[108:111], v[52:55], v[156:159]
    ds_read_b64_tr_b16 v[72:73], v17 offset:36960
    v_mfma_f32_16x16x32_bf16 v[160:163], v[108:111], v[56:59], v[160:163]
    ds_read_b64_tr_b16 v[74:75], v17 offset:39264
    ds_read_b64_tr_b16 v[76:77], v17 offset:36992
    v_mfma_f32_16x16x32_bf16 v[164:167], v[112:115], v[52:55], v[164:167]
    s_add_u32 m0, s30, 0x4800
    s_nop 0
    buffer_load_dwordx4 v14, s[8:11], s28 offen lds
    v_mfma_f32_16x16x32_bf16 v[168:171], v[112:115], v[56:59], v[168:171]
    ds_read_b64_tr_b16 v[78:79], v17 offset:39296
    v_mfma_f32_16x16x32_bf16 v[172:175], v[116:119], v[52:55], v[172:175]
    ds_read_b64_tr_b16 v[80:81], v17 offset:37024
    ds_read_b64_tr_b16 v[82:83], v17 offset:39328
    v_mfma_f32_16x16x32_bf16 v[176:179], v[116:119], v[56:59], v[176:179]
    s_add_u32 m0, s30, 0x4c00
    s_nop 0
    buffer_load_dwordx4 v15, s[8:11], s28 offen lds
    v_mfma_f32_16x16x32_bf16 v[180:183], v[120:123], v[52:55], v[180:183]
    ds_read_b64_tr_b16 v[84:85], v17 offset:37056
    v_mfma_f32_16x16x32_bf16 v[184:187], v[120:123], v[56:59], v[184:187]
    ds_read_b64_tr_b16 v[86:87], v17 offset:39360
    v_mfma_f32_16x16x32_bf16 v[188:191], v[124:127], v[52:55], v[188:191]
    ds_read_b64_tr_b16 v[88:89], v17 offset:37088
    s_add_u32 m0, s30, 0x5000
    s_mov_b64 exec, 0xffff
    buffer_load_dwordx4 v16, s[8:11], s28 offen lds
    s_mov_b64 exec, -1
    s_add_u32 s28, s28, 0x90000
    v_mfma_f32_16x16x32_bf16 v[192:195], v[124:127], v[56:59], v[192:195]
    ds_read_b64_tr_b16 v[90:91], v17 offset:39392
    v_mfma_f32_16x16x32_bf16 v[196:199], v[128:131], v[52:55], v[196:199]
    ds_read_b64_tr_b16 v[92:93], v17 offset:37120
    v_mfma_f32_16x16x32_bf16 v[200:203], v[128:131], v[56:59], v[200:203]
    ds_read_b64_tr_b16 v[94:95], v17 offset:39424
    s_waitcnt vmcnt(12) lgkmcnt(0)
    v_mfma_f32_16x16x32_bf16 v[132:135], v[60:63], v[20:23], v[132:135]
    ds_read_b64_tr_b16 v[96:97], v17 offset:46080
    ds_read_b64_tr_b16 v[98:99], v17 offset:48384
    v_mfma_f32_16x16x32_bf16 v[136:139], v[60:63], v[24:27], v[136:139]
    ds_read_b64_tr_b16 v[100:101], v17 offset:46112
    v_mfma_f32_16x16x32_bf16 v[140:143], v[64:67], v[20:23], v[140:143]
    ds_read_b64_tr_b16 v[102:103], v17 offset:48416
    v_mfma_f32_16x16x32_bf16 v[144:147], v[64:67], v[24:27], v[144:147]
    ds_read_b64_tr_b16 v[104:105], v17 offset:46144
    v_mfma_f32_16x16x32_bf16 v[148:151], v[68:71], v[20:23], v[148:151]
    ds_read_b64_tr_b16 v[106:107], v17 offset:48448
    v_mfma_f32_16x16x32_bf16 v[152:155], v[68:71], v[24:27], v[152:155]
    ds_read_b64_tr_b16 v[108:109], v17 offset:46176
    v_mfma_f32_16x16x32_bf16 v[156:159], v[72:75], v[20:23], v[156:159]
    ds_read_b64_tr_b16 v[110:111], v17 offset:48480
    v_mfma_f32_16x16x32_bf16 v[160:163], v[72:75], v[24:27], v[160:163]
    ds_read_b64_tr_b16 v[112:113], v17 offset:46208
    v_mfma_f32_16x16x32_bf16 v[164:167], v[76:79], v[20:23], v[164:167]
    buffer_load_dwordx4 v[52:55], v12, s[4:7], s27 offen
    v_mfma_f32_16x16x32_bf16 v[168:171], v[76:79], v[24:27], v[168:171]
    ds_read_b64_tr_b16 v[114:115], v17 offset:48512
    ds_read_b64_tr_b16 v[116:117], v17 offset:46240
    v_mfma_f32_16x16x32_bf16 v[172:175], v[80:83], v[20:23], v[172:175]
    ds_read_b64_tr_b16 v[118:119], v17 offset:48544
    v_mfma_f32_16x16x32_bf16 v[176:179], v[80:83], v[24:27], v[176:179]
    ds_read_b64_tr_b16 v[120:121], v17 offset:46272
    v_mfma_f32_16x16x32_bf16 v[180:183], v[84:87], v[20:23], v[180:183]
    ds_read_b64_tr_b16 v[122:123], v17 offset:48576
    v_mfma_f32_16x16x32_bf16 v[184:187], v[84:87], v[24:27], v[184:187]
    ds_read_b64_tr_b16 v[124:125], v17 offset:46304
    v_mfma_f32_16x16x32_bf16 v[188:191], v[88:91], v[20:23], v[188:191]
    ds_read_b64_tr_b16 v[126:127], v17 offset:48608
    v_mfma_f32_16x16x32_bf16 v[192:195], v[88:91], v[24:27], v[192:195]
    ds_read_b64_tr_b16 v[128:129], v17 offset:46336
    v_mfma_f32_16x16x32_bf16 v[196:199], v[92:95], v[20:23], v[196:199]
    ds_read_b64_tr_b16 v[130:131], v17 offset:48640
    v_mfma_f32_16x16x32_bf16 v[200:203], v[92:95], v[24:27], v[200:203]
    buffer_load_dwordx4 v[56:59], v13, s[4:7], s27 offen
    s_add_u32 s27, s27, 1024
    s_waitcnt vmcnt(9) lgkmcnt(0)
    s_barrier
    v_mfma_f32_16x16x32_bf16 v[132:135], v[96:99], v[28:31], v[132:135]
    ds_read_b64_tr_b16 v[60:61], v17 offset:0
    ds_read_b64_tr_b16 v[62:63], v17 offset:2304
    v_mfma_f32_16x16x32_bf16 v[136:139], v[96:99], v[32:35], v[136:139]
    ds_read_b64_tr_b16 v[64:65], v17 offset:32
    v_mfma_f32_16x16x32_bf16 v[140:143], v[100:103], v[28:31], v[140:143]
    buffer_load_dwordx4 v[20:23], v12, s[4:7], s27 offen
    v_mfma_f32_16x16x32_bf16 v[144:147], v[100:103], v[32:35], v[144:147]
    ds_read_b64_tr_b16 v[66:67], v17 offset:2336
    ds_read_b64_tr_b16 v[68:69], v17 offset:64
    v_mfma_f32_16x16x32_bf16 v[148:151], v[104:107], v[28:31], v[148:151]
    ds_read_b64_tr_b16 v[70:71], v17 offset:2368
    v_mfma_f32_16x16x32_bf16 v[152:155], v[104:107], v[32:35], v[152:155]
    buffer_load_dwordx4 v[24:27], v13, s[4:7], s27 offen
    s_add_u32 s27, s27, 1024
    v_mfma_f32_16x16x32_bf16 v[156:159], v[108:111], v[28:31], v[156:159]
    ds_read_b64_tr_b16 v[72:73], v17 offset:96
    v_mfma_f32_16x16x32_bf16 v[160:163], v[108:111], v[32:35], v[160:163]
    ds_read_b64_tr_b16 v[74:75], v17 offset:2400
    ds_read_b64_tr_b16 v[76:77], v17 offset:128
    v_mfma_f32_16x16x32_bf16 v[164:167], v[112:115], v[28:31], v[164:167]
    s_add_u32 m0, s30, 0x9000
    s_nop 0
    buffer_load_dwordx4 v14, s[8:11], s28 offen lds
    v_mfma_f32_16x16x32_bf16 v[168:171], v[112:115], v[32:35], v[168:171]
    ds_read_b64_tr_b16 v[78:79], v17 offset:2432
    v_mfma_f32_16x16x32_bf16 v[172:175], v[116:119], v[28:31], v[172:175]
    ds_read_b64_tr_b16 v[80:81], v17 offset:160
    ds_read_b64_tr_b16 v[82:83], v17 offset:2464
    v_mfma_f32_16x16x32_bf16 v[176:179], v[116:119], v[32:35], v[176:179]
    s_add_u32 m0, s30, 0x9400
    s_nop 0
    buffer_load_dwordx4 v15, s[8:11], s28 offen lds
    v_mfma_f32_16x16x32_bf16 v[180:183], v[120:123], v[28:31], v[180:183]
    ds_read_b64_tr_b16 v[84:85], v17 offset:192
    v_mfma_f32_16x16x32_bf16 v[184:187], v[120:123], v[32:35], v[184:187]
    ds_read_b64_tr_b16 v[86:87], v17 offset:2496
    v_mfma_f32_16x16x32_bf16 v[188:191], v[124:127], v[28:31], v[188:191]
    ds_read_b64_tr_b16 v[88:89], v17 offset:224
    s_add_u32 m0, s30, 0x9800
    s_mov_b64 exec, 0xffff
    buffer_load_dwordx4 v16, s[8:11], s28 offen lds
    s_mov_b64 exec, -1
    s_add_u32 s28, s28, 0x90000
    v_mfma_f32_16x16x32_bf16 v[192:195], v[124:127], v[32:35], v[192:195]
    ds_read_b64_tr_b16 v[90:91], v17 offset:2528
    v_mfma_f32_16x16x32_bf16 v[196:199], v[128:131], v[28:31], v[196:199]
    ds_read_b64_tr_b16 v[92:93], v17 offset:256
    v_mfma_f32_16x16x32_bf16 v[200:203], v[128:131], v[32:35], v[200:203]
    ds_read_b64_tr_b16 v[94:95], v17 offset:2560
    s_waitcnt vmcnt(12) lgkmcnt(0)
    v_mfma_f32_16x16x32_bf16 v[132:135], v[60:63], v[36:39], v[132:135]
    ds_read_b64_tr_b16 v[96:97], v17 offset:9216
    ds_read_b64_tr_b16 v[98:99], v17 offset:11520
    v_mfma_f32_16x16x32_bf16 v[136:139], v[60:63], v[40:43], v[136:139]
    ds_read_b64_tr_b16 v[100:101], v17 offset:9248
    v_mfma_f32_16x16x32_bf16 v[140:143], v[64:67], v[36:39], v[140:143]
    ds_read_b64_tr_b16 v[102:103], v17 offset:11552
    v_mfma_f32_16x16x32_bf16 v[144:147], v[64:67], v[40:43], v[144:147]
    ds_read_b64_tr_b16 v[104:105], v17 offset:9280
    v_mfma_f32_16x16x32_bf16 v[148:151], v[68:71], v[36:39], v[148:151]
    ds_read_b64_tr_b16 v[106:107], v17 offset:11584
    v_mfma_f32_16x16x32_bf16 v[152:155], v[68:71], v[40:43], v[152:155]
    ds_read_b64_tr_b16 v[108:109], v17 offset:9312
    v_mfma_f32_16x16x32_bf16 v[156:159], v[72:75], v[36:39], v[156:159]
    ds_read_b64_tr_b16 v[110:111], v17 offset:11616
    v_mfma_f32_16x16x32_bf16 v[160:163], v[72:75], v[40:43], v[160:163]
    ds_read_b64_tr_b16 v[112:113], v17 offset:9344
    v_mfma_f32_16x16x32_bf16 v[164:167], v[76:79], v[36:39], v[164:167]
    buffer_load_dwordx4 v[28:31], v12, s[4:7], s27 offen
    v_mfma_f32_16x16x32_bf16 v[168:171], v[76:79], v[40:43], v[168:171]
    ds_read_b64_tr_b16 v[114:115], v17 offset:11648
    ds_read_b64_tr_b16 v[116:117], v17 offset:9376
    v_mfma_f32_16x16x32_bf16 v[172:175], v[80:83], v[36:39], v[172:175]
    ds_read_b64_tr_b16 v[118:119], v17 offset:11680
    v_mfma_f32_16x16x32_bf16 v[176:179], v[80:83], v[40:43], v[176:179]
    ds_read_b64_tr_b16 v[120:121], v17 offset:9408
    v_mfma_f32_16x16x32_bf16 v[180:183], v[84:87], v[36:39], v[180:183]
    ds_read_b64_tr_b16 v[122:123], v17 offset:11712
    v_mfma_f32_16x16x32_bf16 v[184:187], v[84:87], v[40:43], v[184:187]
    ds_read_b64_tr_b16 v[124:125], v17 offset:9440
    v_mfma_f32_16x16x32_bf16 v[188:191], v[88:91], v[36:39], v[188:191]
    ds_read_b64_tr_b16 v[126:127], v17 offset:11744
    v_mfma_f32_16x16x32_bf16 v[192:195], v[88:91], v[40:43], v[192:195]
    ds_read_b64_tr_b16 v[128:129], v17 offset:9472
    v_mfma_f32_16x16x32_bf16 v[196:199], v[92:95], v[36:39], v[196:199]
    ds_read_b64_tr_b16 v[130:131], v17 offset:11776
    v_mfma_f32_16x16x32_bf16 v[200:203], v[92:95], v[40:43], v[200:203]
    buffer_load_dwordx4 v[32:35], v13, s[4:7], s27 offen
    s_add_u32 s27, s27, 1024
    s_waitcnt vmcnt(9) lgkmcnt(0)
    s_barrier
    v_mfma_f32_16x16x32_bf16 v[132:135], v[96:99], v[44:47], v[132:135]
    ds_read_b64_tr_b16 v[60:61], v17 offset:18432
    ds_read_b64_tr_b16 v[62:63], v17 offset:20736
    v_mfma_f32_16x16x32_bf16 v[136:139], v[96:99], v[48:51], v[136:139]
    ds_read_b64_tr_b16 v[64:65], v17 offset:18464
    v_mfma_f32_16x16x32_bf16 v[140:143], v[100:103], v[44:47], v[140:143]
    ds_read_b64_tr_b16 v[66:67], v17 offset:20768
    v_mfma_f32_16x16x32_bf16 v[144:147], v[100:103], v[48:51], v[144:147]
    ds_read_b64_tr_b16 v[68:69], v17 offset:18496
    v_mfma_f32_16x16x32_bf16 v[148:151], v[104:107], v[44:47], v[148:151]
    ds_read_b64_tr_b16 v[70:71], v17 offset:20800
    v_mfma_f32_16x16x32_bf16 v[152:155], v[104:107], v[48:51], v[152:155]
    ds_read_b64_tr_b16 v[72:73], v17 offset:18528
    v_mfma_f32_16x16x32_bf16 v[156:159], v[108:111], v[44:47], v[156:159]
    ds_read_b64_tr_b16 v[74:75], v17 offset:20832
    v_mfma_f32_16x16x32_bf16 v[160:163], v[108:111], v[48:51], v[160:163]
    ds_read_b64_tr_b16 v[76:77], v17 offset:18560
    v_mfma_f32_16x16x32_bf16 v[164:167], v[112:115], v[44:47], v[164:167]
    buffer_load_dwordx4 v[36:39], v12, s[4:7], s27 offen
    v_mfma_f32_16x16x32_bf16 v[168:171], v[112:115], v[48:51], v[168:171]
    ds_read_b64_tr_b16 v[78:79], v17 offset:20864
    ds_read_b64_tr_b16 v[80:81], v17 offset:18592
    v_mfma_f32_16x16x32_bf16 v[172:175], v[116:119], v[44:47], v[172:175]
    ds_read_b64_tr_b16 v[82:83], v17 offset:20896
    v_mfma_f32_16x16x32_bf16 v[176:179], v[116:119], v[48:51], v[176:179]
    ds_read_b64_tr_b16 v[84:85], v17 offset:18624
    v_mfma_f32_16x16x32_bf16 v[180:183], v[120:123], v[44:47], v[180:183]
    ds_read_b64_tr_b16 v[86:87], v17 offset:20928
    v_mfma_f32_16x16x32_bf16 v[184:187], v[120:123], v[48:51], v[184:187]
    ds_read_b64_tr_b16 v[88:89], v17 offset:18656
    v_mfma_f32_16x16x32_bf16 v[188:191], v[124:127], v[44:47], v[188:191]
    ds_read_b64_tr_b16 v[90:91], v17 offset:20960
    v_mfma_f32_16x16x32_bf16 v[192:195], v[124:127], v[48:51], v[192:195]
    ds_read_b64_tr_b16 v[92:93], v17 offset:18688
    v_mfma_f32_16x16x32_bf16 v[196:199], v[128:131], v[44:47], v[196:199]
    ds_read_b64_tr_b16 v[94:95], v17 offset:20992
    v_mfma_f32_16x16x32_bf16 v[200:203], v[128:131], v[48:51], v[200:203]
    buffer_load_dwordx4 v[40:43], v13, s[4:7], s27 offen
    s_add_u32 s27, s27, 1024
    s_waitcnt vmcnt(9) lgkmcnt(0)
    v_mfma_f32_16x16x32_bf16 v[132:135], v[60:63], v[52:55], v[132:135]
    ds_read_b64_tr_b16 v[96:97], v17 offset:27648
    v_mfma_f32_16x16x32_bf16 v[136:139], v[60:63], v[56:59], v[136:139]
    ds_read_b64_tr_b16 v[98:99], v17 offset:29952
    v_mfma_f32_16x16x32_bf16 v[140:143], v[64:67], v[52:55], v[140:143]
    ds_read_b64_tr_b16 v[100:101], v17 offset:27680
    v_mfma_f32_16x16x32_bf16 v[144:147], v[64:67], v[56:59], v[144:147]
    ds_read_b64_tr_b16 v[102:103], v17 offset:29984
    v_mfma_f32_16x16x32_bf16 v[148:151], v[68:71], v[52:55], v[148:151]
    ds_read_b64_tr_b16 v[104:105], v17 offset:27712
    v_mfma_f32_16x16x32_bf16 v[152:155], v[68:71], v[56:59], v[152:155]
    ds_read_b64_tr_b16 v[106:107], v17 offset:30016
    v_mfma_f32_16x16x32_bf16 v[156:159], v[72:75], v[52:55], v[156:159]
    ds_read_b64_tr_b16 v[108:109], v17 offset:27744
    v_mfma_f32_16x16x32_bf16 v[160:163], v[72:75], v[56:59], v[160:163]
    ds_read_b64_tr_b16 v[110:111], v17 offset:30048
    v_mfma_f32_16x16x32_bf16 v[164:167], v[76:79], v[52:55], v[164:167]
    ds_read_b64_tr_b16 v[112:113], v17 offset:27776
    v_mfma_f32_16x16x32_bf16 v[168:171], v[76:79], v[56:59], v[168:171]
    ds_read_b64_tr_b16 v[114:115], v17 offset:30080
    v_mfma_f32_16x16x32_bf16 v[172:175], v[80:83], v[52:55], v[172:175]
    ds_read_b64_tr_b16 v[116:117], v17 offset:27808
    v_mfma_f32_16x16x32_bf16 v[176:179], v[80:83], v[56:59], v[176:179]
    ds_read_b64_tr_b16 v[118:119], v17 offset:30112
    v_mfma_f32_16x16x32_bf16 v[180:183], v[84:87], v[52:55], v[180:183]
    ds_read_b64_tr_b16 v[120:121], v17 offset:27840
    v_mfma_f32_16x16x32_bf16 v[184:187], v[84:87], v[56:59], v[184:187]
    ds_read_b64_tr_b16 v[122:123], v17 offset:30144
    v_mfma_f32_16x16x32_bf16 v[188:191], v[88:91], v[52:55], v[188:191]
    ds_read_b64_tr_b16 v[124:125], v17 offset:27872
    v_mfma_f32_16x16x32_bf16 v[192:195], v[88:91], v[56:59], v[192:195]
    ds_read_b64_tr_b16 v[126:127], v17 offset:30176
    v_mfma_f32_16x16x32_bf16 v[196:199], v[92:95], v[52:55], v[196:199]
    ds_read_b64_tr_b16 v[128:129], v17 offset:27904
    v_mfma_f32_16x16x32_bf16 v[200:203], v[92:95], v[56:59], v[200:203]
    ds_read_b64_tr_b16 v[130:131], v17 offset:30208
    s_waitcnt vmcnt(4) lgkmcnt(0)
    s_barrier
    v_mfma_f32_16x16x32_bf16 v[132:135], v[96:99], v[20:23], v[132:135]
    ds_read_b64_tr_b16 v[60:61], v17 offset:36864
    v_mfma_f32_16x16x32_bf16 v[136:139], v[96:99], v[24:27], v[136:139]
    ds_read_b64_tr_b16 v[62:63], v17 offset:39168
    v_mfma_f32_16x16x32_bf16 v[140:143], v[100:103], v[20:23], v[140:143]
    ds_read_b64_tr_b16 v[64:65], v17 offset:36896
    v_mfma_f32_16x16x32_bf16 v[144:147], v[100:103], v[24:27], v[144:147]
    ds_read_b64_tr_b16 v[66:67], v17 offset:39200
    v_mfma_f32_16x16x32_bf16 v[148:151], v[104:107], v[20:23], v[148:151]
    ds_read_b64_tr_b16 v[68:69], v17 offset:36928
    v_mfma_f32_16x16x32_bf16 v[152:155], v[104:107], v[24:27], v[152:155]
    ds_read_b64_tr_b16 v[70:71], v17 offset:39232
    v_mfma_f32_16x16x32_bf16 v[156:159], v[108:111], v[20:23], v[156:159]
    ds_read_b64_tr_b16 v[72:73], v17 offset:36960
    v_mfma_f32_16x16x32_bf16 v[160:163], v[108:111], v[24:27], v[160:163]
    ds_read_b64_tr_b16 v[74:75], v17 offset:39264
    v_mfma_f32_16x16x32_bf16 v[164:167], v[112:115], v[20:23], v[164:167]
    ds_read_b64_tr_b16 v[76:77], v17 offset:36992
    v_mfma_f32_16x16x32_bf16 v[168:171], v[112:115], v[24:27], v[168:171]
    ds_read_b64_tr_b16 v[78:79], v17 offset:39296
    v_mfma_f32_16x16x32_bf16 v[172:175], v[116:119], v[20:23], v[172:175]
    ds_read_b64_tr_b16 v[80:81], v17 offset:37024
    v_mfma_f32_16x16x32_bf16 v[176:179], v[116:119], v[24:27], v[176:179]
    ds_read_b64_tr_b16 v[82:83], v17 offset:39328
    v_mfma_f32_16x16x32_bf16 v[180:183], v[120:123], v[20:23], v[180:183]
    ds_read_b64_tr_b16 v[84:85], v17 offset:37056
    v_mfma_f32_16x16x32_bf16 v[184:187], v[120:123], v[24:27], v[184:187]
    ds_read_b64_tr_b16 v[86:87], v17 offset:39360
    v_mfma_f32_16x16x32_bf16 v[188:191], v[124:127], v[20:23], v[188:191]
    ds_read_b64_tr_b16 v[88:89], v17 offset:37088
    v_mfma_f32_16x16x32_bf16 v[192:195], v[124:127], v[24:27], v[192:195]
    ds_read_b64_tr_b16 v[90:91], v17 offset:39392
    v_mfma_f32_16x16x32_bf16 v[196:199], v[128:131], v[20:23], v[196:199]
    ds_read_b64_tr_b16 v[92:93], v17 offset:37120
    v_mfma_f32_16x16x32_bf16 v[200:203], v[128:131], v[24:27], v[200:203]
    ds_read_b64_tr_b16 v[94:95], v17 offset:39424
    s_waitcnt vmcnt(2) lgkmcnt(0)
    v_mfma_f32_16x16x32_bf16 v[132:135], v[60:63], v[28:31], v[132:135]
    ds_read_b64_tr_b16 v[96:97], v17 offset:46080
    v_mfma_f32_16x16x32_bf16 v[136:139], v[60:63], v[32:35], v[136:139]
    ds_read_b64_tr_b16 v[98:99], v17 offset:48384
    v_mfma_f32_16x16x32_bf16 v[140:143], v[64:67], v[28:31], v[140:143]
    ds_read_b64_tr_b16 v[100:101], v17 offset:46112
    v_mfma_f32_16x16x32_bf16 v[144:147], v[64:67], v[32:35], v[144:147]
    ds_read_b64_tr_b16 v[102:103], v17 offset:48416
    v_mfma_f32_16x16x32_bf16 v[148:151], v[68:71], v[28:31], v[148:151]
    ds_read_b64_tr_b16 v[104:105], v17 offset:46144
    v_mfma_f32_16x16x32_bf16 v[152:155], v[68:71], v[32:35], v[152:155]
    ds_read_b64_tr_b16 v[106:107], v17 offset:48448
    v_mfma_f32_16x16x32_bf16 v[156:159], v[72:75], v[28:31], v[156:159]
    ds_read_b64_tr_b16 v[108:109], v17 offset:46176
    v_mfma_f32_16x16x32_bf16 v[160:163], v[72:75], v[32:35], v[160:163]
    ds_read_b64_tr_b16 v[110:111], v17 offset:48480
    v_mfma_f32_16x16x32_bf16 v[164:167], v[76:79], v[28:31], v[164:167]
    ds_read_b64_tr_b16 v[112:113], v17 offset:46208
    v_mfma_f32_16x16x32_bf16 v[168:171], v[76:79], v[32:35], v[168:171]
    ds_read_b64_tr_b16 v[114:115], v17 offset:48512
    v_mfma_f32_16x16x32_bf16 v[172:175], v[80:83], v[28:31], v[172:175]
    ds_read_b64_tr_b16 v[116:117], v17 offset:46240
    v_mfma_f32_16x16x32_bf16 v[176:179], v[80:83], v[32:35], v[176:179]
    ds_read_b64_tr_b16 v[118:119], v17 offset:48544
    v_mfma_f32_16x16x32_bf16 v[180:183], v[84:87], v[28:31], v[180:183]
    ds_read_b64_tr_b16 v[120:121], v17 offset:46272
    v_mfma_f32_16x16x32_bf16 v[184:187], v[84:87], v[32:35], v[184:187]
    ds_read_b64_tr_b16 v[122:123], v17 offset:48576
    v_mfma_f32_16x16x32_bf16 v[188:191], v[88:91], v[28:31], v[188:191]
    ds_read_b64_tr_b16 v[124:125], v17 offset:46304
    v_mfma_f32_16x16x32_bf16 v[192:195], v[88:91], v[32:35], v[192:195]
    ds_read_b64_tr_b16 v[126:127], v17 offset:48608
    v_mfma_f32_16x16x32_bf16 v[196:199], v[92:95], v[28:31], v[196:199]
    ds_read_b64_tr_b16 v[128:129], v17 offset:46336
    v_mfma_f32_16x16x32_bf16 v[200:203], v[92:95], v[32:35], v[200:203]
    ds_read_b64_tr_b16 v[130:131], v17 offset:48640
    s_waitcnt vmcnt(0) lgkmcnt(0)
    v_mfma_f32_16x16x32_bf16 v[132:135], v[96:99], v[36:39], v[132:135]
    v_mfma_f32_16x16x32_bf16 v[136:139], v[96:99], v[40:43], v[136:139]
    v_mfma_f32_16x16x32_bf16 v[140:143], v[100:103], v[36:39], v[140:143]
    v_mfma_f32_16x16x32_bf16 v[144:147], v[100:103], v[40:43], v[144:147]
    v_mfma_f32_16x16x32_bf16 v[148:151], v[104:107], v[36:39], v[148:151]
    v_mfma_f32_16x16x32_bf16 v[152:155], v[104:107], v[40:43], v[152:155]
    v_mfma_f32_16x16x32_bf16 v[156:159], v[108:111], v[36:39], v[156:159]
    v_mfma_f32_16x16x32_bf16 v[160:163], v[108:111], v[40:43], v[160:163]
    v_mfma_f32_16x16x32_bf16 v[164:167], v[112:115], v[36:39], v[164:167]
    v_mfma_f32_16x16x32_bf16 v[168:171], v[112:115], v[40:43], v[168:171]
    v_mfma_f32_16x16x32_bf16 v[172:175], v[116:119], v[36:39], v[172:175]
    v_mfma_f32_16x16x32_bf16 v[176:179], v[116:119], v[40:43], v[176:179]
    v_mfma_f32_16x16x32_bf16 v[180:183], v[120:123], v[36:39], v[180:183]
    v_mfma_f32_16x16x32_bf16 v[184:187], v[120:123], v[40:43], v[184:187]
    v_mfma_f32_16x16x32_bf16 v[188:191], v[124:127], v[36:39], v[188:191]
    v_mfma_f32_16x16x32_bf16 v[192:195], v[124:127], v[40:43], v[192:195]
    v_mfma_f32_16x16x32_bf16 v[196:199], v[128:131], v[36:39], v[196:199]
    v_mfma_f32_16x16x32_bf16 v[200:203], v[128:131], v[40:43], v[200:203]
    s_nop 15
    s_waitcnt vmcnt(0)
    s_barrier
    s_mul_i32 s34, s20, 9728
    v_and_b32 v2, 15, v1
    v_mul_u32_u24 v2, 304, v2
    v_lshrrev_b32 v3, 4, v1
    v_lshl_add_u32 v4, v3, 3, v2
    v_add_u32 v4, s34, v4
    v_lshlrev_b32 v60, 16, v204
    v_and_b32 v61, 0xffff0000, v204
    v_lshlrev_b32 v62, 16, v205
    v_and_b32 v63, 0xffff0000, v205
    v_add_f32 v132, v132, v60
    v_add_f32 v133, v133, v61
    v_add_f32 v134, v134, v62
    v_add_f32 v135, v135, v63
    v_max_f32 v132, 0, v132
    v_max_f32 v133, 0, v133
    v_max_f32 v134, 0, v134
    v_max_f32 v135, 0, v135
    v_mul_f32 v132, v132, v132
    v_mul_f32 v133, v133, v133
    v_mul_f32 v134, v134, v134
    v_mul_f32 v135, v135, v135
    v_cvt_pk_bf16_f32 v132, v132, v133
    v_cvt_pk_bf16_f32 v133, v134, v135
    ds_write_b64 v4, v[132:133] offset:0
    v_add_f32 v136, v136, v60
    v_add_f32 v137, v137, v61
    v_add_f32 v138, v138, v62
    v_add_f32 v139, v139, v63
    v_max_f32 v136, 0, v136
    v_max_f32 v137, 0, v137
    v_max_f32 v138, 0, v138
    v_max_f32 v139, 0, v139
    v_mul_f32 v136, v136, v136
    v_mul_f32 v137, v137, v137
    v_mul_f32 v138, v138, v138
    v_mul_f32 v139, v139, v139
    v_cvt_pk_bf16_f32 v136, v136, v137
    v_cvt_pk_bf16_f32 v137, v138, v139
    ds_write_b64 v4, v[136:137] offset:4864
    v_lshlrev_b32 v60, 16, v206
    v_and_b32 v61, 0xffff0000, v206
    v_lshlrev_b32 v62, 16, v207
    v_and_b32 v63, 0xffff0000, v207
    v_add_f32 v140, v140, v60
    v_add_f32 v141, v141, v61
    v_add_f32 v142, v142, v62
    v_add_f32 v143, v143, v63
    v_max_f32 v140, 0, v140
    v_max_f32 v141, 0, v141
    v_max_f32 v142, 0, v142
    v_max_f32 v143, 0, v143
    v_mul_f32 v140, v140, v140
    v_mul_f32 v141, v141, v141
    v_mul_f32 v142, v142, v142
    v_mul_f32 v143, v143, v143
    v_cvt_pk_bf16_f32 v140, v140, v141
    v_cvt_pk_bf16_f32 v141, v142, v143
    ds_write_b64 v4, v[140:141] offset:32
    v_add_f32 v144, v144, v60
    v_add_f32 v145, v145, v61
    v_add_f32 v146, v146, v62
    v_add_f32 v147, v147, v63
    v_max_f32 v144, 0, v144
    v_max_f32 v145, 0, v145
    v_max_f32 v146, 0, v146
    v_max_f32 v147, 0, v147
    v_mul_f32 v144, v144, v144
    v_mul_f32 v145, v145, v145
    v_mul_f32 v146, v146, v146
    v_mul_f32 v147, v147, v147
    v_cvt_pk_bf16_f32 v144, v144, v145
    v_cvt_pk_bf16_f32 v145, v146, v147
    ds_write_b64 v4, v[144:145] offset:4896
    v_lshlrev_b32 v60, 16, v208
    v_and_b32 v61, 0xffff0000, v208
    v_lshlrev_b32 v62, 16, v209
    v_and_b32 v63, 0xffff0000, v209
    v_add_f32 v148, v148, v60
    v_add_f32 v149, v149, v61
    v_add_f32 v150, v150, v62
    v_add_f32 v151, v151, v63
    v_max_f32 v148, 0, v148
    v_max_f32 v149, 0, v149
    v_max_f32 v150, 0, v150
    v_max_f32 v151, 0, v151
    v_mul_f32 v148, v148, v148
    v_mul_f32 v149, v149, v149
    v_mul_f32 v150, v150, v150
    v_mul_f32 v151, v151, v151
    v_cvt_pk_bf16_f32 v148, v148, v149
    v_cvt_pk_bf16_f32 v149, v150, v151
    ds_write_b64 v4, v[148:149] offset:64
    v_add_f32 v152, v152, v60
    v_add_f32 v153, v153, v61
    v_add_f32 v154, v154, v62
    v_add_f32 v155, v155, v63
    v_max_f32 v152, 0, v152
    v_max_f32 v153, 0, v153
    v_max_f32 v154, 0, v154
    v_max_f32 v155, 0, v155
    v_mul_f32 v152, v152, v152
    v_mul_f32 v153, v153, v153
    v_mul_f32 v154, v154, v154
    v_mul_f32 v155, v155, v155
    v_cvt_pk_bf16_f32 v152, v152, v153
    v_cvt_pk_bf16_f32 v153, v154, v155
    ds_write_b64 v4, v[152:153] offset:4928
    v_lshlrev_b32 v60, 16, v210
    v_and_b32 v61, 0xffff0000, v210
    v_lshlrev_b32 v62, 16, v211
    v_and_b32 v63, 0xffff0000, v211
    v_add_f32 v156, v156, v60
    v_add_f32 v157, v157, v61
    v_add_f32 v158, v158, v62
    v_add_f32 v159, v159, v63
    v_max_f32 v156, 0, v156
    v_max_f32 v157, 0, v157
    v_max_f32 v158, 0, v158
    v_max_f32 v159, 0, v159
    v_mul_f32 v156, v156, v156
    v_mul_f32 v157, v157, v157
    v_mul_f32 v158, v158, v158
    v_mul_f32 v159, v159, v159
    v_cvt_pk_bf16_f32 v156, v156, v157
    v_cvt_pk_bf16_f32 v157, v158, v159
    ds_write_b64 v4, v[156:157] offset:96
    v_add_f32 v160, v160, v60
    v_add_f32 v161, v161, v61
    v_add_f32 v162, v162, v62
    v_add_f32 v163, v163, v63
    v_max_f32 v160, 0, v160
    v_max_f32 v161, 0, v161
    v_max_f32 v162, 0, v162
    v_max_f32 v163, 0, v163
    v_mul_f32 v160, v160, v160
    v_mul_f32 v161, v161, v161
    v_mul_f32 v162, v162, v162
    v_mul_f32 v163, v163, v163
    v_cvt_pk_bf16_f32 v160, v160, v161
    v_cvt_pk_bf16_f32 v161, v162, v163
    ds_write_b64 v4, v[160:161] offset:4960
    v_lshlrev_b32 v60, 16, v212
    v_and_b32 v61, 0xffff0000, v212
    v_lshlrev_b32 v62, 16, v213
    v_and_b32 v63, 0xffff0000, v213
    v_add_f32 v164, v164, v60
    v_add_f32 v165, v165, v61
    v_add_f32 v166, v166, v62
    v_add_f32 v167, v167, v63
    v_max_f32 v164, 0, v164
    v_max_f32 v165, 0, v165
    v_max_f32 v166, 0, v166
    v_max_f32 v167, 0, v167
    v_mul_f32 v164, v164, v164
    v_mul_f32 v165, v165, v165
    v_mul_f32 v166, v166, v166
    v_mul_f32 v167, v167, v167
    v_cvt_pk_bf16_f32 v164, v164, v165
    v_cvt_pk_bf16_f32 v165, v166, v167
    ds_write_b64 v4, v[164:165] offset:128
    v_add_f32 v168, v168, v60
    v_add_f32 v169, v169, v61
    v_add_f32 v170, v170, v62
    v_add_f32 v171, v171, v63
    v_max_f32 v168, 0, v168
    v_max_f32 v169, 0, v169
    v_max_f32 v170, 0, v170
    v_max_f32 v171, 0, v171
    v_mul_f32 v168, v168, v168
    v_mul_f32 v169, v169, v169
    v_mul_f32 v170, v170, v170
    v_mul_f32 v171, v171, v171
    v_cvt_pk_bf16_f32 v168, v168, v169
    v_cvt_pk_bf16_f32 v169, v170, v171
    ds_write_b64 v4, v[168:169] offset:4992
    v_lshlrev_b32 v60, 16, v214
    v_and_b32 v61, 0xffff0000, v214
    v_lshlrev_b32 v62, 16, v215
    v_and_b32 v63, 0xffff0000, v215
    v_add_f32 v172, v172, v60
    v_add_f32 v173, v173, v61
    v_add_f32 v174, v174, v62
    v_add_f32 v175, v175, v63
    v_max_f32 v172, 0, v172
    v_max_f32 v173, 0, v173
    v_max_f32 v174, 0, v174
    v_max_f32 v175, 0, v175
    v_mul_f32 v172, v172, v172
    v_mul_f32 v173, v173, v173
    v_mul_f32 v174, v174, v174
    v_mul_f32 v175, v175, v175
    v_cvt_pk_bf16_f32 v172, v172, v173
    v_cvt_pk_bf16_f32 v173, v174, v175
    ds_write_b64 v4, v[172:173] offset:160
    v_add_f32 v176, v176, v60
    v_add_f32 v177, v177, v61
    v_add_f32 v178, v178, v62
    v_add_f32 v179, v179, v63
    v_max_f32 v176, 0, v176
    v_max_f32 v177, 0, v177
    v_max_f32 v178, 0, v178
    v_max_f32 v179, 0, v179
    v_mul_f32 v176, v176, v176
    v_mul_f32 v177, v177, v177
    v_mul_f32 v178, v178, v178
    v_mul_f32 v179, v179, v179
    v_cvt_pk_bf16_f32 v176, v176, v177
    v_cvt_pk_bf16_f32 v177, v178, v179
    ds_write_b64 v4, v[176:177] offset:5024
    v_lshlrev_b32 v60, 16, v216
    v_and_b32 v61, 0xffff0000, v216
    v_lshlrev_b32 v62, 16, v217
    v_and_b32 v63, 0xffff0000, v217
    v_add_f32 v180, v180, v60
    v_add_f32 v181, v181, v61
    v_add_f32 v182, v182, v62
    v_add_f32 v183, v183, v63
    v_max_f32 v180, 0, v180
    v_max_f32 v181, 0, v181
    v_max_f32 v182, 0, v182
    v_max_f32 v183, 0, v183
    v_mul_f32 v180, v180, v180
    v_mul_f32 v181, v181, v181
    v_mul_f32 v182, v182, v182
    v_mul_f32 v183, v183, v183
    v_cvt_pk_bf16_f32 v180, v180, v181
    v_cvt_pk_bf16_f32 v181, v182, v183
    ds_write_b64 v4, v[180:181] offset:192
    v_add_f32 v184, v184, v60
    v_add_f32 v185, v185, v61
    v_add_f32 v186, v186, v62
    v_add_f32 v187, v187, v63
    v_max_f32 v184, 0, v184
    v_max_f32 v185, 0, v185
    v_max_f32 v186, 0, v186
    v_max_f32 v187, 0, v187
    v_mul_f32 v184, v184, v184
    v_mul_f32 v185, v185, v185
    v_mul_f32 v186, v186, v186
    v_mul_f32 v187, v187, v187
    v_cvt_pk_bf16_f32 v184, v184, v185
    v_cvt_pk_bf16_f32 v185, v186, v187
    ds_write_b64 v4, v[184:185] offset:5056
    v_lshlrev_b32 v60, 16, v218
    v_and_b32 v61, 0xffff0000, v218
    v_lshlrev_b32 v62, 16, v219
    v_and_b32 v63, 0xffff0000, v219
    v_add_f32 v188, v188, v60
    v_add_f32 v189, v189, v61
    v_add_f32 v190, v190, v62
    v_add_f32 v191, v191, v63
    v_max_f32 v188, 0, v188
    v_max_f32 v189, 0, v189
    v_max_f32 v190, 0, v190
    v_max_f32 v191, 0, v191
    v_mul_f32 v188, v188, v188
    v_mul_f32 v189, v189, v189
    v_mul_f32 v190, v190, v190
    v_mul_f32 v191, v191, v191
    v_cvt_pk_bf16_f32 v188, v188, v189
    v_cvt_pk_bf16_f32 v189, v190, v191
    ds_write_b64 v4, v[188:189] offset:224
    v_add_f32 v192, v192, v60
    v_add_f32 v193, v193, v61
    v_add_f32 v194, v194, v62
    v_add_f32 v195, v195, v63
    v_max_f32 v192, 0, v192
    v_max_f32 v193, 0, v193
    v_max_f32 v194, 0, v194
    v_max_f32 v195, 0, v195
    v_mul_f32 v192, v192, v192
    v_mul_f32 v193, v193, v193
    v_mul_f32 v194, v194, v194
    v_mul_f32 v195, v195, v195
    v_cvt_pk_bf16_f32 v192, v192, v193
    v_cvt_pk_bf16_f32 v193, v194, v195
    ds_write_b64 v4, v[192:193] offset:5088
    v_lshlrev_b32 v60, 16, v220
    v_and_b32 v61, 0xffff0000, v220
    v_lshlrev_b32 v62, 16, v221
    v_and_b32 v63, 0xffff0000, v221
    v_add_f32 v196, v196, v60
    v_add_f32 v197, v197, v61
    v_add_f32 v198, v198, v62
    v_add_f32 v199, v199, v63
    v_max_f32 v196, 0, v196
    v_max_f32 v197, 0, v197
    v_max_f32 v198, 0, v198
    v_max_f32 v199, 0, v199
    v_mul_f32 v196, v196, v196
    v_mul_f32 v197, v197, v197
    v_mul_f32 v198, v198, v198
    v_mul_f32 v199, v199, v199
    v_cvt_pk_bf16_f32 v196, v196, v197
    v_cvt_pk_bf16_f32 v197, v198, v199
    ds_write_b64 v4, v[196:197] offset:256
    v_add_f32 v200, v200, v60
    v_add_f32 v201, v201, v61
    v_add_f32 v202, v202, v62
    v_add_f32 v203, v203, v63
    v_max_f32 v200, 0, v200
    v_max_f32 v201, 0, v201
    v_max_f32 v202, 0, v202
    v_max_f32 v203, 0, v203
    v_mul_f32 v200, v200, v200
    v_mul_f32 v201, v201, v201
    v_mul_f32 v202, v202, v202
    v_mul_f32 v203, v203, v203
    v_cvt_pk_bf16_f32 v200, v200, v201
    v_cvt_pk_bf16_f32 v201, v202, v203
    ds_write_b64 v4, v[200:201] offset:5120
    s_waitcnt lgkmcnt(0)
    ds_read_b128 v[132:135], v222
    ds_read_b128 v[140:143], v224
    ds_read_b128 v[148:151], v226
    ds_read_b128 v[156:159], v228
    ds_read_b128 v[164:167], v230
    ds_read_b128 v[172:175], v232
    ds_read_b128 v[180:183], v234
    ds_read_b128 v[188:191], v236
    ds_read_b128 v[196:199], v238
    s_waitcnt lgkmcnt(8)
    buffer_store_dwordx4 v[132:135], v223, s[12:15], s56 offen sc0 sc1
    s_waitcnt lgkmcnt(7)
    buffer_store_dwordx4 v[140:143], v225, s[12:15], s56 offen sc0 sc1
    s_waitcnt lgkmcnt(6)
    buffer_store_dwordx4 v[148:151], v227, s[12:15], s56 offen sc0 sc1
    s_waitcnt lgkmcnt(5)
    buffer_store_dwordx4 v[156:159], v229, s[12:15], s56 offen sc0 sc1
    s_waitcnt lgkmcnt(4)
    buffer_store_dwordx4 v[164:167], v231, s[12:15], s56 offen sc0 sc1
    s_waitcnt lgkmcnt(3)
    buffer_store_dwordx4 v[172:175], v233, s[12:15], s56 offen sc0 sc1
    s_waitcnt lgkmcnt(2)
    buffer_store_dwordx4 v[180:183], v235, s[12:15], s56 offen sc0 sc1
    s_waitcnt lgkmcnt(1)
    buffer_store_dwordx4 v[188:191], v237, s[12:15], s56 offen sc0 sc1
    s_waitcnt lgkmcnt(0)
    buffer_store_dwordx4 v[196:199], v239, s[12:15], s56 offen sc0 sc1
L_mlp_up_kernel_end:
    s_endpgm
.globl down_kernel
.p2align 8
.type down_kernel,@function
down_kernel:
    s_cmp_ge_u32 s2, 256
    s_cbranch_scc1 L_down_kernel_end
    s_load_dwordx2 s[44:45], s[0:1], 72
    s_load_dwordx2 s[46:47], s[0:1], 104
    v_lshrrev_b32 v2, 6, v0
    v_and_b32 v1, 63, v0
    s_nop 0
    v_readfirstlane_b32 s20, v2
    s_nop 3
    s_and_b32 s21, s20, 3
    s_lshr_b32 s23, s20, 2
    s_and_b32 s26, s2, 3
    s_bfe_u32 s32, s2, 0x10002
    s_lshr_b32 s33, s2, 3
    s_and_b32 s34, s33, 3
    s_mul_i32 s25, s34, 144
    s_lshr_b32 s33, s33, 2
    s_lshl_b32 s32, s32, 3
    s_add_u32 s33, s33, s32
    s_lshl_b32 s24, s33, 7
    s_mul_i32 s27, s26, 36864
    s_mul_i32 s28, s26, 1327104
    s_waitcnt lgkmcnt(0)
    s_add_u32 s4, s46, 0x6000000
    s_addc_u32 s5, s47, 0
    s_mov_b32 s6, 0x1200000
    s_mov_b32 s7, 0x00020000
    s_mov_b32 s8, s44
    s_mov_b32 s9, s45
    s_mov_b32 s10, 0x510000
    s_mov_b32 s11, 0x00020000
    s_add_u32 s12, s46, 0x8000000
    s_addc_u32 s13, s47, 0
    s_mov_b32 s14, 0x1200000
    s_mov_b32 s15, 0x00020000
    s_lshr_b32 s32, s24, 4
    s_lshl_b32 s33, s21, 1
    s_add_u32 s32, s32, s33
    s_mul_i32 s32, s32, 147456
    s_add_u32 s27, s27, s32
    s_lshl_b32 s32, s23, 10
    s_add_u32 s27, s27, s32
    v_lshlrev_b32 v12, 4, v1
    v_add_u32 v13, 0x24000, v12
    s_lshl_b32 s34, s25, 1
    s_mov_b32 s33, 1152
    s_lshl_b32 s32, s20, 3
    v_add_u32 v2, 0, v1
    v_mul_u32_u24 v3, 57, v2
    v_lshrrev_b32 v3, 10, v3
    v_mul_u32_u24 v4, 18, v3
    v_sub_u32 v4, v2, v4
    v_add_u32 v3, s32, v3
    v_bfe_u32 v5, v3, 2, 1
    v_bfe_u32 v6, v3, 3, 1
    v_and_b32 v3, 0xfffffff3, v3
    v_lshl_or_b32 v3, v5, 3, v3
    v_lshl_or_b32 v3, v6, 2, v3
    v_mul_lo_u32 v3, v3, s33
    v_lshl_add_u32 v3, v4, 4, v3
    v_add_u32 v14, s34, v3
    v_add_u32 v2, 64, v1
    v_mul_u32_u24 v3, 57, v2
    v_lshrrev_b32 v3, 10, v3
    v_mul_u32_u24 v4, 18, v3
    v_sub_u32 v4, v2, v4
    v_add_u32 v3, s32, v3
    v_bfe_u32 v5, v3, 2, 1
    v_bfe_u32 v6, v3, 3, 1
    v_and_b32 v3, 0xfffffff3, v3
    v_lshl_or_b32 v3, v5, 3, v3
    v_lshl_or_b32 v3, v6, 2, v3
    v_mul_lo_u32 v3, v3, s33
    v_lshl_add_u32 v3, v4, 4, v3
    v_add_u32 v15, s34, v3
    v_add_u32 v2, 128, v1
    v_mul_u32_u24 v3, 57, v2
    v_lshrrev_b32 v3, 10, v3
    v_mul_u32_u24 v4, 18, v3
    v_sub_u32 v4, v2, v4
    v_add_u32 v3, s32, v3
    v_bfe_u32 v5, v3, 2, 1
    v_bfe_u32 v6, v3, 3, 1
    v_and_b32 v3, 0xfffffff3, v3
    v_lshl_or_b32 v3, v5, 3, v3
    v_lshl_or_b32 v3, v6, 2, v3
    v_mul_lo_u32 v3, v3, s33
    v_lshl_add_u32 v3, v4, 4, v3
    v_add_u32 v16, s34, v3
    s_mul_i32 s30, s20, 2304
    buffer_load_dwordx4 v[20:23], v12, s[4:7], s27 offen
    buffer_load_dwordx4 v[24:27], v13, s[4:7], s27 offen
    s_add_u32 s27, s27, 2048
    s_add_u32 m0, s30, 0x0
    s_nop 0
    buffer_load_dwordx4 v14, s[8:11], s28 offen lds
    s_add_u32 m0, s30, 0x400
    s_nop 0
    buffer_load_dwordx4 v15, s[8:11], s28 offen lds
    s_add_u32 m0, s30, 0x800
    s_mov_b64 exec, 0xffff
    buffer_load_dwordx4 v16, s[8:11], s28 offen lds
    s_mov_b64 exec, -1
    s_add_u32 s28, s28, 0x12000
    buffer_load_dwordx4 v[28:31], v12, s[4:7], s27 offen
    buffer_load_dwordx4 v[32:35], v13, s[4:7], s27 offen
    s_add_u32 s27, s27, 2048
    s_add_u32 m0, s30, 0x4800
    s_nop 0
    buffer_load_dwordx4 v14, s[8:11], s28 offen lds
    s_add_u32 m0, s30, 0x4c00
    s_nop 0
    buffer_load_dwordx4 v15, s[8:11], s28 offen lds
    s_add_u32 m0, s30, 0x5000
    s_mov_b64 exec, 0xffff
    buffer_load_dwordx4 v16, s[8:11], s28 offen lds
    s_mov_b64 exec, -1
    s_add_u32 s28, s28, 0x12000
    buffer_load_dwordx4 v[36:39], v12, s[4:7], s27 offen
    buffer_load_dwordx4 v[40:43], v13, s[4:7], s27 offen
    s_add_u32 s27, s27, 2048
    s_add_u32 m0, s30, 0x9000
    s_nop 0
    buffer_load_dwordx4 v14, s[8:11], s28 offen lds
    s_add_u32 m0, s30, 0x9400
    s_nop 0
    buffer_load_dwordx4 v15, s[8:11], s28 offen lds
    s_add_u32 m0, s30, 0x9800
    s_mov_b64 exec, 0xffff
    buffer_load_dwordx4 v16, s[8:11], s28 offen lds
    s_mov_b64 exec, -1
    s_add_u32 s28, s28, 0x12000
    buffer_load_dwordx4 v[44:47], v12, s[4:7], s27 offen
    buffer_load_dwordx4 v[48:51], v13, s[4:7], s27 offen
    s_add_u32 s27, s27, 2048
    s_add_u32 m0, s30, 0xd800
    s_nop 0
    buffer_load_dwordx4 v14, s[8:11], s28 offen lds
    s_add_u32 m0, s30, 0xdc00
    s_nop 0
    buffer_load_dwordx4 v15, s[8:11], s28 offen lds
    s_add_u32 m0, s30, 0xe000
    s_mov_b64 exec, 0xffff
    buffer_load_dwordx4 v16, s[8:11], s28 offen lds
    s_mov_b64 exec, -1
    s_add_u32 s28, s28, 0x12000
    v_lshrrev_b32 v2, 4, v1
    v_bfe_u32 v3, v1, 2, 2
    v_and_b32 v4, 3, v1
    v_lshrrev_b32 v5, 1, v2
    v_lshl_add_u32 v3, v5, 4, v3
    v_and_b32 v5, 1, v2
    v_lshl_add_u32 v3, v5, 2, v3
    v_mul_u32_u24 v3, 288, v3
    v_lshl_add_u32 v17, v4, 3, v3
    s_mul_i32 s33, s23, 9216
    v_add_u32 v17, s33, v17
    v_add_u32 v18, 0x10000, v17
    v_mov_b32 v132, 0
    v_mov_b32 v133, 0
    v_mov_b32 v134, 0
    v_mov_b32 v135, 0
    v_mov_b32 v136, 0
    v_mov_b32 v137, 0
    v_mov_b32 v138, 0
    v_mov_b32 v139, 0
    v_mov_b32 v140, 0
    v_mov_b32 v141, 0
    v_mov_b32 v142, 0
    v_mov_b32 v143, 0
    v_mov_b32 v144, 0
    v_mov_b32 v145, 0
    v_mov_b32 v146, 0
    v_mov_b32 v147, 0
    v_mov_b32 v148, 0
    v_mov_b32 v149, 0
    v_mov_b32 v150, 0
    v_mov_b32 v151, 0
    v_mov_b32 v152, 0
    v_mov_b32 v153, 0
    v_mov_b32 v154, 0
    v_mov_b32 v155, 0
    v_mov_b32 v156, 0
    v_mov_b32 v157, 0
    v_mov_b32 v158, 0
    v_mov_b32 v159, 0
    v_mov_b32 v160, 0
    v_mov_b32 v161, 0
    v_mov_b32 v162, 0
    v_mov_b32 v163, 0
    v_mov_b32 v164, 0
    v_mov_b32 v165, 0
    v_mov_b32 v166, 0
    v_mov_b32 v167, 0
    v_mov_b32 v168, 0
    v_mov_b32 v169, 0
    v_mov_b32 v170, 0
    v_mov_b32 v171, 0
    v_mov_b32 v172, 0
    v_mov_b32 v173, 0
    v_mov_b32 v174, 0
    v_mov_b32 v175, 0
    v_mov_b32 v176, 0
    v_mov_b32 v177, 0
    v_mov_b32 v178, 0
    v_mov_b32 v179, 0
    v_mov_b32 v180, 0
    v_mov_b32 v181, 0
    v_mov_b32 v182, 0
    v_mov_b32 v183, 0
    v_mov_b32 v184, 0
    v_mov_b32 v185, 0
    v_mov_b32 v186, 0
    v_mov_b32 v187, 0
    v_mov_b32 v188, 0
    v_mov_b32 v189, 0
    v_mov_b32 v190, 0
    v_mov_b32 v191, 0
    v_mov_b32 v192, 0
    v_mov_b32 v193, 0
    v_mov_b32 v194, 0
    v_mov_b32 v195, 0
    v_mov_b32 v196, 0
    v_mov_b32 v197, 0
    v_mov_b32 v198, 0
    v_mov_b32 v199, 0
    v_mov_b32 v200, 0
    v_mov_b32 v201, 0
    v_mov_b32 v202, 0
    v_mov_b32 v203, 0
    s_mul_i32 s56, s26, 4718592
    s_lshl_b32 s58, s20, 4
    s_add_u32 s57, s24, s58
    s_mul_i32 s57, s57, 2304
    s_add_u32 s56, s56, s57
    s_lshl_b32 s57, s25, 2
    s_add_u32 s56, s56, s57
    s_mul_i32 s58, s58, 592
    v_add_u32 v3, 0, v1
    v_mul_u32_u24 v4, 1821, v3
    v_lshrrev_b32 v4, 16, v4
    v_mul_u32_u24 v5, 36, v4
    v_sub_u32 v5, v3, v5
    v_lshlrev_b32 v5, 4, v5
    v_mul_u32_u24 v204, 592, v4
    v_add3_u32 v204, v204, v5, s58
    v_add_u32 v206, 0x12800, v204
    v_mul_u32_u24 v205, 2304, v4
    v_add_u32 v205, v205, v5
    v_add_u32 v3, 64, v1
    v_mul_u32_u24 v4, 1821, v3
    v_lshrrev_b32 v4, 16, v4
    v_mul_u32_u24 v5, 36, v4
    v_sub_u32 v5, v3, v5
    v_lshlrev_b32 v5, 4, v5
    v_mul_u32_u24 v207, 592, v4
    v_add3_u32 v207, v207, v5, s58
    v_add_u32 v209, 0x12800, v207
    v_mul_u32_u24 v208, 2304, v4
    v_add_u32 v208, v208, v5
    v_add_u32 v3, 128, v1
    v_mul_u32_u24 v4, 1821, v3
    v_lshrrev_b32 v4, 16, v4
    v_mul_u32_u24 v5, 36, v4
    v_sub_u32 v5, v3, v5
    v_lshlrev_b32 v5, 4, v5
    v_mul_u32_u24 v210, 592, v4
    v_add3_u32 v210, v210, v5, s58
    v_add_u32 v212, 0x12800, v210
    v_mul_u32_u24 v211, 2304, v4
    v_add_u32 v211, v211, v5
    v_add_u32 v3, 192, v1
    v_mul_u32_u24 v4, 1821, v3
    v_lshrrev_b32 v4, 16, v4
    v_mul_u32_u24 v5, 36, v4
    v_sub_u32 v5, v3, v5
    v_lshlrev_b32 v5, 4, v5
    v_mul_u32_u24 v213, 592, v4
    v_add3_u32 v213, v213, v5, s58
    v_add_u32 v215, 0x12800, v213
    v_mul_u32_u24 v214, 2304, v4
    v_add_u32 v214, v214, v5
    v_add_u32 v3, 256, v1
    v_mul_u32_u24 v4, 1821, v3
    v_lshrrev_b32 v4, 16, v4
    v_mul_u32_u24 v5, 36, v4
    v_sub_u32 v5, v3, v5
    v_lshlrev_b32 v5, 4, v5
    v_mul_u32_u24 v216, 592, v4
    v_add3_u32 v216, v216, v5, s58
    v_add_u32 v218, 0x12800, v216
    v_mul_u32_u24 v217, 2304, v4
    v_add_u32 v217, v217, v5
    v_add_u32 v3, 320, v1
    v_mul_u32_u24 v4, 1821, v3
    v_lshrrev_b32 v4, 16, v4
    v_mul_u32_u24 v5, 36, v4
    v_sub_u32 v5, v3, v5
    v_lshlrev_b32 v5, 4, v5
    v_mul_u32_u24 v219, 592, v4
    v_add3_u32 v219, v219, v5, s58
    v_add_u32 v221, 0x12800, v219
    v_mul_u32_u24 v220, 2304, v4
    v_add_u32 v220, v220, v5
    v_add_u32 v3, 384, v1
    v_mul_u32_u24 v4, 1821, v3
    v_lshrrev_b32 v4, 16, v4
    v_mul_u32_u24 v5, 36, v4
    v_sub_u32 v5, v3, v5
    v_lshlrev_b32 v5, 4, v5
    v_mul_u32_u24 v222, 592, v4
    v_add3_u32 v222, v222, v5, s58
    v_add_u32 v224, 0x12800, v222
    v_mul_u32_u24 v223, 2304, v4
    v_add_u32 v223, v223, v5
    v_add_u32 v3, 448, v1
    v_mul_u32_u24 v4, 1821, v3
    v_lshrrev_b32 v4, 16, v4
    v_mul_u32_u24 v5, 36, v4
    v_sub_u32 v5, v3, v5
    v_lshlrev_b32 v5, 4, v5
    v_mul_u32_u24 v225, 592, v4
    v_add3_u32 v225, v225, v5, s58
    v_add_u32 v227, 0x12800, v225
    v_mul_u32_u24 v226, 2304, v4
    v_add_u32 v226, v226, v5
    v_add_u32 v3, 512, v1
    v_mul_u32_u24 v4, 1821, v3
    v_lshrrev_b32 v4, 16, v4
    v_mul_u32_u24 v5, 36, v4
    v_sub_u32 v5, v3, v5
    v_lshlrev_b32 v5, 4, v5
    v_mul_u32_u24 v228, 592, v4
    v_add3_u32 v228, v228, v5, s58
    v_add_u32 v230, 0x12800, v228
    v_mul_u32_u24 v229, 2304, v4
    v_add_u32 v229, v229, v5
    s_waitcnt vmcnt(15)
    s_barrier
    ds_read_b64_tr_b16 v[60:61], v17 offset:0
    ds_read_b64_tr_b16 v[62:63], v17 offset:2304
    ds_read_b64_tr_b16 v[64:65], v17 offset:32
    ds_read_b64_tr_b16 v[66:67], v17 offset:2336
    ds_read_b64_tr_b16 v[68:69], v17 offset:64
    ds_read_b64_tr_b16 v[70:71], v17 offset:2368
    ds_read_b64_tr_b16 v[72:73], v17 offset:96
    ds_read_b64_tr_b16 v[74:75], v17 offset:2400
    ds_read_b64_tr_b16 v[76:77], v17 offset:128
    ds_read_b64_tr_b16 v[78:79], v17 offset:2432
    ds_read_b64_tr_b16 v[80:81], v17 offset:160
    ds_read_b64_tr_b16 v[82:83], v17 offset:2464
    ds_read_b64_tr_b16 v[84:85], v17 offset:192
    ds_read_b64_tr_b16 v[86:87], v17 offset:2496
    ds_read_b64_tr_b16 v[88:89], v17 offset:224
    ds_read_b64_tr_b16 v[90:91], v17 offset:2528
    ds_read_b64_tr_b16 v[92:93], v17 offset:256
    ds_read_b64_tr_b16 v[94:95], v17 offset:2560
    s_waitcnt vmcnt(10) lgkmcnt(0)
    s_barrier
    v_mfma_f32_16x16x32_bf16 v[132:135], v[60:63], v[20:23], v[132:135]
    ds_read_b64_tr_b16 v[96:97], v17 offset:18432
    ds_read_b64_tr_b16 v[98:99], v17 offset:20736
    v_mfma_f32_16x16x32_bf16 v[136:139], v[60:63], v[24:27], v[136:139]
    ds_read_b64_tr_b16 v[100:101], v17 offset:18464
    v_mfma_f32_16x16x32_bf16 v[140:143], v[64:67], v[20:23], v[140:143]
    buffer_load_dwordx4 v[52:55], v12, s[4:7], s27 offen
    v_mfma_f32_16x16x32_bf16 v[144:147], v[64:67], v[24:27], v[144:147]
    ds_read_b64_tr_b16 v[102:103], v17 offset:20768
    ds_read_b64_tr_b16 v[104:105], v17 offset:18496
    v_mfma_f32_16x16x32_bf16 v[148:151], v[68:71], v[20:23], v[148:151]
    ds_read_b64_tr_b16 v[106:107], v17 offset:20800
    v_mfma_f32_16x16x32_bf16 v[152:155], v[68:71], v[24:27], v[152:155]
    buffer_load_dwordx4 v[56:59], v13, s[4:7], s27 offen
    s_add_u32 s27, s27, 2048
    v_mfma_f32_16x16x32_bf16 v[156:159], v[72:75], v[20:23], v[156:159]
    ds_read_b64_tr_b16 v[108:109], v17 offset:18528
    v_mfma_f32_16x16x32_bf16 v[160:163], v[72:75], v[24:27], v[160:163]
    ds_read_b64_tr_b16 v[110:111], v17 offset:20832
    ds_read_b64_tr_b16 v[112:113], v17 offset:18560
    v_mfma_f32_16x16x32_bf16 v[164:167], v[76:79], v[20:23], v[164:167]
    s_add_u32 m0, s30, 0x0
    s_nop 0
    buffer_load_dwordx4 v14, s[8:11], s28 offen lds
    v_mfma_f32_16x16x32_bf16 v[168:171], v[76:79], v[24:27], v[168:171]
    ds_read_b64_tr_b16 v[114:115], v17 offset:20864
    v_mfma_f32_16x16x32_bf16 v[172:175], v[80:83], v[20:23], v[172:175]
    ds_read_b64_tr_b16 v[116:117], v17 offset:18592
    ds_read_b64_tr_b16 v[118:119], v17 offset:20896
    v_mfma_f32_16x16x32_bf16 v[176:179], v[80:83], v[24:27], v[176:179]
    s_add_u32 m0, s30, 0x400
    s_nop 0
    buffer_load_dwordx4 v15, s[8:11], s28 offen lds
    v_mfma_f32_16x16x32_bf16 v[180:183], v[84:87], v[20:23], v[180:183]
    ds_read_b64_tr_b16 v[120:121], v17 offset:18624
    v_mfma_f32_16x16x32_bf16 v[184:187], v[84:87], v[24:27], v[184:187]
    ds_read_b64_tr_b16 v[122:123], v17 offset:20928
    v_mfma_f32_16x16x32_bf16 v[188:191], v[88:91], v[20:23], v[188:191]
    ds_read_b64_tr_b16 v[124:125], v17 offset:18656
    s_add_u32 m0, s30, 0x800
    s_mov_b64 exec, 0xffff
    buffer_load_dwordx4 v16, s[8:11], s28 offen lds
    s_mov_b64 exec, -1
    s_add_u32 s28, s28, 0x12000
    v_mfma_f32_16x16x32_bf16 v[192:195], v[88:91], v[24:27], v[192:195]
    ds_read_b64_tr_b16 v[126:127], v17 offset:20960
    v_mfma_f32_16x16x32_bf16 v[196:199], v[92:95], v[20:23], v[196:199]
    ds_read_b64_tr_b16 v[128:129], v17 offset:18688
    v_mfma_f32_16x16x32_bf16 v[200:203], v[92:95], v[24:27], v[200:203]
    ds_read_b64_tr_b16 v[130:131], v17 offset:20992
    s_waitcnt vmcnt(10) lgkmcnt(0)
    s_barrier
    v_mfma_f32_16x16x32_bf16 v[132:135], v[96:99], v[28:31], v[132:135]
    ds_read_b64_tr_b16 v[60:61], v17 offset:36864
    ds_read_b64_tr_b16 v[62:63], v17 offset:39168
    v_mfma_f32_16x16x32_bf16 v[136:139], v[96:99], v[32:35], v[136:139]
    ds_read_b64_tr_b16 v[64:65], v17 offset:36896
    v_mfma_f32_16x16x32_bf16 v[140:143], v[100:103], v[28:31], v[140:143]
    buffer_load_dwordx4 v[20:23], v12, s[4:7], s27 offen
    v_mfma_f32_16x16x32_bf16 v[144:147], v[100:103], v[32:35], v[144:147]
    ds_read_b64_tr_b16 v[66:67], v17 offset:39200
    ds_read_b64_tr_b16 v[68:69], v17 offset:36928
    v_mfma_f32_16x16x32_bf16 v[148:151], v[104:107], v[28:31], v[148:151]
    ds_read_b64_tr_b16 v[70:71], v17 offset:39232
    v_mfma_f32_16x16x32_bf16 v[152:155], v[104:107], v[32:35], v[152:155]
    buffer_load_dwordx4 v[24:27], v13, s[4:7], s27 offen
    s_add_u32 s27, s27, 2048
    v_mfma_f32_16x16x32_bf16 v[156:159], v[108:111], v[28:31], v[156:159]
    ds_read_b64_tr_b16 v[72:73], v17 offset:36960
    v_mfma_f32_16x16x32_bf16 v[160:163], v[108:111], v[32:35], v[160:163]
    ds_read_b64_tr_b16 v[74:75], v17 offset:39264
    ds_read_b64_tr_b16 v[76:77], v17 offset:36992
    v_mfma_f32_16x16x32_bf16 v[164:167], v[112:115], v[28:31], v[164:167]
    s_add_u32 m0, s30, 0x4800
    s_nop 0
    buffer_load_dwordx4 v14, s[8:11], s28 offen lds
    v_mfma_f32_16x16x32_bf16 v[168:171], v[112:115], v[32:35], v[168:171]
    ds_read_b64_tr_b16 v[78:79], v17 offset:39296
    v_mfma_f32_16x16x32_bf16 v[172:175], v[116:119], v[28:31], v[172:175]
    ds_read_b64_tr_b16 v[80:81], v17 offset:37024
    ds_read_b64_tr_b16 v[82:83], v17 offset:39328
    v_mfma_f32_16x16x32_bf16 v[176:179], v[116:119], v[32:35], v[176:179]
    s_add_u32 m0, s30, 0x4c00
    s_nop 0
    buffer_load_dwordx4 v15, s[8:11], s28 offen lds
    v_mfma_f32_16x16x32_bf16 v[180:183], v[120:123], v[28:31], v[180:183]
    ds_read_b64_tr_b16 v[84:85], v17 offset:37056
    v_mfma_f32_16x16x32_bf16 v[184:187], v[120:123], v[32:35], v[184:187]
    ds_read_b64_tr_b16 v[86:87], v17 offset:39360
    v_mfma_f32_16x16x32_bf16 v[188:191], v[124:127], v[28:31], v[188:191]
    ds_read_b64_tr_b16 v[88:89], v17 offset:37088
    s_add_u32 m0, s30, 0x5000
    s_mov_b64 exec, 0xffff
    buffer_load_dwordx4 v16, s[8:11], s28 offen lds
    s_mov_b64 exec, -1
    s_add_u32 s28, s28, 0x12000
    v_mfma_f32_16x16x32_bf16 v[192:195], v[124:127], v[32:35], v[192:195]
    ds_read_b64_tr_b16 v[90:91], v17 offset:39392
    v_mfma_f32_16x16x32_bf16 v[196:199], v[128:131], v[28:31], v[196:199]
    ds_read_b64_tr_b16 v[92:93], v17 offset:37120
    v_mfma_f32_16x16x32_bf16 v[200:203], v[128:131], v[32:35], v[200:203]
    ds_read_b64_tr_b16 v[94:95], v17 offset:39424
    s_waitcnt vmcnt(10) lgkmcnt(0)
    s_barrier
    v_mfma_f32_16x16x32_bf16 v[132:135], v[60:63], v[36:39], v[132:135]
    ds_read_b64_tr_b16 v[96:97], v17 offset:55296
    ds_read_b64_tr_b16 v[98:99], v17 offset:57600
    v_mfma_f32_16x16x32_bf16 v[136:139], v[60:63], v[40:43], v[136:139]
    ds_read_b64_tr_b16 v[100:101], v17 offset:55328
    v_mfma_f32_16x16x32_bf16 v[140:143], v[64:67], v[36:39], v[140:143]
    buffer_load_dwordx4 v[28:31], v12, s[4:7], s27 offen
    v_mfma_f32_16x16x32_bf16 v[144:147], v[64:67], v[40:43], v[144:147]
    ds_read_b64_tr_b16 v[102:103], v17 offset:57632
    ds_read_b64_tr_b16 v[104:105], v17 offset:55360
    v_mfma_f32_16x16x32_bf16 v[148:151], v[68:71], v[36:39], v[148:151]
    ds_read_b64_tr_b16 v[106:107], v17 offset:57664
    v_mfma_f32_16x16x32_bf16 v[152:155], v[68:71], v[40:43], v[152:155]
    buffer_load_dwordx4 v[32:35], v13, s[4:7], s27 offen
    s_add_u32 s27, s27, 2048
    v_mfma_f32_16x16x32_bf16 v[156:159], v[72:75], v[36:39], v[156:159]
    ds_read_b64_tr_b16 v[108:109], v17 offset:55392
    v_mfma_f32_16x16x32_bf16 v[160:163], v[72:75], v[40:43], v[160:163]
    ds_read_b64_tr_b16 v[110:111], v17 offset:57696
    ds_read_b64_tr_b16 v[112:113], v17 offset:55424
    v_mfma_f32_16x16x32_bf16 v[164:167], v[76:79], v[36:39], v[164:167]
    s_add_u32 m0, s30, 0x9000
    s_nop 0
    buffer_load_dwordx4 v14, s[8:11], s28 offen lds
    v_mfma_f32_16x16x32_bf16 v[168:171], v[76:79], v[40:43], v[168:171]
    ds_read_b64_tr_b16 v[114:115], v17 offset:57728
    v_mfma_f32_16x16x32_bf16 v[172:175], v[80:83], v[36:39], v[172:175]
    ds_read_b64_tr_b16 v[116:117], v17 offset:55456
    ds_read_b64_tr_b16 v[118:119], v17 offset:57760
    v_mfma_f32_16x16x32_bf16 v[176:179], v[80:83], v[40:43], v[176:179]
    s_add_u32 m0, s30, 0x9400
    s_nop 0
    buffer_load_dwordx4 v15, s[8:11], s28 offen lds
    v_mfma_f32_16x16x32_bf16 v[180:183], v[84:87], v[36:39], v[180:183]
    ds_read_b64_tr_b16 v[120:121], v17 offset:55488
    v_mfma_f32_16x16x32_bf16 v[184:187], v[84:87], v[40:43], v[184:187]
    ds_read_b64_tr_b16 v[122:123], v17 offset:57792
    v_mfma_f32_16x16x32_bf16 v[188:191], v[88:91], v[36:39], v[188:191]
    ds_read_b64_tr_b16 v[124:125], v17 offset:55520
    s_add_u32 m0, s30, 0x9800
    s_mov_b64 exec, 0xffff
    buffer_load_dwordx4 v16, s[8:11], s28 offen lds
    s_mov_b64 exec, -1
    s_add_u32 s28, s28, 0x12000
    v_mfma_f32_16x16x32_bf16 v[192:195], v[88:91], v[40:43], v[192:195]
    ds_read_b64_tr_b16 v[126:127], v17 offset:57824
    v_mfma_f32_16x16x32_bf16 v[196:199], v[92:95], v[36:39], v[196:199]
    ds_read_b64_tr_b16 v[128:129], v17 offset:55552
    v_mfma_f32_16x16x32_bf16 v[200:203], v[92:95], v[40:43], v[200:203]
    ds_read_b64_tr_b16 v[130:131], v17 offset:57856
    s_waitcnt vmcnt(10) lgkmcnt(0)
    s_barrier
    v_mfma_f32_16x16x32_bf16 v[132:135], v[96:99], v[44:47], v[132:135]
    ds_read_b64_tr_b16 v[60:61], v17 offset:0
    ds_read_b64_tr_b16 v[62:63], v17 offset:2304
    v_mfma_f32_16x16x32_bf16 v[136:139], v[96:99], v[48:51], v[136:139]
    ds_read_b64_tr_b16 v[64:65], v17 offset:32
    v_mfma_f32_16x16x32_bf16 v[140:143], v[100:103], v[44:47], v[140:143]
    buffer_load_dwordx4 v[36:39], v12, s[4:7], s27 offen
    v_mfma_f32_16x16x32_bf16 v[144:147], v[100:103], v[48:51], v[144:147]
    ds_read_b64_tr_b16 v[66:67], v17 offset:2336
    ds_read_b64_tr_b16 v[68:69], v17 offset:64
    v_mfma_f32_16x16x32_bf16 v[148:151], v[104:107], v[44:47], v[148:151]
    ds_read_b64_tr_b16 v[70:71], v17 offset:2368
    v_mfma_f32_16x16x32_bf16 v[152:155], v[104:107], v[48:51], v[152:155]
    buffer_load_dwordx4 v[40:43], v13, s[4:7], s27 offen
    s_add_u32 s27, s27, 2048
    v_mfma_f32_16x16x32_bf16 v[156:159], v[108:111], v[44:47], v[156:159]
    ds_read_b64_tr_b16 v[72:73], v17 offset:96
    v_mfma_f32_16x16x32_bf16 v[160:163], v[108:111], v[48:51], v[160:163]
    ds_read_b64_tr_b16 v[74:75], v17 offset:2400
    ds_read_b64_tr_b16 v[76:77], v17 offset:128
    v_mfma_f32_16x16x32_bf16 v[164:167], v[112:115], v[44:47], v[164:167]
    s_add_u32 m0, s30, 0xd800
    s_nop 0
    buffer_load_dwordx4 v14, s[8:11], s28 offen lds
    v_mfma_f32_16x16x32_bf16 v[168:171], v[112:115], v[48:51], v[168:171]
    ds_read_b64_tr_b16 v[78:79], v17 offset:2432
    v_mfma_f32_16x16x32_bf16 v[172:175], v[116:119], v[44:47], v[172:175]
    ds_read_b64_tr_b16 v[80:81], v17 offset:160
    ds_read_b64_tr_b16 v[82:83], v17 offset:2464
    v_mfma_f32_16x16x32_bf16 v[176:179], v[116:119], v[48:51], v[176:179]
    s_add_u32 m0, s30, 0xdc00
    s_nop 0
    buffer_load_dwordx4 v15, s[8:11], s28 offen lds
    v_mfma_f32_16x16x32_bf16 v[180:183], v[120:123], v[44:47], v[180:183]
    ds_read_b64_tr_b16 v[84:85], v17 offset:192
    v_mfma_f32_16x16x32_bf16 v[184:187], v[120:123], v[48:51], v[184:187]
    ds_read_b64_tr_b16 v[86:87], v17 offset:2496
    v_mfma_f32_16x16x32_bf16 v[188:191], v[124:127], v[44:47], v[188:191]
    ds_read_b64_tr_b16 v[88:89], v17 offset:224
    s_add_u32 m0, s30, 0xe000
    s_mov_b64 exec, 0xffff
    buffer_load_dwordx4 v16, s[8:11], s28 offen lds
    s_mov_b64 exec, -1
    s_add_u32 s28, s28, 0x12000
    v_mfma_f32_16x16x32_bf16 v[192:195], v[124:127], v[48:51], v[192:195]
    ds_read_b64_tr_b16 v[90:91], v17 offset:2528
    v_mfma_f32_16x16x32_bf16 v[196:199], v[128:131], v[44:47], v[196:199]
    ds_read_b64_tr_b16 v[92:93], v17 offset:256
    v_mfma_f32_16x16x32_bf16 v[200:203], v[128:131], v[48:51], v[200:203]
    ds_read_b64_tr_b16 v[94:95], v17 offset:2560
    s_waitcnt vmcnt(10) lgkmcnt(0)
    s_barrier
    v_mfma_f32_16x16x32_bf16 v[132:135], v[60:63], v[52:55], v[132:135]
    ds_read_b64_tr_b16 v[96:97], v17 offset:18432
    ds_read_b64_tr_b16 v[98:99], v17 offset:20736
    v_mfma_f32_16x16x32_bf16 v[136:139], v[60:63], v[56:59], v[136:139]
    ds_read_b64_tr_b16 v[100:101], v17 offset:18464
    v_mfma_f32_16x16x32_bf16 v[140:143], v[64:67], v[52:55], v[140:143]
    buffer_load_dwordx4 v[44:47], v12, s[4:7], s27 offen
    v_mfma_f32_16x16x32_bf16 v[144:147], v[64:67], v[56:59], v[144:147]
    ds_read_b64_tr_b16 v[102:103], v17 offset:20768
    ds_read_b64_tr_b16 v[104:105], v17 offset:18496
    v_mfma_f32_16x16x32_bf16 v[148:151], v[68:71], v[52:55], v[148:151]
    ds_read_b64_tr_b16 v[106:107], v17 offset:20800
    v_mfma_f32_16x16x32_bf16 v[152:155], v[68:71], v[56:59], v[152:155]
    buffer_load_dwordx4 v[48:51], v13, s[4:7], s27 offen
    s_add_u32 s27, s27, 2048
    v_mfma_f32_16x16x32_bf16 v[156:159], v[72:75], v[52:55], v[156:159]
    ds_read_b64_tr_b16 v[108:109], v17 offset:18528
    v_mfma_f32_16x16x32_bf16 v[160:163], v[72:75], v[56:59], v[160:163]
    ds_read_b64_tr_b16 v[110:111], v17 offset:20832
    ds_read_b64_tr_b16 v[112:113], v17 offset:18560
    v_mfma_f32_16x16x32_bf16 v[164:167], v[76:79], v[52:55], v[164:167]
    s_add_u32 m0, s30, 0x0
    s_nop 0
    buffer_load_dwordx4 v14, s[8:11], s28 offen lds
    v_mfma_f32_16x16x32_bf16 v[168:171], v[76:79], v[56:59], v[168:171]
    ds_read_b64_tr_b16 v[114:115], v17 offset:20864
    v_mfma_f32_16x16x32_bf16 v[172:175], v[80:83], v[52:55], v[172:175]
    ds_read_b64_tr_b16 v[116:117], v17 offset:18592
    ds_read_b64_tr_b16 v[118:119], v17 offset:20896
    v_mfma_f32_16x16x32_bf16 v[176:179], v[80:83], v[56:59], v[176:179]
    s_add_u32 m0, s30, 0x400
    s_nop 0
    buffer_load_dwordx4 v15, s[8:11], s28 offen lds
    v_mfma_f32_16x16x32_bf16 v[180:183], v[84:87], v[52:55], v[180:183]
    ds_read_b64_tr_b16 v[120:121], v17 offset:18624
    v_mfma_f32_16x16x32_bf16 v[184:187], v[84:87], v[56:59], v[184:187]
    ds_read_b64_tr_b16 v[122:123], v17 offset:20928
    v_mfma_f32_16x16x32_bf16 v[188:191], v[88:91], v[52:55], v[188:191]
    ds_read_b64_tr_b16 v[124:125], v17 offset:18656
    s_add_u32 m0, s30, 0x800
    s_mov_b64 exec, 0xffff
    buffer_load_dwordx4 v16, s[8:11], s28 offen lds
    s_mov_b64 exec, -1
    s_add_u32 s28, s28, 0x12000
    v_mfma_f32_16x16x32_bf16 v[192:195], v[88:91], v[56:59], v[192:195]
    ds_read_b64_tr_b16 v[126:127], v17 offset:20960
    v_mfma_f32_16x16x32_bf16 v[196:199], v[92:95], v[52:55], v[196:199]
    ds_read_b64_tr_b16 v[128:129], v17 offset:18688
    v_mfma_f32_16x16x32_bf16 v[200:203], v[92:95], v[56:59], v[200:203]
    ds_read_b64_tr_b16 v[130:131], v17 offset:20992
    s_waitcnt vmcnt(10) lgkmcnt(0)
    s_barrier
    v_mfma_f32_16x16x32_bf16 v[132:135], v[96:99], v[20:23], v[132:135]
    ds_read_b64_tr_b16 v[60:61], v17 offset:36864
    ds_read_b64_tr_b16 v[62:63], v17 offset:39168
    v_mfma_f32_16x16x32_bf16 v[136:139], v[96:99], v[24:27], v[136:139]
    ds_read_b64_tr_b16 v[64:65], v17 offset:36896
    v_mfma_f32_16x16x32_bf16 v[140:143], v[100:103], v[20:23], v[140:143]
    buffer_load_dwordx4 v[52:55], v12, s[4:7], s27 offen
    v_mfma_f32_16x16x32_bf16 v[144:147], v[100:103], v[24:27], v[144:147]
    ds_read_b64_tr_b16 v[66:67], v17 offset:39200
    ds_read_b64_tr_b16 v[68:69], v17 offset:36928
    v_mfma_f32_16x16x32_bf16 v[148:151], v[104:107], v[20:23], v[148:151]
    ds_read_b64_tr_b16 v[70:71], v17 offset:39232
    v_mfma_f32_16x16x32_bf16 v[152:155], v[104:107], v[24:27], v[152:155]
    buffer_load_dwordx4 v[56:59], v13, s[4:7], s27 offen
    s_add_u32 s27, s27, 2048
    v_mfma_f32_16x16x32_bf16 v[156:159], v[108:111], v[20:23], v[156:159]
    ds_read_b64_tr_b16 v[72:73], v17 offset:36960
    v_mfma_f32_16x16x32_bf16 v[160:163], v[108:111], v[24:27], v[160:163]
    ds_read_b64_tr_b16 v[74:75], v17 offset:39264
    ds_read_b64_tr_b16 v[76:77], v17 offset:36992
    v_mfma_f32_16x16x32_bf16 v[164:167], v[112:115], v[20:23], v[164:167]
    s_add_u32 m0, s30, 0x4800
    s_nop 0
    buffer_load_dwordx4 v14, s[8:11], s28 offen lds
    v_mfma_f32_16x16x32_bf16 v[168:171], v[112:115], v[24:27], v[168:171]
    ds_read_b64_tr_b16 v[78:79], v17 offset:39296
    v_mfma_f32_16x16x32_bf16 v[172:175], v[116:119], v[20:23], v[172:175]
    ds_read_b64_tr_b16 v[80:81], v17 offset:37024
    ds_read_b64_tr_b16 v[82:83], v17 offset:39328
    v_mfma_f32_16x16x32_bf16 v[176:179], v[116:119], v[24:27], v[176:179]
    s_add_u32 m0, s30, 0x4c00
    s_nop 0
    buffer_load_dwordx4 v15, s[8:11], s28 offen lds
    v_mfma_f32_16x16x32_bf16 v[180:183], v[120:123], v[20:23], v[180:183]
    ds_read_b64_tr_b16 v[84:85], v17 offset:37056
    v_mfma_f32_16x16x32_bf16 v[184:187], v[120:123], v[24:27], v[184:187]
    ds_read_b64_tr_b16 v[86:87], v17 offset:39360
    v_mfma_f32_16x16x32_bf16 v[188:191], v[124:127], v[20:23], v[188:191]
    ds_read_b64_tr_b16 v[88:89], v17 offset:37088
    s_add_u32 m0, s30, 0x5000
    s_mov_b64 exec, 0xffff
    buffer_load_dwordx4 v16, s[8:11], s28 offen lds
    s_mov_b64 exec, -1
    s_add_u32 s28, s28, 0x12000
    v_mfma_f32_16x16x32_bf16 v[192:195], v[124:127], v[24:27], v[192:195]
    ds_read_b64_tr_b16 v[90:91], v17 offset:39392
    v_mfma_f32_16x16x32_bf16 v[196:199], v[128:131], v[20:23], v[196:199]
    ds_read_b64_tr_b16 v[92:93], v17 offset:37120
    v_mfma_f32_16x16x32_bf16 v[200:203], v[128:131], v[24:27], v[200:203]
    ds_read_b64_tr_b16 v[94:95], v17 offset:39424
    s_waitcnt vmcnt(10) lgkmcnt(0)
    s_barrier
    v_mfma_f32_16x16x32_bf16 v[132:135], v[60:63], v[28:31], v[132:135]
    ds_read_b64_tr_b16 v[96:97], v17 offset:55296
    ds_read_b64_tr_b16 v[98:99], v17 offset:57600
    v_mfma_f32_16x16x32_bf16 v[136:139], v[60:63], v[32:35], v[136:139]
    ds_read_b64_tr_b16 v[100:101], v17 offset:55328
    v_mfma_f32_16x16x32_bf16 v[140:143], v[64:67], v[28:31], v[140:143]
    buffer_load_dwordx4 v[20:23], v12, s[4:7], s27 offen
    v_mfma_f32_16x16x32_bf16 v[144:147], v[64:67], v[32:35], v[144:147]
    ds_read_b64_tr_b16 v[102:103], v17 offset:57632
    ds_read_b64_tr_b16 v[104:105], v17 offset:55360
    v_mfma_f32_16x16x32_bf16 v[148:151], v[68:71], v[28:31], v[148:151]
    ds_read_b64_tr_b16 v[106:107], v17 offset:57664
    v_mfma_f32_16x16x32_bf16 v[152:155], v[68:71], v[32:35], v[152:155]
    buffer_load_dwordx4 v[24:27], v13, s[4:7], s27 offen
    s_add_u32 s27, s27, 2048
    v_mfma_f32_16x16x32_bf16 v[156:159], v[72:75], v[28:31], v[156:159]
    ds_read_b64_tr_b16 v[108:109], v17 offset:55392
    v_mfma_f32_16x16x32_bf16 v[160:163], v[72:75], v[32:35], v[160:163]
    ds_read_b64_tr_b16 v[110:111], v17 offset:57696
    ds_read_b64_tr_b16 v[112:113], v17 offset:55424
    v_mfma_f32_16x16x32_bf16 v[164:167], v[76:79], v[28:31], v[164:167]
    s_add_u32 m0, s30, 0x9000
    s_nop 0
    buffer_load_dwordx4 v14, s[8:11], s28 offen lds
    v_mfma_f32_16x16x32_bf16 v[168:171], v[76:79], v[32:35], v[168:171]
    ds_read_b64_tr_b16 v[114:115], v17 offset:57728
    v_mfma_f32_16x16x32_bf16 v[172:175], v[80:83], v[28:31], v[172:175]
    ds_read_b64_tr_b16 v[116:117], v17 offset:55456
    ds_read_b64_tr_b16 v[118:119], v17 offset:57760
    v_mfma_f32_16x16x32_bf16 v[176:179], v[80:83], v[32:35], v[176:179]
    s_add_u32 m0, s30, 0x9400
    s_nop 0
    buffer_load_dwordx4 v15, s[8:11], s28 offen lds
    v_mfma_f32_16x16x32_bf16 v[180:183], v[84:87], v[28:31], v[180:183]
    ds_read_b64_tr_b16 v[120:121], v17 offset:55488
    v_mfma_f32_16x16x32_bf16 v[184:187], v[84:87], v[32:35], v[184:187]
    ds_read_b64_tr_b16 v[122:123], v17 offset:57792
    v_mfma_f32_16x16x32_bf16 v[188:191], v[88:91], v[28:31], v[188:191]
    ds_read_b64_tr_b16 v[124:125], v17 offset:55520
    s_add_u32 m0, s30, 0x9800
    s_mov_b64 exec, 0xffff
    buffer_load_dwordx4 v16, s[8:11], s28 offen lds
    s_mov_b64 exec, -1
    s_add_u32 s28, s28, 0x12000
    v_mfma_f32_16x16x32_bf16 v[192:195], v[88:91], v[32:35], v[192:195]
    ds_read_b64_tr_b16 v[126:127], v17 offset:57824
    v_mfma_f32_16x16x32_bf16 v[196:199], v[92:95], v[28:31], v[196:199]
    ds_read_b64_tr_b16 v[128:129], v17 offset:55552
    v_mfma_f32_16x16x32_bf16 v[200:203], v[92:95], v[32:35], v[200:203]
    ds_read_b64_tr_b16 v[130:131], v17 offset:57856
    s_waitcnt vmcnt(10) lgkmcnt(0)
    s_barrier
    v_mfma_f32_16x16x32_bf16 v[132:135], v[96:99], v[36:39], v[132:135]
    ds_read_b64_tr_b16 v[60:61], v17 offset:0
    ds_read_b64_tr_b16 v[62:63], v17 offset:2304
    v_mfma_f32_16x16x32_bf16 v[136:139], v[96:99], v[40:43], v[136:139]
    ds_read_b64_tr_b16 v[64:65], v17 offset:32
    v_mfma_f32_16x16x32_bf16 v[140:143], v[100:103], v[36:39], v[140:143]
    buffer_load_dwordx4 v[28:31], v12, s[4:7], s27 offen
    v_mfma_f32_16x16x32_bf16 v[144:147], v[100:103], v[40:43], v[144:147]
    ds_read_b64_tr_b16 v[66:67], v17 offset:2336
    ds_read_b64_tr_b16 v[68:69], v17 offset:64
    v_mfma_f32_16x16x32_bf16 v[148:151], v[104:107], v[36:39], v[148:151]
    ds_read_b64_tr_b16 v[70:71], v17 offset:2368
    v_mfma_f32_16x16x32_bf16 v[152:155], v[104:107], v[40:43], v[152:155]
    buffer_load_dwordx4 v[32:35], v13, s[4:7], s27 offen
    s_add_u32 s27, s27, 2048
    v_mfma_f32_16x16x32_bf16 v[156:159], v[108:111], v[36:39], v[156:159]
    ds_read_b64_tr_b16 v[72:73], v17 offset:96
    v_mfma_f32_16x16x32_bf16 v[160:163], v[108:111], v[40:43], v[160:163]
    ds_read_b64_tr_b16 v[74:75], v17 offset:2400
    ds_read_b64_tr_b16 v[76:77], v17 offset:128
    v_mfma_f32_16x16x32_bf16 v[164:167], v[112:115], v[36:39], v[164:167]
    s_add_u32 m0, s30, 0xd800
    s_nop 0
    buffer_load_dwordx4 v14, s[8:11], s28 offen lds
    v_mfma_f32_16x16x32_bf16 v[168:171], v[112:115], v[40:43], v[168:171]
    ds_read_b64_tr_b16 v[78:79], v17 offset:2432
    v_mfma_f32_16x16x32_bf16 v[172:175], v[116:119], v[36:39], v[172:175]
    ds_read_b64_tr_b16 v[80:81], v17 offset:160
    ds_read_b64_tr_b16 v[82:83], v17 offset:2464
    v_mfma_f32_16x16x32_bf16 v[176:179], v[116:119], v[40:43], v[176:179]
    s_add_u32 m0, s30, 0xdc00
    s_nop 0
    buffer_load_dwordx4 v15, s[8:11], s28 offen lds
    v_mfma_f32_16x16x32_bf16 v[180:183], v[120:123], v[36:39], v[180:183]
    ds_read_b64_tr_b16 v[84:85], v17 offset:192
    v_mfma_f32_16x16x32_bf16 v[184:187], v[120:123], v[40:43], v[184:187]
    ds_read_b64_tr_b16 v[86:87], v17 offset:2496
    v_mfma_f32_16x16x32_bf16 v[188:191], v[124:127], v[36:39], v[188:191]
    ds_read_b64_tr_b16 v[88:89], v17 offset:224
    s_add_u32 m0, s30, 0xe000
    s_mov_b64 exec, 0xffff
    buffer_load_dwordx4 v16, s[8:11], s28 offen lds
    s_mov_b64 exec, -1
    s_add_u32 s28, s28, 0x12000
    v_mfma_f32_16x16x32_bf16 v[192:195], v[124:127], v[40:43], v[192:195]
    ds_read_b64_tr_b16 v[90:91], v17 offset:2528
    v_mfma_f32_16x16x32_bf16 v[196:199], v[128:131], v[36:39], v[196:199]
    ds_read_b64_tr_b16 v[92:93], v17 offset:256
    v_mfma_f32_16x16x32_bf16 v[200:203], v[128:131], v[40:43], v[200:203]
    ds_read_b64_tr_b16 v[94:95], v17 offset:2560
    s_waitcnt vmcnt(10) lgkmcnt(0)
    s_barrier
    v_mfma_f32_16x16x32_bf16 v[132:135], v[60:63], v[44:47], v[132:135]
    ds_read_b64_tr_b16 v[96:97], v17 offset:18432
    ds_read_b64_tr_b16 v[98:99], v17 offset:20736
    v_mfma_f32_16x16x32_bf16 v[136:139], v[60:63], v[48:51], v[136:139]
    ds_read_b64_tr_b16 v[100:101], v17 offset:18464
    v_mfma_f32_16x16x32_bf16 v[140:143], v[64:67], v[44:47], v[140:143]
    buffer_load_dwordx4 v[36:39], v12, s[4:7], s27 offen
    v_mfma_f32_16x16x32_bf16 v[144:147], v[64:67], v[48:51], v[144:147]
    ds_read_b64_tr_b16 v[102:103], v17 offset:20768
    ds_read_b64_tr_b16 v[104:105], v17 offset:18496
    v_mfma_f32_16x16x32_bf16 v[148:151], v[68:71], v[44:47], v[148:151]
    ds_read_b64_tr_b16 v[106:107], v17 offset:20800
    v_mfma_f32_16x16x32_bf16 v[152:155], v[68:71], v[48:51], v[152:155]
    buffer_load_dwordx4 v[40:43], v13, s[4:7], s27 offen
    s_add_u32 s27, s27, 2048
    v_mfma_f32_16x16x32_bf16 v[156:159], v[72:75], v[44:47], v[156:159]
    ds_read_b64_tr_b16 v[108:109], v17 offset:18528
    v_mfma_f32_16x16x32_bf16 v[160:163], v[72:75], v[48:51], v[160:163]
    ds_read_b64_tr_b16 v[110:111], v17 offset:20832
    ds_read_b64_tr_b16 v[112:113], v17 offset:18560
    v_mfma_f32_16x16x32_bf16 v[164:167], v[76:79], v[44:47], v[164:167]
    s_add_u32 m0, s30, 0x0
    s_nop 0
    buffer_load_dwordx4 v14, s[8:11], s28 offen lds
    v_mfma_f32_16x16x32_bf16 v[168:171], v[76:79], v[48:51], v[168:171]
    ds_read_b64_tr_b16 v[114:115], v17 offset:20864
    v_mfma_f32_16x16x32_bf16 v[172:175], v[80:83], v[44:47], v[172:175]
    ds_read_b64_tr_b16 v[116:117], v17 offset:18592
    ds_read_b64_tr_b16 v[118:119], v17 offset:20896
    v_mfma_f32_16x16x32_bf16 v[176:179], v[80:83], v[48:51], v[176:179]
    s_add_u32 m0, s30, 0x400
    s_nop 0
    buffer_load_dwordx4 v15, s[8:11], s28 offen lds
    v_mfma_f32_16x16x32_bf16 v[180:183], v[84:87], v[44:47], v[180:183]
    ds_read_b64_tr_b16 v[120:121], v17 offset:18624
    v_mfma_f32_16x16x32_bf16 v[184:187], v[84:87], v[48:51], v[184:187]
    ds_read_b64_tr_b16 v[122:123], v17 offset:20928
    v_mfma_f32_16x16x32_bf16 v[188:191], v[88:91], v[44:47], v[188:191]
    ds_read_b64_tr_b16 v[124:125], v17 offset:18656
    s_add_u32 m0, s30, 0x800
    s_mov_b64 exec, 0xffff
    buffer_load_dwordx4 v16, s[8:11], s28 offen lds
    s_mov_b64 exec, -1
    s_add_u32 s28, s28, 0x12000
    v_mfma_f32_16x16x32_bf16 v[192:195], v[88:91], v[48:51], v[192:195]
    ds_read_b64_tr_b16 v[126:127], v17 offset:20960
    v_mfma_f32_16x16x32_bf16 v[196:199], v[92:95], v[44:47], v[196:199]
    ds_read_b64_tr_b16 v[128:129], v17 offset:18688
    v_mfma_f32_16x16x32_bf16 v[200:203], v[92:95], v[48:51], v[200:203]
    ds_read_b64_tr_b16 v[130:131], v17 offset:20992
    s_waitcnt vmcnt(10) lgkmcnt(0)
    s_barrier
    v_mfma_f32_16x16x32_bf16 v[132:135], v[96:99], v[52:55], v[132:135]
    ds_read_b64_tr_b16 v[60:61], v17 offset:36864
    ds_read_b64_tr_b16 v[62:63], v17 offset:39168
    v_mfma_f32_16x16x32_bf16 v[136:139], v[96:99], v[56:59], v[136:139]
    ds_read_b64_tr_b16 v[64:65], v17 offset:36896
    v_mfma_f32_16x16x32_bf16 v[140:143], v[100:103], v[52:55], v[140:143]
    buffer_load_dwordx4 v[44:47], v12, s[4:7], s27 offen
    v_mfma_f32_16x16x32_bf16 v[144:147], v[100:103], v[56:59], v[144:147]
    ds_read_b64_tr_b16 v[66:67], v17 offset:39200
    ds_read_b64_tr_b16 v[68:69], v17 offset:36928
    v_mfma_f32_16x16x32_bf16 v[148:151], v[104:107], v[52:55], v[148:151]
    ds_read_b64_tr_b16 v[70:71], v17 offset:39232
    v_mfma_f32_16x16x32_bf16 v[152:155], v[104:107], v[56:59], v[152:155]
    buffer_load_dwordx4 v[48:51], v13, s[4:7], s27 offen
    s_add_u32 s27, s27, 2048
    v_mfma_f32_16x16x32_bf16 v[156:159], v[108:111], v[52:55], v[156:159]
    ds_read_b64_tr_b16 v[72:73], v17 offset:36960
    v_mfma_f32_16x16x32_bf16 v[160:163], v[108:111], v[56:59], v[160:163]
    ds_read_b64_tr_b16 v[74:75], v17 offset:39264
    ds_read_b64_tr_b16 v[76:77], v17 offset:36992
    v_mfma_f32_16x16x32_bf16 v[164:167], v[112:115], v[52:55], v[164:167]
    s_add_u32 m0, s30, 0x4800
    s_nop 0
    buffer_load_dwordx4 v14, s[8:11], s28 offen lds
    v_mfma_f32_16x16x32_bf16 v[168:171], v[112:115], v[56:59], v[168:171]
    ds_read_b64_tr_b16 v[78:79], v17 offset:39296
    v_mfma_f32_16x16x32_bf16 v[172:175], v[116:119], v[52:55], v[172:175]
    ds_read_b64_tr_b16 v[80:81], v17 offset:37024
    ds_read_b64_tr_b16 v[82:83], v17 offset:39328
    v_mfma_f32_16x16x32_bf16 v[176:179], v[116:119], v[56:59], v[176:179]
    s_add_u32 m0, s30, 0x4c00
    s_nop 0
    buffer_load_dwordx4 v15, s[8:11], s28 offen lds
    v_mfma_f32_16x16x32_bf16 v[180:183], v[120:123], v[52:55], v[180:183]
    ds_read_b64_tr_b16 v[84:85], v17 offset:37056
    v_mfma_f32_16x16x32_bf16 v[184:187], v[120:123], v[56:59], v[184:187]
    ds_read_b64_tr_b16 v[86:87], v17 offset:39360
    v_mfma_f32_16x16x32_bf16 v[188:191], v[124:127], v[52:55], v[188:191]
    ds_read_b64_tr_b16 v[88:89], v17 offset:37088
    s_add_u32 m0, s30, 0x5000
    s_mov_b64 exec, 0xffff
    buffer_load_dwordx4 v16, s[8:11], s28 offen lds
    s_mov_b64 exec, -1
    s_add_u32 s28, s28, 0x12000
    v_mfma_f32_16x16x32_bf16 v[192:195], v[124:127], v[56:59], v[192:195]
    ds_read_b64_tr_b16 v[90:91], v17 offset:39392
    v_mfma_f32_16x16x32_bf16 v[196:199], v[128:131], v[52:55], v[196:199]
    ds_read_b64_tr_b16 v[92:93], v17 offset:37120
    v_mfma_f32_16x16x32_bf16 v[200:203], v[128:131], v[56:59], v[200:203]
    ds_read_b64_tr_b16 v[94:95], v17 offset:39424
    s_waitcnt vmcnt(10) lgkmcnt(0)
    s_barrier
    v_mfma_f32_16x16x32_bf16 v[132:135], v[60:63], v[20:23], v[132:135]
    ds_read_b64_tr_b16 v[96:97], v17 offset:55296
    ds_read_b64_tr_b16 v[98:99], v17 offset:57600
    v_mfma_f32_16x16x32_bf16 v[136:139], v[60:63], v[24:27], v[136:139]
    ds_read_b64_tr_b16 v[100:101], v17 offset:55328
    v_mfma_f32_16x16x32_bf16 v[140:143], v[64:67], v[20:23], v[140:143]
    buffer_load_dwordx4 v[52:55], v12, s[4:7], s27 offen
    v_mfma_f32_16x16x32_bf16 v[144:147], v[64:67], v[24:27], v[144:147]
    ds_read_b64_tr_b16 v[102:103], v17 offset:57632
    ds_read_b64_tr_b16 v[104:105], v17 offset:55360
    v_mfma_f32_16x16x32_bf16 v[148:151], v[68:71], v[20:23], v[148:151]
    ds_read_b64_tr_b16 v[106:107], v17 offset:57664
    v_mfma_f32_16x16x32_bf16 v[152:155], v[68:71], v[24:27], v[152:155]
    buffer_load_dwordx4 v[56:59], v13, s[4:7], s27 offen
    s_add_u32 s27, s27, 2048
    v_mfma_f32_16x16x32_bf16 v[156:159], v[72:75], v[20:23], v[156:159]
    ds_read_b64_tr_b16 v[108:109], v17 offset:55392
    v_mfma_f32_16x16x32_bf16 v[160:163], v[72:75], v[24:27], v[160:163]
    ds_read_b64_tr_b16 v[110:111], v17 offset:57696
    ds_read_b64_tr_b16 v[112:113], v17 offset:55424
    v_mfma_f32_16x16x32_bf16 v[164:167], v[76:79], v[20:23], v[164:167]
    s_add_u32 m0, s30, 0x9000
    s_nop 0
    buffer_load_dwordx4 v14, s[8:11], s28 offen lds
    v_mfma_f32_16x16x32_bf16 v[168:171], v[76:79], v[24:27], v[168:171]
    ds_read_b64_tr_b16 v[114:115], v17 offset:57728
    v_mfma_f32_16x16x32_bf16 v[172:175], v[80:83], v[20:23], v[172:175]
    ds_read_b64_tr_b16 v[116:117], v17 offset:55456
    ds_read_b64_tr_b16 v[118:119], v17 offset:57760
    v_mfma_f32_16x16x32_bf16 v[176:179], v[80:83], v[24:27], v[176:179]
    s_add_u32 m0, s30, 0x9400
    s_nop 0
    buffer_load_dwordx4 v15, s[8:11], s28 offen lds
    v_mfma_f32_16x16x32_bf16 v[180:183], v[84:87], v[20:23], v[180:183]
    ds_read_b64_tr_b16 v[120:121], v17 offset:55488
    v_mfma_f32_16x16x32_bf16 v[184:187], v[84:87], v[24:27], v[184:187]
    ds_read_b64_tr_b16 v[122:123], v17 offset:57792
    v_mfma_f32_16x16x32_bf16 v[188:191], v[88:91], v[20:23], v[188:191]
    ds_read_b64_tr_b16 v[124:125], v17 offset:55520
    s_add_u32 m0, s30, 0x9800
    s_mov_b64 exec, 0xffff
    buffer_load_dwordx4 v16, s[8:11], s28 offen lds
    s_mov_b64 exec, -1
    s_add_u32 s28, s28, 0x12000
    v_mfma_f32_16x16x32_bf16 v[192:195], v[88:91], v[24:27], v[192:195]
    ds_read_b64_tr_b16 v[126:127], v17 offset:57824
    v_mfma_f32_16x16x32_bf16 v[196:199], v[92:95], v[20:23], v[196:199]
    ds_read_b64_tr_b16 v[128:129], v17 offset:55552
    v_mfma_f32_16x16x32_bf16 v[200:203], v[92:95], v[24:27], v[200:203]
    ds_read_b64_tr_b16 v[130:131], v17 offset:57856
    s_waitcnt vmcnt(10) lgkmcnt(0)
    s_barrier
    v_mfma_f32_16x16x32_bf16 v[132:135], v[96:99], v[28:31], v[132:135]
    ds_read_b64_tr_b16 v[60:61], v17 offset:0
    ds_read_b64_tr_b16 v[62:63], v17 offset:2304
    v_mfma_f32_16x16x32_bf16 v[136:139], v[96:99], v[32:35], v[136:139]
    ds_read_b64_tr_b16 v[64:65], v17 offset:32
    v_mfma_f32_16x16x32_bf16 v[140:143], v[100:103], v[28:31], v[140:143]
    buffer_load_dwordx4 v[20:23], v12, s[4:7], s27 offen
    v_mfma_f32_16x16x32_bf16 v[144:147], v[100:103], v[32:35], v[144:147]
    ds_read_b64_tr_b16 v[66:67], v17 offset:2336
    ds_read_b64_tr_b16 v[68:69], v17 offset:64
    v_mfma_f32_16x16x32_bf16 v[148:151], v[104:107], v[28:31], v[148:151]
    ds_read_b64_tr_b16 v[70:71], v17 offset:2368
    v_mfma_f32_16x16x32_bf16 v[152:155], v[104:107], v[32:35], v[152:155]
    buffer_load_dwordx4 v[24:27], v13, s[4:7], s27 offen
    s_add_u32 s27, s27, 2048
    v_mfma_f32_16x16x32_bf16 v[156:159], v[108:111], v[28:31], v[156:159]
    ds_read_b64_tr_b16 v[72:73], v17 offset:96
    v_mfma_f32_16x16x32_bf16 v[160:163], v[108:111], v[32:35], v[160:163]
    ds_read_b64_tr_b16 v[74:75], v17 offset:2400
    ds_read_b64_tr_b16 v[76:77], v17 offset:128
    v_mfma_f32_16x16x32_bf16 v[164:167], v[112:115], v[28:31], v[164:167]
    s_add_u32 m0, s30, 0xd800
    s_nop 0
    buffer_load_dwordx4 v14, s[8:11], s28 offen lds
    v_mfma_f32_16x16x32_bf16 v[168:171], v[112:115], v[32:35], v[168:171]
    ds_read_b64_tr_b16 v[78:79], v17 offset:2432
    v_mfma_f32_16x16x32_bf16 v[172:175], v[116:119], v[28:31], v[172:175]
    ds_read_b64_tr_b16 v[80:81], v17 offset:160
    ds_read_b64_tr_b16 v[82:83], v17 offset:2464
    v_mfma_f32_16x16x32_bf16 v[176:179], v[116:119], v[32:35], v[176:179]
    s_add_u32 m0, s30, 0xdc00
    s_nop 0
    buffer_load_dwordx4 v15, s[8:11], s28 offen lds
    v_mfma_f32_16x16x32_bf16 v[180:183], v[120:123], v[28:31], v[180:183]
    ds_read_b64_tr_b16 v[84:85], v17 offset:192
    v_mfma_f32_16x16x32_bf16 v[184:187], v[120:123], v[32:35], v[184:187]
    ds_read_b64_tr_b16 v[86:87], v17 offset:2496
    v_mfma_f32_16x16x32_bf16 v[188:191], v[124:127], v[28:31], v[188:191]
    ds_read_b64_tr_b16 v[88:89], v17 offset:224
    s_add_u32 m0, s30, 0xe000
    s_mov_b64 exec, 0xffff
    buffer_load_dwordx4 v16, s[8:11], s28 offen lds
    s_mov_b64 exec, -1
    s_add_u32 s28, s28, 0x12000
    v_mfma_f32_16x16x32_bf16 v[192:195], v[124:127], v[32:35], v[192:195]
    ds_read_b64_tr_b16 v[90:91], v17 offset:2528
    v_mfma_f32_16x16x32_bf16 v[196:199], v[128:131], v[28:31], v[196:199]
    ds_read_b64_tr_b16 v[92:93], v17 offset:256
    v_mfma_f32_16x16x32_bf16 v[200:203], v[128:131], v[32:35], v[200:203]
    ds_read_b64_tr_b16 v[94:95], v17 offset:2560
    s_waitcnt vmcnt(10) lgkmcnt(0)
    s_barrier
    v_mfma_f32_16x16x32_bf16 v[132:135], v[60:63], v[36:39], v[132:135]
    ds_read_b64_tr_b16 v[96:97], v17 offset:18432
    ds_read_b64_tr_b16 v[98:99], v17 offset:20736
    v_mfma_f32_16x16x32_bf16 v[136:139], v[60:63], v[40:43], v[136:139]
    ds_read_b64_tr_b16 v[100:101], v17 offset:18464
    v_mfma_f32_16x16x32_bf16 v[140:143], v[64:67], v[36:39], v[140:143]
    buffer_load_dwordx4 v[28:31], v12, s[4:7], s27 offen
    v_mfma_f32_16x16x32_bf16 v[144:147], v[64:67], v[40:43], v[144:147]
    ds_read_b64_tr_b16 v[102:103], v17 offset:20768
    ds_read_b64_tr_b16 v[104:105], v17 offset:18496
    v_mfma_f32_16x16x32_bf16 v[148:151], v[68:71], v[36:39], v[148:151]
    ds_read_b64_tr_b16 v[106:107], v17 offset:20800
    v_mfma_f32_16x16x32_bf16 v[152:155], v[68:71], v[40:43], v[152:155]
    buffer_load_dwordx4 v[32:35], v13, s[4:7], s27 offen
    s_add_u32 s27, s27, 2048
    v_mfma_f32_16x16x32_bf16 v[156:159], v[72:75], v[36:39], v[156:159]
    ds_read_b64_tr_b16 v[108:109], v17 offset:18528
    v_mfma_f32_16x16x32_bf16 v[160:163], v[72:75], v[40:43], v[160:163]
    ds_read_b64_tr_b16 v[110:111], v17 offset:20832
    ds_read_b64_tr_b16 v[112:113], v17 offset:18560
    v_mfma_f32_16x16x32_bf16 v[164:167], v[76:79], v[36:39], v[164:167]
    s_add_u32 m0, s30, 0x0
    s_nop 0
    buffer_load_dwordx4 v14, s[8:11], s28 offen lds
    v_mfma_f32_16x16x32_bf16 v[168:171], v[76:79], v[40:43], v[168:171]
    ds_read_b64_tr_b16 v[114:115], v17 offset:20864
    v_mfma_f32_16x16x32_bf16 v[172:175], v[80:83], v[36:39], v[172:175]
    ds_read_b64_tr_b16 v[116:117], v17 offset:18592
    ds_read_b64_tr_b16 v[118:119], v17 offset:20896
    v_mfma_f32_16x16x32_bf16 v[176:179], v[80:83], v[40:43], v[176:179]
    s_add_u32 m0, s30, 0x400
    s_nop 0
    buffer_load_dwordx4 v15, s[8:11], s28 offen lds
    v_mfma_f32_16x16x32_bf16 v[180:183], v[84:87], v[36:39], v[180:183]
    ds_read_b64_tr_b16 v[120:121], v17 offset:18624
    v_mfma_f32_16x16x32_bf16 v[184:187], v[84:87], v[40:43], v[184:187]
    ds_read_b64_tr_b16 v[122:123], v17 offset:20928
    v_mfma_f32_16x16x32_bf16 v[188:191], v[88:91], v[36:39], v[188:191]
    ds_read_b64_tr_b16 v[124:125], v17 offset:18656
    s_add_u32 m0, s30, 0x800
    s_mov_b64 exec, 0xffff
    buffer_load_dwordx4 v16, s[8:11], s28 offen lds
    s_mov_b64 exec, -1
    s_add_u32 s28, s28, 0x12000
    v_mfma_f32_16x16x32_bf16 v[192:195], v[88:91], v[40:43], v[192:195]
    ds_read_b64_tr_b16 v[126:127], v17 offset:20960
    v_mfma_f32_16x16x32_bf16 v[196:199], v[92:95], v[36:39], v[196:199]
    ds_read_b64_tr_b16 v[128:129], v17 offset:18688
    v_mfma_f32_16x16x32_bf16 v[200:203], v[92:95], v[40:43], v[200:203]
    ds_read_b64_tr_b16 v[130:131], v17 offset:20992
    s_waitcnt vmcnt(10) lgkmcnt(0)
    s_barrier
    v_mfma_f32_16x16x32_bf16 v[132:135], v[96:99], v[44:47], v[132:135]
    ds_read_b64_tr_b16 v[60:61], v17 offset:36864
    ds_read_b64_tr_b16 v[62:63], v17 offset:39168
    v_mfma_f32_16x16x32_bf16 v[136:139], v[96:99], v[48:51], v[136:139]
    ds_read_b64_tr_b16 v[64:65], v17 offset:36896
    v_mfma_f32_16x16x32_bf16 v[140:143], v[100:103], v[44:47], v[140:143]
    buffer_load_dwordx4 v[36:39], v12, s[4:7], s27 offen
    v_mfma_f32_16x16x32_bf16 v[144:147], v[100:103], v[48:51], v[144:147]
    ds_read_b64_tr_b16 v[66:67], v17 offset:39200
    ds_read_b64_tr_b16 v[68:69], v17 offset:36928
    v_mfma_f32_16x16x32_bf16 v[148:151], v[104:107], v[44:47], v[148:151]
    ds_read_b64_tr_b16 v[70:71], v17 offset:39232
    v_mfma_f32_16x16x32_bf16 v[152:155], v[104:107], v[48:51], v[152:155]
    buffer_load_dwordx4 v[40:43], v13, s[4:7], s27 offen
    s_add_u32 s27, s27, 2048
    v_mfma_f32_16x16x32_bf16 v[156:159], v[108:111], v[44:47], v[156:159]
    ds_read_b64_tr_b16 v[72:73], v17 offset:36960
    v_mfma_f32_16x16x32_bf16 v[160:163], v[108:111], v[48:51], v[160:163]
    ds_read_b64_tr_b16 v[74:75], v17 offset:39264
    ds_read_b64_tr_b16 v[76:77], v17 offset:36992
    v_mfma_f32_16x16x32_bf16 v[164:167], v[112:115], v[44:47], v[164:167]
    s_add_u32 m0, s30, 0x4800
    s_nop 0
    buffer_load_dwordx4 v14, s[8:11], s28 offen lds
    v_mfma_f32_16x16x32_bf16 v[168:171], v[112:115], v[48:51], v[168:171]
    ds_read_b64_tr_b16 v[78:79], v17 offset:39296
    v_mfma_f32_16x16x32_bf16 v[172:175], v[116:119], v[44:47], v[172:175]
    ds_read_b64_tr_b16 v[80:81], v17 offset:37024
    ds_read_b64_tr_b16 v[82:83], v17 offset:39328
    v_mfma_f32_16x16x32_bf16 v[176:179], v[116:119], v[48:51], v[176:179]
    s_add_u32 m0, s30, 0x4c00
    s_nop 0
    buffer_load_dwordx4 v15, s[8:11], s28 offen lds
    v_mfma_f32_16x16x32_bf16 v[180:183], v[120:123], v[44:47], v[180:183]
    ds_read_b64_tr_b16 v[84:85], v17 offset:37056
    v_mfma_f32_16x16x32_bf16 v[184:187], v[120:123], v[48:51], v[184:187]
    ds_read_b64_tr_b16 v[86:87], v17 offset:39360
    v_mfma_f32_16x16x32_bf16 v[188:191], v[124:127], v[44:47], v[188:191]
    ds_read_b64_tr_b16 v[88:89], v17 offset:37088
    s_add_u32 m0, s30, 0x5000
    s_mov_b64 exec, 0xffff
    buffer_load_dwordx4 v16, s[8:11], s28 offen lds
    s_mov_b64 exec, -1
    s_add_u32 s28, s28, 0x12000
    v_mfma_f32_16x16x32_bf16 v[192:195], v[124:127], v[48:51], v[192:195]
    ds_read_b64_tr_b16 v[90:91], v17 offset:39392
    v_mfma_f32_16x16x32_bf16 v[196:199], v[128:131], v[44:47], v[196:199]
    ds_read_b64_tr_b16 v[92:93], v17 offset:37120
    v_mfma_f32_16x16x32_bf16 v[200:203], v[128:131], v[48:51], v[200:203]
    ds_read_b64_tr_b16 v[94:95], v17 offset:39424
    s_waitcnt vmcnt(10) lgkmcnt(0)
    s_barrier
    v_mfma_f32_16x16x32_bf16 v[132:135], v[60:63], v[52:55], v[132:135]
    ds_read_b64_tr_b16 v[96:97], v17 offset:55296
    v_mfma_f32_16x16x32_bf16 v[136:139], v[60:63], v[56:59], v[136:139]
    ds_read_b64_tr_b16 v[98:99], v17 offset:57600
    v_mfma_f32_16x16x32_bf16 v[140:143], v[64:67], v[52:55], v[140:143]
    ds_read_b64_tr_b16 v[100:101], v17 offset:55328
    v_mfma_f32_16x16x32_bf16 v[144:147], v[64:67], v[56:59], v[144:147]
    ds_read_b64_tr_b16 v[102:103], v17 offset:57632
    v_mfma_f32_16x16x32_bf16 v[148:151], v[68:71], v[52:55], v[148:151]
    ds_read_b64_tr_b16 v[104:105], v17 offset:55360
    v_mfma_f32_16x16x32_bf16 v[152:155], v[68:71], v[56:59], v[152:155]
    ds_read_b64_tr_b16 v[106:107], v17 offset:57664
    v_mfma_f32_16x16x32_bf16 v[156:159], v[72:75], v[52:55], v[156:159]
    ds_read_b64_tr_b16 v[108:109], v17 offset:55392
    v_mfma_f32_16x16x32_bf16 v[160:163], v[72:75], v[56:59], v[160:163]
    ds_read_b64_tr_b16 v[110:111], v17 offset:57696
    v_mfma_f32_16x16x32_bf16 v[164:167], v[76:79], v[52:55], v[164:167]
    ds_read_b64_tr_b16 v[112:113], v17 offset:55424
    v_mfma_f32_16x16x32_bf16 v[168:171], v[76:79], v[56:59], v[168:171]
    ds_read_b64_tr_b16 v[114:115], v17 offset:57728
    v_mfma_f32_16x16x32_bf16 v[172:175], v[80:83], v[52:55], v[172:175]
    ds_read_b64_tr_b16 v[116:117], v17 offset:55456
    v_mfma_f32_16x16x32_bf16 v[176:179], v[80:83], v[56:59], v[176:179]
    ds_read_b64_tr_b16 v[118:119], v17 offset:57760
    v_mfma_f32_16x16x32_bf16 v[180:183], v[84:87], v[52:55], v[180:183]
    ds_read_b64_tr_b16 v[120:121], v17 offset:55488
    v_mfma_f32_16x16x32_bf16 v[184:187], v[84:87], v[56:59], v[184:187]
    ds_read_b64_tr_b16 v[122:123], v17 offset:57792
    v_mfma_f32_16x16x32_bf16 v[188:191], v[88:91], v[52:55], v[188:191]
    ds_read_b64_tr_b16 v[124:125], v17 offset:55520
    v_mfma_f32_16x16x32_bf16 v[192:195], v[88:91], v[56:59], v[192:195]
    ds_read_b64_tr_b16 v[126:127], v17 offset:57824
    v_mfma_f32_16x16x32_bf16 v[196:199], v[92:95], v[52:55], v[196:199]
    ds_read_b64_tr_b16 v[128:129], v17 offset:55552
    v_mfma_f32_16x16x32_bf16 v[200:203], v[92:95], v[56:59], v[200:203]
    ds_read_b64_tr_b16 v[130:131], v17 offset:57856
    s_waitcnt vmcnt(5) lgkmcnt(0)
    s_barrier
    v_mfma_f32_16x16x32_bf16 v[132:135], v[96:99], v[20:23], v[132:135]
    ds_read_b64_tr_b16 v[60:61], v17 offset:0
    v_mfma_f32_16x16x32_bf16 v[136:139], v[96:99], v[24:27], v[136:139]
    ds_read_b64_tr_b16 v[62:63], v17 offset:2304
    v_mfma_f32_16x16x32_bf16 v[140:143], v[100:103], v[20:23], v[140:143]
    ds_read_b64_tr_b16 v[64:65], v17 offset:32
    v_mfma_f32_16x16x32_bf16 v[144:147], v[100:103], v[24:27], v[144:147]
    ds_read_b64_tr_b16 v[66:67], v17 offset:2336
    v_mfma_f32_16x16x32_bf16 v[148:151], v[104:107], v[20:23], v[148:151]
    ds_read_b64_tr_b16 v[68:69], v17 offset:64
    v_mfma_f32_16x16x32_bf16 v[152:155], v[104:107], v[24:27], v[152:155]
    ds_read_b64_tr_b16 v[70:71], v17 offset:2368
    v_mfma_f32_16x16x32_bf16 v[156:159], v[108:111], v[20:23], v[156:159]
    ds_read_b64_tr_b16 v[72:73], v17 offset:96
    v_mfma_f32_16x16x32_bf16 v[160:163], v[108:111], v[24:27], v[160:163]
    ds_read_b64_tr_b16 v[74:75], v17 offset:2400
    v_mfma_f32_16x16x32_bf16 v[164:167], v[112:115], v[20:23], v[164:167]
    ds_read_b64_tr_b16 v[76:77], v17 offset:128
    v_mfma_f32_16x16x32_bf16 v[168:171], v[112:115], v[24:27], v[168:171]
    ds_read_b64_tr_b16 v[78:79], v17 offset:2432
    v_mfma_f32_16x16x32_bf16 v[172:175], v[116:119], v[20:23], v[172:175]
    ds_read_b64_tr_b16 v[80:81], v17 offset:160
    v_mfma_f32_16x16x32_bf16 v[176:179], v[116:119], v[24:27], v[176:179]
    ds_read_b64_tr_b16 v[82:83], v17 offset:2464
    v_mfma_f32_16x16x32_bf16 v[180:183], v[120:123], v[20:23], v[180:183]
    ds_read_b64_tr_b16 v[84:85], v17 offset:192
    v_mfma_f32_16x16x32_bf16 v[184:187], v[120:123], v[24:27], v[184:187]
    ds_read_b64_tr_b16 v[86:87], v17 offset:2496
    v_mfma_f32_16x16x32_bf16 v[188:191], v[124:127], v[20:23], v[188:191]
    ds_read_b64_tr_b16 v[88:89], v17 offset:224
    v_mfma_f32_16x16x32_bf16 v[192:195], v[124:127], v[24:27], v[192:195]
    ds_read_b64_tr_b16 v[90:91], v17 offset:2528
    v_mfma_f32_16x16x32_bf16 v[196:199], v[128:131], v[20:23], v[196:199]
    ds_read_b64_tr_b16 v[92:93], v17 offset:256
    v_mfma_f32_16x16x32_bf16 v[200:203], v[128:131], v[24:27], v[200:203]
    ds_read_b64_tr_b16 v[94:95], v17 offset:2560
    s_waitcnt vmcnt(0) lgkmcnt(0)
    s_barrier
    v_mfma_f32_16x16x32_bf16 v[132:135], v[60:63], v[28:31], v[132:135]
    ds_read_b64_tr_b16 v[96:97], v17 offset:18432
    v_mfma_f32_16x16x32_bf16 v[136:139], v[60:63], v[32:35], v[136:139]
    ds_read_b64_tr_b16 v[98:99], v17 offset:20736
    v_mfma_f32_16x16x32_bf16 v[140:143], v[64:67], v[28:31], v[140:143]
    ds_read_b64_tr_b16 v[100:101], v17 offset:18464
    v_mfma_f32_16x16x32_bf16 v[144:147], v[64:67], v[32:35], v[144:147]
    ds_read_b64_tr_b16 v[102:103], v17 offset:20768
    v_mfma_f32_16x16x32_bf16 v[148:151], v[68:71], v[28:31], v[148:151]
    ds_read_b64_tr_b16 v[104:105], v17 offset:18496
    v_mfma_f32_16x16x32_bf16 v[152:155], v[68:71], v[32:35], v[152:155]
    ds_read_b64_tr_b16 v[106:107], v17 offset:20800
    v_mfma_f32_16x16x32_bf16 v[156:159], v[72:75], v[28:31], v[156:159]
    ds_read_b64_tr_b16 v[108:109], v17 offset:18528
    v_mfma_f32_16x16x32_bf16 v[160:163], v[72:75], v[32:35], v[160:163]
    ds_read_b64_tr_b16 v[110:111], v17 offset:20832
    v_mfma_f32_16x16x32_bf16 v[164:167], v[76:79], v[28:31], v[164:167]
    ds_read_b64_tr_b16 v[112:113], v17 offset:18560
    v_mfma_f32_16x16x32_bf16 v[168:171], v[76:79], v[32:35], v[168:171]
    ds_read_b64_tr_b16 v[114:115], v17 offset:20864
    v_mfma_f32_16x16x32_bf16 v[172:175], v[80:83], v[28:31], v[172:175]
    ds_read_b64_tr_b16 v[116:117], v17 offset:18592
    v_mfma_f32_16x16x32_bf16 v[176:179], v[80:83], v[32:35], v[176:179]
    ds_read_b64_tr_b16 v[118:119], v17 offset:20896
    v_mfma_f32_16x16x32_bf16 v[180:183], v[84:87], v[28:31], v[180:183]
    ds_read_b64_tr_b16 v[120:121], v17 offset:18624
    v_mfma_f32_16x16x32_bf16 v[184:187], v[84:87], v[32:35], v[184:187]
    ds_read_b64_tr_b16 v[122:123], v17 offset:20928
    v_mfma_f32_16x16x32_bf16 v[188:191], v[88:91], v[28:31], v[188:191]
    ds_read_b64_tr_b16 v[124:125], v17 offset:18656
    v_mfma_f32_16x16x32_bf16 v[192:195], v[88:91], v[32:35], v[192:195]
    ds_read_b64_tr_b16 v[126:127], v17 offset:20960
    v_mfma_f32_16x16x32_bf16 v[196:199], v[92:95], v[28:31], v[196:199]
    ds_read_b64_tr_b16 v[128:129], v17 offset:18688
    v_mfma_f32_16x16x32_bf16 v[200:203], v[92:95], v[32:35], v[200:203]
    ds_read_b64_tr_b16 v[130:131], v17 offset:20992
    s_waitcnt vmcnt(3) lgkmcnt(0)
    v_mfma_f32_16x16x32_bf16 v[132:135], v[96:99], v[36:39], v[132:135]
    v_mfma_f32_16x16x32_bf16 v[136:139], v[96:99], v[40:43], v[136:139]
    v_mfma_f32_16x16x32_bf16 v[140:143], v[100:103], v[36:39], v[140:143]
    v_mfma_f32_16x16x32_bf16 v[144:147], v[100:103], v[40:43], v[144:147]
    v_mfma_f32_16x16x32_bf16 v[148:151], v[104:107], v[36:39], v[148:151]
    v_mfma_f32_16x16x32_bf16 v[152:155], v[104:107], v[40:43], v[152:155]
    v_mfma_f32_16x16x32_bf16 v[156:159], v[108:111], v[36:39], v[156:159]
    v_mfma_f32_16x16x32_bf16 v[160:163], v[108:111], v[40:43], v[160:163]
    v_mfma_f32_16x16x32_bf16 v[164:167], v[112:115], v[36:39], v[164:167]
    v_mfma_f32_16x16x32_bf16 v[168:171], v[112:115], v[40:43], v[168:171]
    v_mfma_f32_16x16x32_bf16 v[172:175], v[116:119], v[36:39], v[172:175]
    v_mfma_f32_16x16x32_bf16 v[176:179], v[116:119], v[40:43], v[176:179]
    v_mfma_f32_16x16x32_bf16 v[180:183], v[120:123], v[36:39], v[180:183]
    v_mfma_f32_16x16x32_bf16 v[184:187], v[120:123], v[40:43], v[184:187]
    v_mfma_f32_16x16x32_bf16 v[188:191], v[124:127], v[36:39], v[188:191]
    v_mfma_f32_16x16x32_bf16 v[192:195], v[124:127], v[40:43], v[192:195]
    v_mfma_f32_16x16x32_bf16 v[196:199], v[128:131], v[36:39], v[196:199]
    v_mfma_f32_16x16x32_bf16 v[200:203], v[128:131], v[40:43], v[200:203]
    s_nop 15
    s_barrier
    s_lshl_b32 s32, s21, 5
    v_and_b32 v2, 15, v1
    v_add_u32 v2, s32, v2
    v_mul_u32_u24 v2, 592, v2
    v_lshrrev_b32 v3, 4, v1
    v_lshl_add_u32 v2, v3, 4, v2
    s_mul_i32 s32, s23, 75776
    v_add_u32 v2, s32, v2
    ds_write_b128 v2, v[132:135] offset:0
    ds_write_b128 v2, v[136:139] offset:9472
    ds_write_b128 v2, v[140:143] offset:64
    ds_write_b128 v2, v[144:147] offset:9536
    ds_write_b128 v2, v[148:151] offset:128
    ds_write_b128 v2, v[152:155] offset:9600
    ds_write_b128 v2, v[156:159] offset:192
    ds_write_b128 v2, v[160:163] offset:9664
    ds_write_b128 v2, v[164:167] offset:256
    ds_write_b128 v2, v[168:171] offset:9728
    ds_write_b128 v2, v[172:175] offset:320
    ds_write_b128 v2, v[176:179] offset:9792
    ds_write_b128 v2, v[180:183] offset:384
    ds_write_b128 v2, v[184:187] offset:9856
    ds_write_b128 v2, v[188:191] offset:448
    ds_write_b128 v2, v[192:195] offset:9920
    ds_write_b128 v2, v[196:199] offset:512
    ds_write_b128 v2, v[200:203] offset:9984
    s_waitcnt lgkmcnt(0)
    s_barrier
    ds_read_b128 v[132:135], v204
    ds_read_b128 v[136:139], v206
    ds_read_b128 v[140:143], v207
    ds_read_b128 v[144:147], v209
    ds_read_b128 v[148:151], v210
    ds_read_b128 v[152:155], v212
    ds_read_b128 v[156:159], v213
    ds_read_b128 v[160:163], v215
    ds_read_b128 v[164:167], v216
    ds_read_b128 v[168:171], v218
    ds_read_b128 v[172:175], v219
    ds_read_b128 v[176:179], v221
    ds_read_b128 v[180:183], v222
    ds_read_b128 v[184:187], v224
    ds_read_b128 v[188:191], v225
    ds_read_b128 v[192:195], v227
    ds_read_b128 v[196:199], v228
    ds_read_b128 v[200:203], v230
    s_waitcnt lgkmcnt(14)
    v_add_f32 v132, v132, v136
    v_add_f32 v133, v133, v137
    v_add_f32 v134, v134, v138
    v_add_f32 v135, v135, v139
    buffer_store_dwordx4 v[132:135], v205, s[12:15], s56 offen sc0 sc1
    s_waitcnt lgkmcnt(14)
    v_add_f32 v140, v140, v144
    v_add_f32 v141, v141, v145
    v_add_f32 v142, v142, v146
    v_add_f32 v143, v143, v147
    buffer_store_dwordx4 v[140:143], v208, s[12:15], s56 offen sc0 sc1
    s_waitcnt lgkmcnt(12)
    v_add_f32 v148, v148, v152
    v_add_f32 v149, v149, v153
    v_add_f32 v150, v150, v154
    v_add_f32 v151, v151, v155
    buffer_store_dwordx4 v[148:151], v211, s[12:15], s56 offen sc0 sc1
    s_waitcnt lgkmcnt(10)
    v_add_f32 v156, v156, v160
    v_add_f32 v157, v157, v161
    v_add_f32 v158, v158, v162
    v_add_f32 v159, v159, v163
    buffer_store_dwordx4 v[156:159], v214, s[12:15], s56 offen sc0 sc1
    s_waitcnt lgkmcnt(8)
    v_add_f32 v164, v164, v168
    v_add_f32 v165, v165, v169
    v_add_f32 v166, v166, v170
    v_add_f32 v167, v167, v171
    buffer_store_dwordx4 v[164:167], v217, s[12:15], s56 offen sc0 sc1
    s_waitcnt lgkmcnt(6)
    v_add_f32 v172, v172, v176
    v_add_f32 v173, v173, v177
    v_add_f32 v174, v174, v178
    v_add_f32 v175, v175, v179
    buffer_store_dwordx4 v[172:175], v220, s[12:15], s56 offen sc0 sc1
    s_waitcnt lgkmcnt(4)
    v_add_f32 v180, v180, v184
    v_add_f32 v181, v181, v185
    v_add_f32 v182, v182, v186
    v_add_f32 v183, v183, v187
    buffer_store_dwordx4 v[180:183], v223, s[12:15], s56 offen sc0 sc1
    s_waitcnt lgkmcnt(2)
    v_add_f32 v188, v188, v192
    v_add_f32 v189, v189, v193
    v_add_f32 v190, v190, v194
    v_add_f32 v191, v191, v195
    buffer_store_dwordx4 v[188:191], v226, s[12:15], s56 offen sc0 sc1
    s_waitcnt lgkmcnt(0)
    v_add_f32 v196, v196, v200
    v_add_f32 v197, v197, v201
    v_add_f32 v198, v198, v202
    v_add_f32 v199, v199, v203
    buffer_store_dwordx4 v[196:199], v229, s[12:15], s56 offen sc0 sc1
L_down_kernel_end:
    s_endpgm
.globl red2_kernel
.p2align 8
.type red2_kernel,@function
red2_kernel:
    s_cmp_ge_u32 s2, 512
    s_cbranch_scc1 L_red2_kernel_end
    v_lshrrev_b32 v2, 6, v0
    v_and_b32 v1, 63, v0
    s_nop 0
    v_readfirstlane_b32 s20, v2
    s_nop 3
    s_mul_i32 s32, s2, 4
    s_add_u32 s32, s32, s20
    s_load_dwordx2 s[46:47], s[0:1], 104
    s_load_dwordx4 s[48:51], s[0:1], 80
    s_mul_i32 s33, s32, 2304
    s_mul_i32 s34, s32, 1152
    s_lshr_b32 s38, s32, 4
    s_mul_i32 s38, s38, 18432
    s_and_b32 s39, s32, 15
    s_lshl_b32 s39, s39, 4
    s_add_u32 s38, s38, s39
    s_waitcnt lgkmcnt(0)
    s_add_u32 s4, s46, 0x8000000
    s_addc_u32 s5, s47, 0
    s_mov_b32 s6, 0x1200000
    s_mov_b32 s7, 0x00020000
    s_add_u32 s16, s46, 0x400000
    s_addc_u32 s17, s47, 0
    s_mov_b32 s18, 0x240000
    s_mov_b32 s19, 0x00020000
    s_mov_b32 s12, s50
    s_mov_b32 s13, s51
    s_mov_b32 s14, 0x240000
    s_mov_b32 s15, 0x00020000
    s_mov_b32 s40, s48
    s_mov_b32 s41, s49
    s_mov_b32 s42, 0x480
    s_mov_b32 s43, 0x00020000
    v_lshlrev_b32 v4, 6, v1
    v_lshlrev_b32 v5, 5, v1
    s_mov_b32 exec_lo, 0xffffffff
    s_mov_b32 exec_hi, 0xf
    buffer_load_dwordx4 v[8:11], v4, s[4:7], s33 offen offset:0
    buffer_load_dwordx4 v[12:15], v4, s[4:7], s33 offen offset:16
    buffer_load_dwordx4 v[16:19], v4, s[4:7], s33 offen offset:32
    buffer_load_dwordx4 v[20:23], v4, s[4:7], s33 offen offset:48
    s_add_u32 s33, s33, 4718592
    buffer_load_dwordx4 v[24:27], v4, s[4:7], s33 offen offset:0
    buffer_load_dwordx4 v[28:31], v4, s[4:7], s33 offen offset:16
    buffer_load_dwordx4 v[32:35], v4, s[4:7], s33 offen offset:32
    buffer_load_dwordx4 v[36:39], v4, s[4:7], s33 offen offset:48
    s_add_u32 s33, s33, 4718592
    buffer_load_dwordx4 v[40:43], v4, s[4:7], s33 offen offset:0
    buffer_load_dwordx4 v[44:47], v4, s[4:7], s33 offen offset:16
    buffer_load_dwordx4 v[48:51], v4, s[4:7], s33 offen offset:32
    buffer_load_dwordx4 v[52:55], v4, s[4:7], s33 offen offset:48
    s_add_u32 s33, s33, 4718592
    buffer_load_dwordx4 v[56:59], v4, s[4:7], s33 offen offset:0
    buffer_load_dwordx4 v[60:63], v4, s[4:7], s33 offen offset:16
    buffer_load_dwordx4 v[64:67], v4, s[4:7], s33 offen offset:32
    buffer_load_dwordx4 v[68:71], v4, s[4:7], s33 offen offset:48
    buffer_load_dwordx4 v[72:75], v5, s[16:19], s34 offen offset:0
    buffer_load_dwordx4 v[76:79], v5, s[16:19], s34 offen offset:16
    buffer_load_dwordx4 v[80:83], v5, s[40:43], 0 offen offset:0
    buffer_load_dwordx4 v[84:87], v5, s[40:43], 0 offen offset:16
    v_lshrrev_b32 v6, 1, v1
    v_lshlrev_b32 v6, 10, v6
    v_and_b32 v104, 1, v1
    v_lshl_add_u32 v6, v104, 9, v6
    s_waitcnt vmcnt(0)
    v_add_f32 v8, v8, v24
    v_add_f32 v40, v40, v56
    v_add_f32 v9, v9, v25
    v_add_f32 v41, v41, v57
    v_add_f32 v10, v10, v26
    v_add_f32 v42, v42, v58
    v_add_f32 v11, v11, v27
    v_add_f32 v43, v43, v59
    v_add_f32 v12, v12, v28
    v_add_f32 v44, v44, v60
    v_add_f32 v13, v13, v29
    v_add_f32 v45, v45, v61
    v_add_f32 v14, v14, v30
    v_add_f32 v46, v46, v62
    v_add_f32 v15, v15, v31
    v_add_f32 v47, v47, v63
    v_add_f32 v16, v16, v32
    v_add_f32 v48, v48, v64
    v_add_f32 v17, v17, v33
    v_add_f32 v49, v49, v65
    v_add_f32 v18, v18, v34
    v_add_f32 v50, v50, v66
    v_add_f32 v19, v19, v35
    v_add_f32 v51, v51, v67
    v_add_f32 v20, v20, v36
    v_add_f32 v52, v52, v68
    v_add_f32 v21, v21, v37
    v_add_f32 v53, v53, v69
    v_add_f32 v22, v22, v38
    v_add_f32 v54, v54, v70
    v_add_f32 v23, v23, v39
    v_add_f32 v55, v55, v71
    v_add_f32 v8, v8, v40
    v_add_f32 v9, v9, v41
    v_add_f32 v10, v10, v42
    v_add_f32 v11, v11, v43
    v_add_f32 v12, v12, v44
    v_add_f32 v13, v13, v45
    v_add_f32 v14, v14, v46
    v_add_f32 v15, v15, v47
    v_add_f32 v16, v16, v48
    v_add_f32 v17, v17, v49
    v_add_f32 v18, v18, v50
    v_add_f32 v19, v19, v51
    v_add_f32 v20, v20, v52
    v_add_f32 v21, v21, v53
    v_add_f32 v22, v22, v54
    v_add_f32 v23, v23, v55
    v_cvt_pk_bf16_f32 v104, v8, v9
    v_lshlrev_b32 v8, 16, v104
    v_and_b32 v9, 0xffff0000, v104
    v_lshlrev_b32 v104, 16, v80
    v_and_b32 v105, 0xffff0000, v80
    v_add_f32 v8, v8, v104
    v_add_f32 v9, v9, v105
    v_cvt_pk_bf16_f32 v104, v8, v9
    v_lshlrev_b32 v8, 16, v104
    v_and_b32 v9, 0xffff0000, v104
    v_lshlrev_b32 v104, 16, v72
    v_and_b32 v105, 0xffff0000, v72
    v_add_f32 v8, v8, v104
    v_add_f32 v9, v9, v105
    v_cvt_pk_bf16_f32 v72, v8, v9
    v_cvt_pk_bf16_f32 v104, v10, v11
    v_lshlrev_b32 v10, 16, v104
    v_and_b32 v11, 0xffff0000, v104
    v_lshlrev_b32 v104, 16, v81
    v_and_b32 v105, 0xffff0000, v81
    v_add_f32 v10, v10, v104
    v_add_f32 v11, v11, v105
    v_cvt_pk_bf16_f32 v104, v10, v11
    v_lshlrev_b32 v10, 16, v104
    v_and_b32 v11, 0xffff0000, v104
    v_lshlrev_b32 v104, 16, v73
    v_and_b32 v105, 0xffff0000, v73
    v_add_f32 v10, v10, v104
    v_add_f32 v11, v11, v105
    v_cvt_pk_bf16_f32 v73, v10, v11
    v_cvt_pk_bf16_f32 v104, v12, v13
    v_lshlrev_b32 v12, 16, v104
    v_and_b32 v13, 0xffff0000, v104
    v_lshlrev_b32 v104, 16, v82
    v_and_b32 v105, 0xffff0000, v82
    v_add_f32 v12, v12, v104
    v_add_f32 v13, v13, v105
    v_cvt_pk_bf16_f32 v104, v12, v13
    v_lshlrev_b32 v12, 16, v104
    v_and_b32 v13, 0xffff0000, v104
    v_lshlrev_b32 v104, 16, v74
    v_and_b32 v105, 0xffff0000, v74
    v_add_f32 v12, v12, v104
    v_add_f32 v13, v13, v105
    v_cvt_pk_bf16_f32 v74, v12, v13
    v_cvt_pk_bf16_f32 v104, v14, v15
    v_lshlrev_b32 v14, 16, v104
    v_and_b32 v15, 0xffff0000, v104
    v_lshlrev_b32 v104, 16, v83
    v_and_b32 v105, 0xffff0000, v83
    v_add_f32 v14, v14, v104
    v_add_f32 v15, v15, v105
    v_cvt_pk_bf16_f32 v104, v14, v15
    v_lshlrev_b32 v14, 16, v104
    v_and_b32 v15, 0xffff0000, v104
    v_lshlrev_b32 v104, 16, v75
    v_and_b32 v105, 0xffff0000, v75
    v_add_f32 v14, v14, v104
    v_add_f32 v15, v15, v105
    v_cvt_pk_bf16_f32 v75, v14, v15
    v_cvt_pk_bf16_f32 v104, v16, v17
    v_lshlrev_b32 v16, 16, v104
    v_and_b32 v17, 0xffff0000, v104
    v_lshlrev_b32 v104, 16, v84
    v_and_b32 v105, 0xffff0000, v84
    v_add_f32 v16, v16, v104
    v_add_f32 v17, v17, v105
    v_cvt_pk_bf16_f32 v104, v16, v17
    v_lshlrev_b32 v16, 16, v104
    v_and_b32 v17, 0xffff0000, v104
    v_lshlrev_b32 v104, 16, v76
    v_and_b32 v105, 0xffff0000, v76
    v_add_f32 v16, v16, v104
    v_add_f32 v17, v17, v105
    v_cvt_pk_bf16_f32 v76, v16, v17
    v_cvt_pk_bf16_f32 v104, v18, v19
    v_lshlrev_b32 v18, 16, v104
    v_and_b32 v19, 0xffff0000, v104
    v_lshlrev_b32 v104, 16, v85
    v_and_b32 v105, 0xffff0000, v85
    v_add_f32 v18, v18, v104
    v_add_f32 v19, v19, v105
    v_cvt_pk_bf16_f32 v104, v18, v19
    v_lshlrev_b32 v18, 16, v104
    v_and_b32 v19, 0xffff0000, v104
    v_lshlrev_b32 v104, 16, v77
    v_and_b32 v105, 0xffff0000, v77
    v_add_f32 v18, v18, v104
    v_add_f32 v19, v19, v105
    v_cvt_pk_bf16_f32 v77, v18, v19
    v_cvt_pk_bf16_f32 v104, v20, v21
    v_lshlrev_b32 v20, 16, v104
    v_and_b32 v21, 0xffff0000, v104
    v_lshlrev_b32 v104, 16, v86
    v_and_b32 v105, 0xffff0000, v86
    v_add_f32 v20, v20, v104
    v_add_f32 v21, v21, v105
    v_cvt_pk_bf16_f32 v104, v20, v21
    v_lshlrev_b32 v20, 16, v104
    v_and_b32 v21, 0xffff0000, v104
    v_lshlrev_b32 v104, 16, v78
    v_and_b32 v105, 0xffff0000, v78
    v_add_f32 v20, v20, v104
    v_add_f32 v21, v21, v105
    v_cvt_pk_bf16_f32 v78, v20, v21
    v_cvt_pk_bf16_f32 v104, v22, v23
    v_lshlrev_b32 v22, 16, v104
    v_and_b32 v23, 0xffff0000, v104
    v_lshlrev_b32 v104, 16, v87
    v_and_b32 v105, 0xffff0000, v87
    v_add_f32 v22, v22, v104
    v_add_f32 v23, v23, v105
    v_cvt_pk_bf16_f32 v104, v22, v23
    v_lshlrev_b32 v22, 16, v104
    v_and_b32 v23, 0xffff0000, v104
    v_lshlrev_b32 v104, 16, v79
    v_and_b32 v105, 0xffff0000, v79
    v_add_f32 v22, v22, v104
    v_add_f32 v23, v23, v105
    v_cvt_pk_bf16_f32 v79, v22, v23
    buffer_store_dwordx4 v[72:75], v5, s[12:15], s34 offen offset:0
    buffer_store_dwordx4 v[76:79], v5, s[12:15], s34 offen offset:16
    s_mov_b64 exec, -1
L_red2_kernel_end:
    s_endpgm
L_text_end:
    s_endpgm
.section .rodata,"a"
.p2align 6
.amdhsa_kernel kv_proj_kernel
  .amdhsa_next_free_vgpr 245
  .amdhsa_next_free_sgpr 102
  .amdhsa_accum_offset 248
  .amdhsa_group_segment_fixed_size 0
  .amdhsa_kernarg_size 112
  .amdhsa_user_sgpr_count 2
  .amdhsa_user_sgpr_kernarg_segment_ptr 1
  .amdhsa_system_sgpr_workgroup_id_x 1
.end_amdhsa_kernel
.p2align 6
.amdhsa_kernel attn_kernel
  .amdhsa_next_free_vgpr 256
  .amdhsa_next_free_sgpr 102
  .amdhsa_accum_offset 256
  .amdhsa_group_segment_fixed_size 0
  .amdhsa_kernarg_size 112
  .amdhsa_user_sgpr_count 2
  .amdhsa_user_sgpr_kernarg_segment_ptr 1
  .amdhsa_system_sgpr_workgroup_id_x 1
.end_amdhsa_kernel
.p2align 6
.amdhsa_kernel oproj_kernel
  .amdhsa_next_free_vgpr 231
  .amdhsa_next_free_sgpr 102
  .amdhsa_accum_offset 232
  .amdhsa_group_segment_fixed_size 0
  .amdhsa_kernarg_size 112
  .amdhsa_user_sgpr_count 2
  .amdhsa_user_sgpr_kernarg_segment_ptr 1
  .amdhsa_system_sgpr_workgroup_id_x 1
.end_amdhsa_kernel
.p2align 6
.amdhsa_kernel red1_kernel
  .amdhsa_next_free_vgpr 112
  .amdhsa_next_free_sgpr 102
  .amdhsa_accum_offset 112
  .amdhsa_group_segment_fixed_size 0
  .amdhsa_kernarg_size 112
  .amdhsa_user_sgpr_count 2
  .amdhsa_user_sgpr_kernarg_segment_ptr 1
  .amdhsa_system_sgpr_workgroup_id_x 1
.end_amdhsa_kernel
.p2align 6
.amdhsa_kernel mlp_up_kernel
  .amdhsa_next_free_vgpr 240
  .amdhsa_next_free_sgpr 102
  .amdhsa_accum_offset 240
  .amdhsa_group_segment_fixed_size 0
  .amdhsa_kernarg_size 112
  .amdhsa_user_sgpr_count 2
  .amdhsa_user_sgpr_kernarg_segment_ptr 1
  .amdhsa_system_sgpr_workgroup_id_x 1
.end_amdhsa_kernel
.p2align 6
.amdhsa_kernel down_kernel
  .amdhsa_next_free_vgpr 231
  .amdhsa_next_free_sgpr 102
  .amdhsa_accum_offset 232
  .amdhsa_group_segment_fixed_size 0
  .amdhsa_kernarg_size 112
  .amdhsa_user_sgpr_count 2
  .amdhsa_user_sgpr_kernarg_segment_ptr 1
  .amdhsa_system_sgpr_workgroup_id_x 1
.end_amdhsa_kernel
.p2align 6
.amdhsa_kernel red2_kernel
  .amdhsa_next_free_vgpr 112
  .amdhsa_next_free_sgpr 102
  .amdhsa_accum_offset 112
  .amdhsa_group_segment_fixed_size 0
  .amdhsa_kernarg_size 112
  .amdhsa_user_sgpr_count 2
  .amdhsa_user_sgpr_kernarg_segment_ptr 1
  .amdhsa_system_sgpr_workgroup_id_x 1
.end_amdhsa_kernel
```
